```python
import torch

def _softmax(x, axis=-1):
    return torch.softmax(x, dim=axis)

def _gelu(x):
    return torch.nn.functional.gelu(x, approximate='tanh')

def _silu(x):
    return torch.nn.functional.silu(x)

def _sigmoid(x):
    return torch.sigmoid(x)

def _layernorm(x, axis=-1, eps=1e-05):
    m = x.mean(dim=axis, keepdim=True)
    v = x.var(dim=axis, keepdim=True, unbiased=False)
    return (x - m) / torch.sqrt(v + eps)

def _scatter_add(tgt, idx, src, axis=0):
    return tgt.clone().index_add_(axis, idx, src)

def _segment_sum(src, seg, n):
    out = torch.zeros((n,) + src.shape[1:], dtype=src.dtype)
    return out.index_add_(0, seg, src)

def _pad(x, pw):
    flat = tuple((v for pair in reversed(pw) for v in pair))
    return torch.nn.functional.pad(x, flat)
kernel_name = 'standalone__conformer_family_zipformer__speech'

def setup_inputs():

    _w = lambda a: (lambda t: t.to(torch.bfloat16) if t.is_floating_point() else t)(torch.as_tensor(a))
    B, T, D, K, H = (2, 4000, 256, 5, 4)
    sc = 0.1
    return {'x': _w((lambda *s: torch.randn(*s, dtype=torch.bfloat16) * 0.8)(B, T, D)), 'w_ff1a': _w((lambda *s: torch.randn(*s, dtype=torch.bfloat16) * 0.8)(D, 4 * D) * sc), 'w_ff1b': _w((lambda *s: torch.randn(*s, dtype=torch.bfloat16) * 0.8)(4 * D, D) * sc), 'w_qkv': _w((lambda *s: torch.randn(*s, dtype=torch.bfloat16) * 0.8)(D, 3 * D) * sc), 'w_o': _w((lambda *s: torch.randn(*s, dtype=torch.bfloat16) * 1.6)(D, D) * sc), 'w_pw1': _w((lambda *s: torch.randn(*s, dtype=torch.bfloat16) * 1.6)(D, 2 * D) * sc), 'dw': _w((lambda *s: torch.randn(*s, dtype=torch.bfloat16) * 0.4)(K, D)), 'w_pw2': _w((lambda *s: torch.randn(*s, dtype=torch.bfloat16) * 0.4)(D, D) * sc), 'w_ff2a': _w((lambda *s: torch.randn(*s, dtype=torch.bfloat16) * 0.8)(D, 4 * D) * sc), 'w_ff2b': _w((lambda *s: torch.randn(*s, dtype=torch.bfloat16) * 0.8)(4 * D, D) * sc)}

def reference(x, w_ff1a, w_ff1b, w_qkv, w_o, w_pw1, dw, w_pw2, w_ff2a, w_ff2b):
    B, T, D = x.shape
    K = dw.shape[0]
    H = 4
    Dh = D // H
    h = _layernorm(x, axis=-1)
    h = _silu(h @ w_ff1a) @ w_ff1b
    x = x + 0.5 * h
    h = _layernorm(x, axis=-1)
    qkv = h @ w_qkv
    q = (lambda x, *d: x.permute(*d))(qkv[..., :D].reshape(B, T, H, Dh), 0, 2, 1, 3)
    k = (lambda x, *d: x.permute(*d))(qkv[..., D:2 * D].reshape(B, T, H, Dh), 0, 2, 1, 3)
    v = (lambda x, *d: x.permute(*d))(qkv[..., 2 * D:].reshape(B, T, H, Dh), 0, 2, 1, 3)
    scale = Dh ** (-0.5)
    scores = torch.einsum('bhqd,bhkd->bhqk', q, k) * scale
    p = _softmax(scores, axis=-1)
    att = torch.einsum('bhqk,bhkd->bhqd', p, v)
    att = (lambda x, *d: x.permute(*d))(att, 0, 2, 1, 3).reshape(B, T, D)
    x = x + att @ w_o
    h = _layernorm(x, axis=-1)
    h = h @ w_pw1
    a, b = (h[..., :D].clone(), h[..., D:].clone())
    h = a * _sigmoid(b)
    pad = K // 2
    hp = _pad(h, ((0, 0), (pad, pad), (0, 0)))
    c = torch.zeros_like(h)
    for i in range(K):
        c = c + hp[:, i:i + T, :] * dw[i][None, None, :]
    x = x + _silu(c) @ w_pw2
    h = _layernorm(x, axis=-1)
    h = _silu(h @ w_ff2a) @ w_ff2b
    x = x + 0.5 * h
    return _layernorm(x, axis=-1)
```

```asm
; @launch kernel=pack_kernel grid=(642,1,1) block=(512,1,1) lds=8192
; @launch kernel=ff1qkv_kernel grid=(250,1,1) block=(512,1,1) lds=87040
; @launch kernel=attn_kernel grid=(256,1,1) block=(512,1,1) lds=139264
; @launch kernel=post_kernel grid=(250,1,1) block=(512,1,1) lds=132096
.amdgcn_target "amdgcn-amd-amdhsa--gfx950"
.text
.globl pack_kernel
.p2align 8
.type pack_kernel,@function
pack_kernel:
    s_cmp_ge_u32 s2, 642
    s_cbranch_scc1 L_pack_end
    s_cmp_lt_u32 s2, 250
    s_cbranch_scc1 L_pack_ln
    s_sub_u32 s2, s2, 250
    s_load_dwordx2 s[6:7], s[0:1], 96
    v_and_b32 v1, 63, v0
    v_lshrrev_b32 v2, 6, v0
    v_and_b32 v3, 31, v0
    v_bfe_u32 v4, v0, 5, 1
    v_readfirstlane_b32 s16, v2
    s_cmp_ge_u32 s2, 368
    s_nop 2
    s_cbranch_scc1 L_pack_zero
    s_cmp_ge_u32 s2, 64
    s_cbranch_scc1 L_pack_next0
    s_load_dwordx2 s[4:5], s[0:1], 8
    s_sub_u32 s17, s2, 0
    s_lshl_b32 s17, s17, 3
    s_add_u32 s17, s17, s16
    s_lshr_b32 s18, s17, 4
    s_and_b32 s19, s17, 15
    s_mov_b32 s20, 2048
    s_mov_b32 s21, 524288
    s_lshr_b32 s22, s18, 2
    s_and_b32 s22, s22, 7
    s_mul_i32 s22, s22, 176
    s_lshr_b32 s23, s18, 0
    s_and_b32 s23, s23, 3
    s_lshl_b32 s23, s23, 4
    s_add_u32 s22, s22, s23
    s_add_u32 s22, s22, s19
    s_add_u32 s22, s22, 0
    s_branch L_pack_common
L_pack_next0:
    s_cmp_ge_u32 s2, 128
    s_cbranch_scc1 L_pack_next1
    s_load_dwordx2 s[4:5], s[0:1], 16
    s_sub_u32 s17, s2, 64
    s_lshl_b32 s17, s17, 3
    s_add_u32 s17, s17, s16
    s_lshr_b32 s18, s17, 6
    s_and_b32 s19, s17, 63
    s_mov_b32 s20, 512
    s_mov_b32 s21, 524288
    s_lshr_b32 s22, s18, 0
    s_and_b32 s22, s22, 7
    s_mul_i32 s22, s22, 176
    s_lshr_b32 s23, s18, 0
    s_and_b32 s23, s23, 0
    s_lshl_b32 s23, s23, 4
    s_add_u32 s22, s22, s23
    s_add_u32 s22, s22, s19
    s_add_u32 s22, s22, 64
    s_branch L_pack_common
L_pack_next1:
    s_cmp_ge_u32 s2, 176
    s_cbranch_scc1 L_pack_next2
    s_load_dwordx2 s[4:5], s[0:1], 24
    s_sub_u32 s17, s2, 128
    s_lshl_b32 s17, s17, 3
    s_add_u32 s17, s17, s16
    s_lshr_b32 s18, s17, 4
    s_and_b32 s19, s17, 15
    s_mov_b32 s20, 1536
    s_mov_b32 s21, 393216
    s_lshr_b32 s22, s18, 0
    s_and_b32 s22, s22, 7
    s_mul_i32 s22, s22, 176
    s_lshr_b32 s23, s18, 3
    s_and_b32 s23, s23, 3
    s_lshl_b32 s23, s23, 4
    s_add_u32 s22, s22, s23
    s_add_u32 s22, s22, s19
    s_add_u32 s22, s22, 128
    s_branch L_pack_common
L_pack_next2:
    s_cmp_ge_u32 s2, 192
    s_cbranch_scc1 L_pack_next3
    s_load_dwordx2 s[4:5], s[0:1], 32
    s_sub_u32 s17, s2, 176
    s_lshl_b32 s17, s17, 3
    s_add_u32 s17, s17, s16
    s_lshr_b32 s18, s17, 4
    s_and_b32 s19, s17, 15
    s_mov_b32 s20, 512
    s_mov_b32 s21, 131072
    s_lshr_b32 s22, s18, 0
    s_and_b32 s22, s22, 7
    s_mul_i32 s22, s22, 192
    s_lshr_b32 s23, s18, 0
    s_and_b32 s23, s23, 0
    s_lshl_b32 s23, s23, 4
    s_add_u32 s22, s22, s23
    s_add_u32 s22, s22, s19
    s_add_u32 s22, s22, 1408
    s_branch L_pack_common
L_pack_next3:
    s_cmp_ge_u32 s2, 224
    s_cbranch_scc1 L_pack_next4
    s_load_dwordx2 s[4:5], s[0:1], 40
    s_sub_u32 s17, s2, 192
    s_lshl_b32 s17, s17, 3
    s_add_u32 s17, s17, s16
    s_lshr_b32 s18, s17, 4
    s_and_b32 s19, s17, 15
    s_mov_b32 s20, 1024
    s_mov_b32 s21, 262144
    s_lshr_b32 s22, s18, 0
    s_and_b32 s22, s22, 7
    s_mul_i32 s22, s22, 192
    s_lshr_b32 s23, s18, 3
    s_and_b32 s23, s23, 1
    s_lshl_b32 s23, s23, 4
    s_add_u32 s22, s22, s23
    s_add_u32 s22, s22, s19
    s_add_u32 s22, s22, 1424
    s_branch L_pack_common
L_pack_next4:
    s_cmp_ge_u32 s2, 240
    s_cbranch_scc1 L_pack_next5
    s_load_dwordx2 s[4:5], s[0:1], 56
    s_sub_u32 s17, s2, 224
    s_lshl_b32 s17, s17, 3
    s_add_u32 s17, s17, s16
    s_lshr_b32 s18, s17, 4
    s_and_b32 s19, s17, 15
    s_mov_b32 s20, 512
    s_mov_b32 s21, 131072
    s_lshr_b32 s22, s18, 0
    s_and_b32 s22, s22, 7
    s_mul_i32 s22, s22, 192
    s_lshr_b32 s23, s18, 0
    s_and_b32 s23, s23, 0
    s_lshl_b32 s23, s23, 4
    s_add_u32 s22, s22, s23
    s_add_u32 s22, s22, s19
    s_add_u32 s22, s22, 1456
    s_branch L_pack_common
L_pack_next5:
    s_cmp_ge_u32 s2, 304
    s_cbranch_scc1 L_pack_next6
    s_load_dwordx2 s[4:5], s[0:1], 64
    s_sub_u32 s17, s2, 240
    s_lshl_b32 s17, s17, 3
    s_add_u32 s17, s17, s16
    s_lshr_b32 s18, s17, 4
    s_and_b32 s19, s17, 15
    s_mov_b32 s20, 2048
    s_mov_b32 s21, 524288
    s_lshr_b32 s22, s18, 2
    s_and_b32 s22, s22, 7
    s_mul_i32 s22, s22, 192
    s_lshr_b32 s23, s18, 0
    s_and_b32 s23, s23, 3
    s_lshl_b32 s23, s23, 4
    s_add_u32 s22, s22, s23
    s_add_u32 s22, s22, s19
    s_add_u32 s22, s22, 1472
    s_branch L_pack_common
L_pack_next6:
    s_cmp_ge_u32 s2, 368
    s_cbranch_scc1 L_pack_next7
    s_load_dwordx2 s[4:5], s[0:1], 72
    s_sub_u32 s17, s2, 304
    s_lshl_b32 s17, s17, 3
    s_add_u32 s17, s17, s16
    s_lshr_b32 s18, s17, 6
    s_and_b32 s19, s17, 63
    s_mov_b32 s20, 512
    s_mov_b32 s21, 524288
    s_lshr_b32 s22, s18, 0
    s_and_b32 s22, s22, 7
    s_mul_i32 s22, s22, 192
    s_lshr_b32 s23, s18, 0
    s_and_b32 s23, s23, 0
    s_lshl_b32 s23, s23, 4
    s_add_u32 s22, s22, s23
    s_add_u32 s22, s22, s19
    s_add_u32 s22, s22, 1536
    s_branch L_pack_common
L_pack_next7:
    s_branch L_pack_end
L_pack_common:
    s_waitcnt lgkmcnt(0)
    s_mov_b32 s8, s4
    s_and_b32 s9, s5, 0xffff
    s_mov_b32 s10, s21
    s_mov_b32 s11, 0x20000
    s_mov_b32 s12, s6
    s_and_b32 s13, s7, 0xffff
    s_mov_b32 s14, 41943040
    s_mov_b32 s15, 0x20000
    s_lshl_b32 s24, s19, 4
    v_lshlrev_b32 v5, 2, v4
    v_add_u32 v5, s24, v5
    v_mul_lo_u32 v5, v5, s20
    s_lshl_b32 s25, s18, 5
    v_add_u32 v6, s25, v3
    v_lshlrev_b32 v6, 1, v6
    v_add_u32 v5, v5, v6
    s_mul_i32 s30, s20, 0
    s_mul_i32 s31, s20, 1
    s_mul_i32 s32, s20, 2
    s_mul_i32 s33, s20, 3
    s_mul_i32 s34, s20, 8
    s_mul_i32 s35, s20, 9
    s_mul_i32 s36, s20, 10
    s_mul_i32 s37, s20, 11
    buffer_load_ushort v16, v5, s[8:11], s30 offen
    buffer_load_ushort v17, v5, s[8:11], s31 offen
    buffer_load_ushort v18, v5, s[8:11], s32 offen
    buffer_load_ushort v19, v5, s[8:11], s33 offen
    buffer_load_ushort v20, v5, s[8:11], s34 offen
    buffer_load_ushort v21, v5, s[8:11], s35 offen
    buffer_load_ushort v22, v5, s[8:11], s36 offen
    buffer_load_ushort v23, v5, s[8:11], s37 offen
    s_lshl_b32 s22, s22, 10
    v_lshlrev_b32 v7, 4, v1
    s_waitcnt vmcnt(0)
    v_lshl_or_b32 v8, v17, 16, v16
    v_lshl_or_b32 v9, v19, 16, v18
    v_lshl_or_b32 v10, v21, 16, v20
    v_lshl_or_b32 v11, v23, 16, v22
    buffer_store_dwordx4 v[8:11], v7, s[12:15], s22 offen
    s_nop 0
    s_branch L_pack_end
L_pack_zero:
    s_waitcnt lgkmcnt(0)
    s_mov_b32 s12, s6
    s_and_b32 s13, s7, 0xffff
    s_mov_b32 s14, 41943040
    s_mov_b32 s15, 0x20000
    s_sub_u32 s17, s2, 368
    s_mul_i32 s18, s17, 43
    s_lshr_b32 s18, s18, 7
    s_mul_i32 s19, s18, 3
    s_sub_u32 s19, s17, s19
    s_add_u32 s19, s19, 125
    s_lshl_b32 s18, s18, 20
    s_lshl_b32 s19, s19, 13
    s_add_u32 s18, s18, s19
    s_add_u32 s18, s18, 16777216
    v_lshlrev_b32 v7, 4, v0
    v_mov_b32 v8, 0
    v_mov_b32 v9, 0
    v_mov_b32 v10, 0
    v_mov_b32 v11, 0
    buffer_store_dwordx4 v[8:11], v7, s[12:15], s18 offen
    s_nop 0
    s_branch L_pack_end
L_pack_ln:
    s_cmp_ge_u32 s2, 250
    s_cbranch_scc1 L_pack_end
    s_load_dwordx2 s[6:7], s[0:1], 96
    v_lshrrev_b32 v6, 6, v0
    v_and_b32 v7, 63, v0
    v_readfirstlane_b32 s16, v6
    v_lshlrev_b32 v1, 4, v7
    v_and_b32 v8, 31, v0
    v_bfe_u32 v9, v0, 5, 1
    v_mul_u32_u24 v3, 80, v8
    v_lshlrev_b32 v10, 1, v6
    v_add_u32 v10, v10, v9
    v_lshlrev_b32 v10, 2, v10
    v_add_u32 v3, 0, v3
    v_add_u32 v2, v10, v3
    v_add_u32 v5, 0, v1
    v_lshlrev_b32 v10, 11, v6
    v_add_u32 v4, v10, v1
    v_add_u32 v4, 0, v4
    s_load_dwordx2 s[4:5], s[0:1], 0
    v_lshlrev_b32 v11, 9, v8
    v_lshlrev_b32 v12, 3, v9
    v_add_u32 v11, v11, v12
    s_lshl_b32 s18, s2, 14
    s_lshl_b32 s19, s16, 6
    s_add_u32 s19, s18, s19
    s_lshl_b32 s21, s16, 11
    s_add_u32 s20, s18, s21
    s_add_u32 s20, s20, 37748736
    s_waitcnt lgkmcnt(0)
    s_mov_b32 s8, s4
    s_and_b32 s9, s5, 0xffff
    s_mov_b32 s10, 4096000
    s_mov_b32 s11, 0x20000
    s_mov_b32 s12, s6
    s_and_b32 s13, s7, 0xffff
    s_mov_b32 s14, 41943040
    s_mov_b32 s15, 0x20000
    buffer_load_dwordx2 v[16:17], v11, s[8:11], s19 offen offset:0
    buffer_load_dwordx2 v[18:19], v11, s[8:11], s19 offen offset:16
    buffer_load_dwordx2 v[20:21], v11, s[8:11], s19 offen offset:32
    buffer_load_dwordx2 v[22:23], v11, s[8:11], s19 offen offset:48
    s_waitcnt vmcnt(0)
    v_lshlrev_b32 v24, 16, v16
    v_and_b32 v25, 0xffff0000, v16
    v_lshlrev_b32 v26, 16, v17
    v_and_b32 v27, 0xffff0000, v17
    v_lshlrev_b32 v28, 16, v18
    v_and_b32 v29, 0xffff0000, v18
    v_lshlrev_b32 v30, 16, v19
    v_and_b32 v31, 0xffff0000, v19
    v_lshlrev_b32 v32, 16, v20
    v_and_b32 v33, 0xffff0000, v20
    v_lshlrev_b32 v34, 16, v21
    v_and_b32 v35, 0xffff0000, v21
    v_lshlrev_b32 v36, 16, v22
    v_and_b32 v37, 0xffff0000, v22
    v_lshlrev_b32 v38, 16, v23
    v_and_b32 v39, 0xffff0000, v23
    v_pk_add_f32 v[6:7], v[24:25], v[26:27]
    v_pk_add_f32 v[8:9], v[28:29], v[30:31]
    v_pk_add_f32 v[10:11], v[32:33], v[34:35]
    v_pk_add_f32 v[12:13], v[36:37], v[38:39]
    v_pk_add_f32 v[6:7], v[6:7], v[8:9]
    v_pk_add_f32 v[10:11], v[10:11], v[12:13]
    v_pk_add_f32 v[6:7], v[6:7], v[10:11]
    v_add_f32 v6, v6, v7
    v_mul_f32 v6, 0x3d800000, v6
    v_pk_add_f32 v[10:11], v[24:25], v[6:7] op_sel_hi:[1,0] neg_lo:[0,1] neg_hi:[0,1]
    v_pk_mul_f32 v[8:9], v[10:11], v[10:11]
    v_pk_add_f32 v[12:13], v[26:27], v[6:7] op_sel_hi:[1,0] neg_lo:[0,1] neg_hi:[0,1]
    v_pk_fma_f32 v[8:9], v[12:13], v[12:13], v[8:9]
    v_pk_add_f32 v[10:11], v[28:29], v[6:7] op_sel_hi:[1,0] neg_lo:[0,1] neg_hi:[0,1]
    v_pk_fma_f32 v[8:9], v[10:11], v[10:11], v[8:9]
    v_pk_add_f32 v[12:13], v[30:31], v[6:7] op_sel_hi:[1,0] neg_lo:[0,1] neg_hi:[0,1]
    v_pk_fma_f32 v[8:9], v[12:13], v[12:13], v[8:9]
    v_pk_add_f32 v[10:11], v[32:33], v[6:7] op_sel_hi:[1,0] neg_lo:[0,1] neg_hi:[0,1]
    v_pk_fma_f32 v[8:9], v[10:11], v[10:11], v[8:9]
    v_pk_add_f32 v[12:13], v[34:35], v[6:7] op_sel_hi:[1,0] neg_lo:[0,1] neg_hi:[0,1]
    v_pk_fma_f32 v[8:9], v[12:13], v[12:13], v[8:9]
    v_pk_add_f32 v[10:11], v[36:37], v[6:7] op_sel_hi:[1,0] neg_lo:[0,1] neg_hi:[0,1]
    v_pk_fma_f32 v[8:9], v[10:11], v[10:11], v[8:9]
    v_pk_add_f32 v[12:13], v[38:39], v[6:7] op_sel_hi:[1,0] neg_lo:[0,1] neg_hi:[0,1]
    v_pk_fma_f32 v[8:9], v[12:13], v[12:13], v[8:9]
    v_add_f32 v8, v8, v9
    ds_write_b32 v2, v6 offset:0
    ds_write_b32 v2, v8 offset:2560
    s_waitcnt lgkmcnt(0)
    s_barrier
    ds_read_b128 v[40:43], v3 offset:0
    ds_read_b128 v[44:47], v3 offset:16
    ds_read_b128 v[48:51], v3 offset:32
    ds_read_b128 v[52:55], v3 offset:48
    ds_read_b128 v[56:59], v3 offset:2560
    ds_read_b128 v[60:63], v3 offset:2576
    ds_read_b128 v[64:67], v3 offset:2592
    ds_read_b128 v[68:71], v3 offset:2608
    s_waitcnt lgkmcnt(4)
    v_pk_add_f32 v[6:7], v[40:41], v[42:43]
    v_pk_add_f32 v[8:9], v[44:45], v[46:47]
    v_pk_add_f32 v[10:11], v[48:49], v[50:51]
    v_pk_add_f32 v[12:13], v[52:53], v[54:55]
    v_pk_add_f32 v[6:7], v[6:7], v[8:9]
    v_pk_add_f32 v[10:11], v[10:11], v[12:13]
    v_pk_add_f32 v[6:7], v[6:7], v[10:11]
    v_add_f32 v6, v6, v7
    v_mul_f32 v6, 0x3d800000, v6
    v_pk_add_f32 v[10:11], v[40:41], v[6:7] op_sel_hi:[1,0] neg_lo:[0,1] neg_hi:[0,1]
    v_pk_mul_f32 v[8:9], v[10:11], v[10:11]
    v_pk_add_f32 v[12:13], v[42:43], v[6:7] op_sel_hi:[1,0] neg_lo:[0,1] neg_hi:[0,1]
    v_pk_fma_f32 v[8:9], v[12:13], v[12:13], v[8:9]
    v_pk_add_f32 v[10:11], v[44:45], v[6:7] op_sel_hi:[1,0] neg_lo:[0,1] neg_hi:[0,1]
    v_pk_fma_f32 v[8:9], v[10:11], v[10:11], v[8:9]
    v_pk_add_f32 v[12:13], v[46:47], v[6:7] op_sel_hi:[1,0] neg_lo:[0,1] neg_hi:[0,1]
    v_pk_fma_f32 v[8:9], v[12:13], v[12:13], v[8:9]
    v_pk_add_f32 v[10:11], v[48:49], v[6:7] op_sel_hi:[1,0] neg_lo:[0,1] neg_hi:[0,1]
    v_pk_fma_f32 v[8:9], v[10:11], v[10:11], v[8:9]
    v_pk_add_f32 v[12:13], v[50:51], v[6:7] op_sel_hi:[1,0] neg_lo:[0,1] neg_hi:[0,1]
    v_pk_fma_f32 v[8:9], v[12:13], v[12:13], v[8:9]
    v_pk_add_f32 v[10:11], v[52:53], v[6:7] op_sel_hi:[1,0] neg_lo:[0,1] neg_hi:[0,1]
    v_pk_fma_f32 v[8:9], v[10:11], v[10:11], v[8:9]
    v_pk_add_f32 v[12:13], v[54:55], v[6:7] op_sel_hi:[1,0] neg_lo:[0,1] neg_hi:[0,1]
    v_pk_fma_f32 v[8:9], v[12:13], v[12:13], v[8:9]
    v_add_f32 v8, v8, v9
    s_waitcnt lgkmcnt(0)
    v_pk_add_f32 v[40:41], v[56:57], v[58:59]
    v_pk_add_f32 v[42:43], v[60:61], v[62:63]
    v_pk_add_f32 v[44:45], v[64:65], v[66:67]
    v_pk_add_f32 v[46:47], v[68:69], v[70:71]
    v_pk_add_f32 v[40:41], v[40:41], v[42:43]
    v_pk_add_f32 v[44:45], v[44:45], v[46:47]
    v_pk_add_f32 v[40:41], v[40:41], v[44:45]
    v_add_f32 v40, v40, v41
    v_fmac_f32 v40, 0x41800000, v8
    v_mul_f32 v8, 0x3b800000, v40
    v_cvt_pk_bf16_f32 v10, v6, v8
    v_lshlrev_b32 v6, 16, v10
    v_and_b32 v8, 0xffff0000, v10
    v_add_f32 v8, 0x3727c5ac, v8
    v_cvt_pk_bf16_f32 v10, v8, v8
    v_lshlrev_b32 v8, 16, v10
    v_sqrt_f32 v8, v8
    v_pk_add_f32 v[40:41], v[24:25], v[6:7] op_sel_hi:[1,0] neg_lo:[0,1] neg_hi:[0,1]
    v_pk_add_f32 v[42:43], v[26:27], v[6:7] op_sel_hi:[1,0] neg_lo:[0,1] neg_hi:[0,1]
    v_pk_add_f32 v[44:45], v[28:29], v[6:7] op_sel_hi:[1,0] neg_lo:[0,1] neg_hi:[0,1]
    v_pk_add_f32 v[46:47], v[30:31], v[6:7] op_sel_hi:[1,0] neg_lo:[0,1] neg_hi:[0,1]
    v_pk_add_f32 v[48:49], v[32:33], v[6:7] op_sel_hi:[1,0] neg_lo:[0,1] neg_hi:[0,1]
    v_pk_add_f32 v[50:51], v[34:35], v[6:7] op_sel_hi:[1,0] neg_lo:[0,1] neg_hi:[0,1]
    v_pk_add_f32 v[52:53], v[36:37], v[6:7] op_sel_hi:[1,0] neg_lo:[0,1] neg_hi:[0,1]
    v_pk_add_f32 v[54:55], v[38:39], v[6:7] op_sel_hi:[1,0] neg_lo:[0,1] neg_hi:[0,1]
    v_cvt_pk_bf16_f32 v10, v8, v8
    v_lshlrev_b32 v8, 16, v10
    v_rcp_f32 v8, v8
    v_cvt_pk_bf16_f32 v10, v40, v41
    v_lshlrev_b32 v40, 16, v10
    v_and_b32 v41, 0xffff0000, v10
    v_cvt_pk_bf16_f32 v10, v42, v43
    v_lshlrev_b32 v42, 16, v10
    v_and_b32 v43, 0xffff0000, v10
    v_cvt_pk_bf16_f32 v10, v44, v45
    v_lshlrev_b32 v44, 16, v10
    v_and_b32 v45, 0xffff0000, v10
    v_cvt_pk_bf16_f32 v10, v46, v47
    v_lshlrev_b32 v46, 16, v10
    v_and_b32 v47, 0xffff0000, v10
    v_cvt_pk_bf16_f32 v10, v48, v49
    v_lshlrev_b32 v48, 16, v10
    v_and_b32 v49, 0xffff0000, v10
    v_cvt_pk_bf16_f32 v10, v50, v51
    v_lshlrev_b32 v50, 16, v10
    v_and_b32 v51, 0xffff0000, v10
    v_cvt_pk_bf16_f32 v10, v52, v53
    v_lshlrev_b32 v52, 16, v10
    v_and_b32 v53, 0xffff0000, v10
    v_cvt_pk_bf16_f32 v10, v54, v55
    v_lshlrev_b32 v54, 16, v10
    v_and_b32 v55, 0xffff0000, v10
    v_pk_mul_f32 v[40:41], v[40:41], v[8:9] op_sel_hi:[1,0]
    v_pk_mul_f32 v[42:43], v[42:43], v[8:9] op_sel_hi:[1,0]
    v_pk_mul_f32 v[44:45], v[44:45], v[8:9] op_sel_hi:[1,0]
    v_pk_mul_f32 v[46:47], v[46:47], v[8:9] op_sel_hi:[1,0]
    v_pk_mul_f32 v[48:49], v[48:49], v[8:9] op_sel_hi:[1,0]
    v_pk_mul_f32 v[50:51], v[50:51], v[8:9] op_sel_hi:[1,0]
    v_pk_mul_f32 v[52:53], v[52:53], v[8:9] op_sel_hi:[1,0]
    v_pk_mul_f32 v[54:55], v[54:55], v[8:9] op_sel_hi:[1,0]
    v_cvt_pk_bf16_f32 v56, v40, v41
    v_cvt_pk_bf16_f32 v57, v42, v43
    v_cvt_pk_bf16_f32 v58, v44, v45
    v_cvt_pk_bf16_f32 v59, v46, v47
    v_cvt_pk_bf16_f32 v60, v48, v49
    v_cvt_pk_bf16_f32 v61, v50, v51
    v_cvt_pk_bf16_f32 v62, v52, v53
    v_cvt_pk_bf16_f32 v63, v54, v55
    buffer_store_dwordx4 v[56:59], v1, s[12:15], s20 offen
    buffer_store_dwordx4 v[60:63], v1, s[12:15], s20 offen offset:1024
    s_nop 0
L_pack_end:
    s_endpgm
.globl ff1qkv_kernel
.p2align 8
.type ff1qkv_kernel,@function
ff1qkv_kernel:
    s_cmp_ge_u32 s2, 250
    s_cbranch_scc1 L_k1_end_ff1qkv_kernel
    s_load_dwordx2 s[6:7], s[0:1], 96
    v_lshrrev_b32 v6, 6, v0
    v_and_b32 v7, 63, v0
    v_readfirstlane_b32 s16, v6
    v_lshlrev_b32 v1, 4, v7
    v_and_b32 v8, 31, v0
    v_bfe_u32 v9, v0, 5, 1
    v_mul_u32_u24 v3, 80, v8
    v_lshlrev_b32 v10, 1, v6
    v_add_u32 v10, v10, v9
    v_lshlrev_b32 v10, 2, v10
    v_add_u32 v3, 81920, v3
    v_add_u32 v2, v10, v3
    v_add_u32 v5, 65536, v1
    v_lshlrev_b32 v10, 11, v6
    v_add_u32 v4, v10, v1
    v_add_u32 v4, 65536, v4
    s_load_dwordx2 s[4:5], s[0:1], 0
    v_lshlrev_b32 v11, 9, v8
    v_lshlrev_b32 v12, 3, v9
    v_add_u32 v11, v11, v12
    s_lshl_b32 s18, s2, 14
    s_lshl_b32 s19, s16, 6
    s_add_u32 s18, s18, s19
    s_mul_i32 s17, s16, 180224
    s_waitcnt lgkmcnt(0)
    s_mov_b32 s8, s4
    s_and_b32 s9, s5, 0xffff
    s_mov_b32 s10, 4096000
    s_mov_b32 s11, 0x20000
    s_mov_b32 s12, s6
    s_and_b32 s13, s7, 0xffff
    s_mov_b32 s14, 41943040
    s_mov_b32 s15, 0x20000
    s_lshl_b32 s20, s2, 14
    s_lshl_b32 s21, s16, 11
    s_add_u32 s20, s20, s21
    s_add_u32 s20, s20, 37748736
    s_add_u32 s21, s21, 65536
    s_mov_b32 m0, s21
    s_nop 0
    buffer_load_dwordx4 v1, s[12:15], s20 offen lds
    buffer_load_dwordx4 v1, s[12:15], s20 offen offset:1024 lds
    s_barrier
    buffer_load_dwordx4 v[168:171], v1, s[12:15], s17 offen offset:0
    buffer_load_dwordx4 v[172:175], v1, s[12:15], s17 offen offset:1024
    buffer_load_dwordx4 v[176:179], v1, s[12:15], s17 offen offset:2048
    buffer_load_dwordx4 v[180:183], v1, s[12:15], s17 offen offset:3072
    s_add_u32 s17, s17, 4096
    buffer_load_dwordx4 v[184:187], v1, s[12:15], s17 offen offset:0
    buffer_load_dwordx4 v[188:191], v1, s[12:15], s17 offen offset:1024
    buffer_load_dwordx2 v[16:17], v11, s[8:11], s18 offen offset:0
    buffer_load_dwordx2 v[18:19], v11, s[8:11], s18 offen offset:16
    buffer_load_dwordx2 v[20:21], v11, s[8:11], s18 offen offset:32
    buffer_load_dwordx2 v[22:23], v11, s[8:11], s18 offen offset:48
    s_lshl_b32 s19, s16, 13
    v_add_u32 v12, s19, v1
    v_add_u32 v0, 0, v12
    s_waitcnt vmcnt(10)
    s_barrier
    ds_read_b128 v[72:75], v5 offset:0
    ds_read_b128 v[76:79], v5 offset:1024
    ds_read_b128 v[80:83], v5 offset:2048
    ds_read_b128 v[84:87], v5 offset:3072
    ds_read_b128 v[88:91], v5 offset:4096
    ds_read_b128 v[92:95], v5 offset:5120
    ds_read_b128 v[96:99], v5 offset:6144
    ds_read_b128 v[100:103], v5 offset:7168
    ds_read_b128 v[104:107], v5 offset:8192
    ds_read_b128 v[108:111], v5 offset:9216
    ds_read_b128 v[112:115], v5 offset:10240
    ds_read_b128 v[116:119], v5 offset:11264
    ds_read_b128 v[120:123], v5 offset:12288
    ds_read_b128 v[124:127], v5 offset:13312
    ds_read_b128 v[128:131], v5 offset:14336
    ds_read_b128 v[132:135], v5 offset:15360
    s_waitcnt lgkmcnt(0)
    s_waitcnt vmcnt(9)
    v_mfma_f32_32x32x16_bf16 v[136:151], v[168:171], v[72:75], 0
    buffer_load_dwordx4 v[192:195], v1, s[12:15], s17 offen offset:2048
    buffer_load_dwordx4 v[196:199], v1, s[12:15], s17 offen offset:3072
    s_add_u32 s17, s17, 4096
    s_waitcnt vmcnt(10)
    v_mfma_f32_32x32x16_bf16 v[136:151], v[172:175], v[76:79], v[136:151]
    buffer_load_dwordx4 v[200:203], v1, s[12:15], s17 offen offset:0
    buffer_load_dwordx4 v[204:207], v1, s[12:15], s17 offen offset:1024
    s_waitcnt vmcnt(11)
    v_mfma_f32_32x32x16_bf16 v[136:151], v[176:179], v[80:83], v[136:151]
    buffer_load_dwordx4 v[208:211], v1, s[12:15], s17 offen offset:2048
    buffer_load_dwordx4 v[212:215], v1, s[12:15], s17 offen offset:3072
    s_add_u32 s17, s17, 4096
    s_waitcnt vmcnt(12)
    v_mfma_f32_32x32x16_bf16 v[136:151], v[180:183], v[84:87], v[136:151]
    buffer_load_dwordx4 v[216:219], v1, s[12:15], s17 offen offset:0
    buffer_load_dwordx4 v[220:223], v1, s[12:15], s17 offen offset:1024
    s_waitcnt vmcnt(13)
    v_mfma_f32_32x32x16_bf16 v[136:151], v[184:187], v[88:91], v[136:151]
    buffer_load_dwordx4 v[224:227], v1, s[12:15], s17 offen offset:2048
    buffer_load_dwordx4 v[228:231], v1, s[12:15], s17 offen offset:3072
    s_add_u32 s17, s17, 4096
    s_waitcnt vmcnt(14)
    v_mfma_f32_32x32x16_bf16 v[136:151], v[188:191], v[92:95], v[136:151]
    buffer_load_dwordx4 v[232:235], v1, s[12:15], s17 offen offset:0
    buffer_load_dwordx4 v[236:239], v1, s[12:15], s17 offen offset:1024
    s_waitcnt vmcnt(11)
    v_mfma_f32_32x32x16_bf16 v[136:151], v[192:195], v[96:99], v[136:151]
    buffer_load_dwordx4 v[240:243], v1, s[12:15], s17 offen offset:2048
    buffer_load_dwordx4 v[244:247], v1, s[12:15], s17 offen offset:3072
    s_add_u32 s17, s17, 4096
    s_waitcnt vmcnt(12)
    v_mfma_f32_32x32x16_bf16 v[136:151], v[196:199], v[100:103], v[136:151]
    buffer_load_dwordx4 v[248:251], v1, s[12:15], s17 offen offset:0
    buffer_load_dwordx4 v[252:255], v1, s[12:15], s17 offen offset:1024
    s_waitcnt vmcnt(13)
    v_mfma_f32_32x32x16_bf16 v[136:151], v[200:203], v[104:107], v[136:151]
    buffer_load_dwordx4 v[168:171], v1, s[12:15], s17 offen offset:2048
    buffer_load_dwordx4 v[172:175], v1, s[12:15], s17 offen offset:3072
    s_add_u32 s17, s17, 4096
    s_waitcnt vmcnt(14)
    v_mfma_f32_32x32x16_bf16 v[136:151], v[204:207], v[108:111], v[136:151]
    buffer_load_dwordx4 v[176:179], v1, s[12:15], s17 offen offset:0
    buffer_load_dwordx4 v[180:183], v1, s[12:15], s17 offen offset:1024
    s_waitcnt vmcnt(15)
    v_mfma_f32_32x32x16_bf16 v[136:151], v[208:211], v[112:115], v[136:151]
    buffer_load_dwordx4 v[184:187], v1, s[12:15], s17 offen offset:2048
    buffer_load_dwordx4 v[188:191], v1, s[12:15], s17 offen offset:3072
    s_add_u32 s17, s17, 4096
    s_waitcnt vmcnt(16)
    v_mfma_f32_32x32x16_bf16 v[136:151], v[212:215], v[116:119], v[136:151]
    buffer_load_dwordx4 v[192:195], v1, s[12:15], s17 offen offset:0
    buffer_load_dwordx4 v[196:199], v1, s[12:15], s17 offen offset:1024
    s_waitcnt vmcnt(17)
    v_mfma_f32_32x32x16_bf16 v[136:151], v[216:219], v[120:123], v[136:151]
    buffer_load_dwordx4 v[200:203], v1, s[12:15], s17 offen offset:2048
    buffer_load_dwordx4 v[204:207], v1, s[12:15], s17 offen offset:3072
    s_add_u32 s17, s17, 4096
    s_waitcnt vmcnt(18)
    v_mfma_f32_32x32x16_bf16 v[136:151], v[220:223], v[124:127], v[136:151]
    buffer_load_dwordx4 v[208:211], v1, s[12:15], s17 offen offset:0
    buffer_load_dwordx4 v[212:215], v1, s[12:15], s17 offen offset:1024
    s_waitcnt vmcnt(19)
    v_mfma_f32_32x32x16_bf16 v[136:151], v[224:227], v[128:131], v[136:151]
    buffer_load_dwordx4 v[216:219], v1, s[12:15], s17 offen offset:2048
    buffer_load_dwordx4 v[220:223], v1, s[12:15], s17 offen offset:3072
    s_add_u32 s17, s17, 4096
    s_waitcnt vmcnt(20)
    v_mfma_f32_32x32x16_bf16 v[136:151], v[228:231], v[132:135], v[136:151]
    buffer_load_dwordx4 v[224:227], v1, s[12:15], s17 offen offset:0
    buffer_load_dwordx4 v[228:231], v1, s[12:15], s17 offen offset:1024
    s_waitcnt vmcnt(21)
    v_mfma_f32_32x32x16_bf16 v[152:167], v[232:235], v[72:75], 0
    buffer_load_dwordx4 v[232:235], v1, s[12:15], s17 offen offset:2048
    s_nop 6
    v_cvt_pk_bf16_f32 v6, v136, v137
    v_lshlrev_b32 v136, 16, v6
    v_and_b32 v137, 0xffff0000, v6
    v_mul_f32 v7, 0xbfb8aa3b, v136
    v_mul_f32 v8, 0xbfb8aa3b, v137
    v_exp_f32 v7, v7
    v_exp_f32 v8, v8
    v_add_f32 v7, 1.0, v7
    s_waitcnt vmcnt(21)
    v_mfma_f32_32x32x16_bf16 v[152:167], v[236:239], v[76:79], v[152:167]
    buffer_load_dwordx4 v[236:239], v1, s[12:15], s17 offen offset:3072
    s_add_u32 s17, s17, 4096
    v_add_f32 v8, 1.0, v8
    v_rcp_f32 v7, v7
    v_rcp_f32 v8, v8
    v_mul_f32 v136, v136, v7
    v_mul_f32 v137, v137, v8
    v_cvt_pk_bf16_f32 v40, v136, v137
    v_cvt_pk_bf16_f32 v6, v138, v139
    v_lshlrev_b32 v138, 16, v6
    s_waitcnt vmcnt(21)
    v_mfma_f32_32x32x16_bf16 v[152:167], v[240:243], v[80:83], v[152:167]
    buffer_load_dwordx4 v[240:243], v1, s[12:15], s17 offen offset:0
    v_and_b32 v139, 0xffff0000, v6
    v_mul_f32 v9, 0xbfb8aa3b, v138
    v_mul_f32 v10, 0xbfb8aa3b, v139
    v_exp_f32 v9, v9
    v_exp_f32 v10, v10
    v_add_f32 v9, 1.0, v9
    v_add_f32 v10, 1.0, v10
    v_rcp_f32 v9, v9
    s_waitcnt vmcnt(21)
    v_mfma_f32_32x32x16_bf16 v[152:167], v[244:247], v[84:87], v[152:167]
    buffer_load_dwordx4 v[244:247], v1, s[12:15], s17 offen offset:1024
    v_rcp_f32 v10, v10
    v_mul_f32 v138, v138, v9
    v_mul_f32 v139, v139, v10
    v_cvt_pk_bf16_f32 v41, v138, v139
    v_cvt_pk_bf16_f32 v6, v140, v141
    v_lshlrev_b32 v140, 16, v6
    v_and_b32 v141, 0xffff0000, v6
    v_mul_f32 v7, 0xbfb8aa3b, v140
    s_waitcnt vmcnt(21)
    v_mfma_f32_32x32x16_bf16 v[152:167], v[248:251], v[88:91], v[152:167]
    buffer_load_dwordx4 v[248:251], v1, s[12:15], s17 offen offset:2048
    v_mul_f32 v8, 0xbfb8aa3b, v141
    v_exp_f32 v7, v7
    v_exp_f32 v8, v8
    v_add_f32 v7, 1.0, v7
    v_add_f32 v8, 1.0, v8
    v_rcp_f32 v7, v7
    v_rcp_f32 v8, v8
    v_mul_f32 v140, v140, v7
    s_waitcnt vmcnt(21)
    v_mfma_f32_32x32x16_bf16 v[152:167], v[252:255], v[92:95], v[152:167]
    buffer_load_dwordx4 v[252:255], v1, s[12:15], s17 offen offset:3072
    s_add_u32 s17, s17, 4096
    v_mul_f32 v141, v141, v8
    v_cvt_pk_bf16_f32 v42, v140, v141
    v_cvt_pk_bf16_f32 v6, v142, v143
    v_lshlrev_b32 v142, 16, v6
    v_and_b32 v143, 0xffff0000, v6
    v_mul_f32 v9, 0xbfb8aa3b, v142
    v_mul_f32 v10, 0xbfb8aa3b, v143
    v_exp_f32 v9, v9
    s_waitcnt vmcnt(21)
    v_mfma_f32_32x32x16_bf16 v[152:167], v[168:171], v[96:99], v[152:167]
    buffer_load_dwordx4 v[168:171], v1, s[12:15], s17 offen offset:0
    v_exp_f32 v10, v10
    v_add_f32 v9, 1.0, v9
    v_add_f32 v10, 1.0, v10
    v_rcp_f32 v9, v9
    v_rcp_f32 v10, v10
    v_mul_f32 v142, v142, v9
    v_mul_f32 v143, v143, v10
    v_cvt_pk_bf16_f32 v43, v142, v143
    s_waitcnt vmcnt(21)
    v_mfma_f32_32x32x16_bf16 v[152:167], v[172:175], v[100:103], v[152:167]
    buffer_load_dwordx4 v[172:175], v1, s[12:15], s17 offen offset:1024
    v_cvt_pk_bf16_f32 v6, v144, v145
    v_lshlrev_b32 v144, 16, v6
    v_and_b32 v145, 0xffff0000, v6
    v_mul_f32 v7, 0xbfb8aa3b, v144
    v_mul_f32 v8, 0xbfb8aa3b, v145
    v_exp_f32 v7, v7
    v_exp_f32 v8, v8
    v_add_f32 v7, 1.0, v7
    s_waitcnt vmcnt(21)
    v_mfma_f32_32x32x16_bf16 v[152:167], v[176:179], v[104:107], v[152:167]
    buffer_load_dwordx4 v[176:179], v1, s[12:15], s17 offen offset:2048
    v_add_f32 v8, 1.0, v8
    v_rcp_f32 v7, v7
    v_rcp_f32 v8, v8
    v_mul_f32 v144, v144, v7
    v_mul_f32 v145, v145, v8
    v_cvt_pk_bf16_f32 v44, v144, v145
    v_cvt_pk_bf16_f32 v6, v146, v147
    v_lshlrev_b32 v146, 16, v6
    s_waitcnt vmcnt(21)
    v_mfma_f32_32x32x16_bf16 v[152:167], v[180:183], v[108:111], v[152:167]
    buffer_load_dwordx4 v[180:183], v1, s[12:15], s17 offen offset:3072
    s_add_u32 s17, s17, 4096
    v_and_b32 v147, 0xffff0000, v6
    v_mul_f32 v9, 0xbfb8aa3b, v146
    v_mul_f32 v10, 0xbfb8aa3b, v147
    v_exp_f32 v9, v9
    v_exp_f32 v10, v10
    v_add_f32 v9, 1.0, v9
    v_add_f32 v10, 1.0, v10
    v_rcp_f32 v9, v9
    s_waitcnt vmcnt(21)
    v_mfma_f32_32x32x16_bf16 v[152:167], v[184:187], v[112:115], v[152:167]
    buffer_load_dwordx4 v[184:187], v1, s[12:15], s17 offen offset:0
    v_rcp_f32 v10, v10
    v_mul_f32 v146, v146, v9
    v_mul_f32 v147, v147, v10
    v_cvt_pk_bf16_f32 v45, v146, v147
    v_cvt_pk_bf16_f32 v6, v148, v149
    v_lshlrev_b32 v148, 16, v6
    v_and_b32 v149, 0xffff0000, v6
    v_mul_f32 v7, 0xbfb8aa3b, v148
    s_waitcnt vmcnt(21)
    v_mfma_f32_32x32x16_bf16 v[152:167], v[188:191], v[116:119], v[152:167]
    buffer_load_dwordx4 v[188:191], v1, s[12:15], s17 offen offset:1024
    v_mul_f32 v8, 0xbfb8aa3b, v149
    v_exp_f32 v7, v7
    v_exp_f32 v8, v8
    v_add_f32 v7, 1.0, v7
    v_add_f32 v8, 1.0, v8
    v_rcp_f32 v7, v7
    v_rcp_f32 v8, v8
    v_mul_f32 v148, v148, v7
    s_waitcnt vmcnt(21)
    v_mfma_f32_32x32x16_bf16 v[152:167], v[192:195], v[120:123], v[152:167]
    buffer_load_dwordx4 v[192:195], v1, s[12:15], s17 offen offset:2048
    v_mul_f32 v149, v149, v8
    v_cvt_pk_bf16_f32 v46, v148, v149
    v_cvt_pk_bf16_f32 v6, v150, v151
    v_lshlrev_b32 v150, 16, v6
    v_and_b32 v151, 0xffff0000, v6
    v_mul_f32 v9, 0xbfb8aa3b, v150
    v_mul_f32 v10, 0xbfb8aa3b, v151
    v_exp_f32 v9, v9
    s_waitcnt vmcnt(21)
    v_mfma_f32_32x32x16_bf16 v[152:167], v[196:199], v[124:127], v[152:167]
    buffer_load_dwordx4 v[196:199], v1, s[12:15], s17 offen offset:3072
    s_add_u32 s17, s17, 4096
    v_exp_f32 v10, v10
    v_add_f32 v9, 1.0, v9
    v_add_f32 v10, 1.0, v10
    v_rcp_f32 v9, v9
    v_rcp_f32 v10, v10
    v_mul_f32 v150, v150, v9
    v_mul_f32 v151, v151, v10
    v_cvt_pk_bf16_f32 v47, v150, v151
    s_waitcnt vmcnt(21)
    v_mfma_f32_32x32x16_bf16 v[152:167], v[200:203], v[128:131], v[152:167]
    buffer_load_dwordx4 v[200:203], v1, s[12:15], s17 offen offset:0
    ds_write_b128 v0, v[40:43] offset:0
    ds_write_b128 v0, v[44:47] offset:1024
    s_waitcnt vmcnt(21)
    v_mfma_f32_32x32x16_bf16 v[152:167], v[204:207], v[132:135], v[152:167]
    buffer_load_dwordx4 v[204:207], v1, s[12:15], s17 offen offset:1024
    s_waitcnt vmcnt(21)
    v_mfma_f32_32x32x16_bf16 v[136:151], v[208:211], v[72:75], 0
    buffer_load_dwordx4 v[208:211], v1, s[12:15], s17 offen offset:2048
    s_nop 7
    v_cvt_pk_bf16_f32 v11, v152, v153
    v_lshlrev_b32 v152, 16, v11
    v_and_b32 v153, 0xffff0000, v11
    v_mul_f32 v12, 0xbfb8aa3b, v152
    v_mul_f32 v13, 0xbfb8aa3b, v153
    v_exp_f32 v12, v12
    v_exp_f32 v13, v13
    v_add_f32 v12, 1.0, v12
    s_waitcnt vmcnt(21)
    v_mfma_f32_32x32x16_bf16 v[136:151], v[212:215], v[76:79], v[136:151]
    buffer_load_dwordx4 v[212:215], v1, s[12:15], s17 offen offset:3072
    s_add_u32 s17, s17, 4096
    v_add_f32 v13, 1.0, v13
    v_rcp_f32 v12, v12
    v_rcp_f32 v13, v13
    v_mul_f32 v152, v152, v12
    v_mul_f32 v153, v153, v13
    v_cvt_pk_bf16_f32 v56, v152, v153
    v_cvt_pk_bf16_f32 v11, v154, v155
    v_lshlrev_b32 v154, 16, v11
    s_waitcnt vmcnt(21)
    v_mfma_f32_32x32x16_bf16 v[136:151], v[216:219], v[80:83], v[136:151]
    buffer_load_dwordx4 v[216:219], v1, s[12:15], s17 offen offset:0
    v_and_b32 v155, 0xffff0000, v11
    v_mul_f32 v14, 0xbfb8aa3b, v154
    v_mul_f32 v15, 0xbfb8aa3b, v155
    v_exp_f32 v14, v14
    v_exp_f32 v15, v15
    v_add_f32 v14, 1.0, v14
    v_add_f32 v15, 1.0, v15
    v_rcp_f32 v14, v14
    s_waitcnt vmcnt(21)
    v_mfma_f32_32x32x16_bf16 v[136:151], v[220:223], v[84:87], v[136:151]
    buffer_load_dwordx4 v[220:223], v1, s[12:15], s17 offen offset:1024
    v_rcp_f32 v15, v15
    v_mul_f32 v154, v154, v14
    v_mul_f32 v155, v155, v15
    v_cvt_pk_bf16_f32 v57, v154, v155
    v_cvt_pk_bf16_f32 v11, v156, v157
    v_lshlrev_b32 v156, 16, v11
    v_and_b32 v157, 0xffff0000, v11
    v_mul_f32 v12, 0xbfb8aa3b, v156
    s_waitcnt vmcnt(21)
    v_mfma_f32_32x32x16_bf16 v[136:151], v[224:227], v[88:91], v[136:151]
    buffer_load_dwordx4 v[224:227], v1, s[12:15], s17 offen offset:2048
    v_mul_f32 v13, 0xbfb8aa3b, v157
    v_exp_f32 v12, v12
    v_exp_f32 v13, v13
    v_add_f32 v12, 1.0, v12
    v_add_f32 v13, 1.0, v13
    v_rcp_f32 v12, v12
    v_rcp_f32 v13, v13
    v_mul_f32 v156, v156, v12
    s_waitcnt vmcnt(21)
    v_mfma_f32_32x32x16_bf16 v[136:151], v[228:231], v[92:95], v[136:151]
    buffer_load_dwordx4 v[228:231], v1, s[12:15], s17 offen offset:3072
    s_add_u32 s17, s17, 4096
    v_mul_f32 v157, v157, v13
    v_cvt_pk_bf16_f32 v58, v156, v157
    v_cvt_pk_bf16_f32 v11, v158, v159
    v_lshlrev_b32 v158, 16, v11
    v_and_b32 v159, 0xffff0000, v11
    v_mul_f32 v14, 0xbfb8aa3b, v158
    v_mul_f32 v15, 0xbfb8aa3b, v159
    v_exp_f32 v14, v14
    s_waitcnt vmcnt(21)
    v_mfma_f32_32x32x16_bf16 v[136:151], v[232:235], v[96:99], v[136:151]
    buffer_load_dwordx4 v[232:235], v1, s[12:15], s17 offen offset:0
    v_exp_f32 v15, v15
    v_add_f32 v14, 1.0, v14
    v_add_f32 v15, 1.0, v15
    v_rcp_f32 v14, v14
    v_rcp_f32 v15, v15
    v_mul_f32 v158, v158, v14
    v_mul_f32 v159, v159, v15
    v_cvt_pk_bf16_f32 v59, v158, v159
    s_waitcnt vmcnt(21)
    v_mfma_f32_32x32x16_bf16 v[136:151], v[236:239], v[100:103], v[136:151]
    buffer_load_dwordx4 v[236:239], v1, s[12:15], s17 offen offset:1024
    v_cvt_pk_bf16_f32 v11, v160, v161
    v_lshlrev_b32 v160, 16, v11
    v_and_b32 v161, 0xffff0000, v11
    v_mul_f32 v12, 0xbfb8aa3b, v160
    v_mul_f32 v13, 0xbfb8aa3b, v161
    v_exp_f32 v12, v12
    v_exp_f32 v13, v13
    v_add_f32 v12, 1.0, v12
    s_waitcnt vmcnt(21)
    v_mfma_f32_32x32x16_bf16 v[136:151], v[240:243], v[104:107], v[136:151]
    buffer_load_dwordx4 v[240:243], v1, s[12:15], s17 offen offset:2048
    v_add_f32 v13, 1.0, v13
    v_rcp_f32 v12, v12
    v_rcp_f32 v13, v13
    v_mul_f32 v160, v160, v12
    v_mul_f32 v161, v161, v13
    v_cvt_pk_bf16_f32 v60, v160, v161
    v_cvt_pk_bf16_f32 v11, v162, v163
    v_lshlrev_b32 v162, 16, v11
    s_waitcnt vmcnt(21)
    v_mfma_f32_32x32x16_bf16 v[136:151], v[244:247], v[108:111], v[136:151]
    buffer_load_dwordx4 v[244:247], v1, s[12:15], s17 offen offset:3072
    s_add_u32 s17, s17, 4096
    v_and_b32 v163, 0xffff0000, v11
    v_mul_f32 v14, 0xbfb8aa3b, v162
    v_mul_f32 v15, 0xbfb8aa3b, v163
    v_exp_f32 v14, v14
    v_exp_f32 v15, v15
    v_add_f32 v14, 1.0, v14
    v_add_f32 v15, 1.0, v15
    v_rcp_f32 v14, v14
    s_waitcnt vmcnt(21)
    v_mfma_f32_32x32x16_bf16 v[136:151], v[248:251], v[112:115], v[136:151]
    buffer_load_dwordx4 v[248:251], v1, s[12:15], s17 offen offset:0
    v_rcp_f32 v15, v15
    v_mul_f32 v162, v162, v14
    v_mul_f32 v163, v163, v15
    v_cvt_pk_bf16_f32 v61, v162, v163
    v_cvt_pk_bf16_f32 v11, v164, v165
    v_lshlrev_b32 v164, 16, v11
    v_and_b32 v165, 0xffff0000, v11
    v_mul_f32 v12, 0xbfb8aa3b, v164
    s_waitcnt vmcnt(21)
    v_mfma_f32_32x32x16_bf16 v[136:151], v[252:255], v[116:119], v[136:151]
    buffer_load_dwordx4 v[252:255], v1, s[12:15], s17 offen offset:1024
    v_mul_f32 v13, 0xbfb8aa3b, v165
    v_exp_f32 v12, v12
    v_exp_f32 v13, v13
    v_add_f32 v12, 1.0, v12
    v_add_f32 v13, 1.0, v13
    v_rcp_f32 v12, v12
    v_rcp_f32 v13, v13
    v_mul_f32 v164, v164, v12
    s_waitcnt vmcnt(21)
    v_mfma_f32_32x32x16_bf16 v[136:151], v[168:171], v[120:123], v[136:151]
    buffer_load_dwordx4 v[168:171], v1, s[12:15], s17 offen offset:2048
    v_mul_f32 v165, v165, v13
    v_cvt_pk_bf16_f32 v62, v164, v165
    v_cvt_pk_bf16_f32 v11, v166, v167
    v_lshlrev_b32 v166, 16, v11
    v_and_b32 v167, 0xffff0000, v11
    v_mul_f32 v14, 0xbfb8aa3b, v166
    v_mul_f32 v15, 0xbfb8aa3b, v167
    v_exp_f32 v14, v14
    s_waitcnt vmcnt(21)
    v_mfma_f32_32x32x16_bf16 v[136:151], v[172:175], v[124:127], v[136:151]
    buffer_load_dwordx4 v[172:175], v1, s[12:15], s17 offen offset:3072
    s_add_u32 s17, s17, 4096
    v_exp_f32 v15, v15
    v_add_f32 v14, 1.0, v14
    v_add_f32 v15, 1.0, v15
    v_rcp_f32 v14, v14
    v_rcp_f32 v15, v15
    v_mul_f32 v166, v166, v14
    v_mul_f32 v167, v167, v15
    v_cvt_pk_bf16_f32 v63, v166, v167
    s_waitcnt vmcnt(21)
    v_mfma_f32_32x32x16_bf16 v[136:151], v[176:179], v[128:131], v[136:151]
    buffer_load_dwordx4 v[176:179], v1, s[12:15], s17 offen offset:0
    ds_write_b128 v0, v[56:59] offset:2048
    ds_write_b128 v0, v[60:63] offset:3072
    s_waitcnt vmcnt(21)
    v_mfma_f32_32x32x16_bf16 v[136:151], v[180:183], v[132:135], v[136:151]
    buffer_load_dwordx4 v[180:183], v1, s[12:15], s17 offen offset:1024
    s_waitcnt vmcnt(21)
    v_mfma_f32_32x32x16_bf16 v[152:167], v[184:187], v[72:75], 0
    buffer_load_dwordx4 v[184:187], v1, s[12:15], s17 offen offset:2048
    s_nop 7
    v_cvt_pk_bf16_f32 v6, v136, v137
    v_lshlrev_b32 v136, 16, v6
    v_and_b32 v137, 0xffff0000, v6
    v_mul_f32 v7, 0xbfb8aa3b, v136
    v_mul_f32 v8, 0xbfb8aa3b, v137
    v_exp_f32 v7, v7
    v_exp_f32 v8, v8
    v_add_f32 v7, 1.0, v7
    s_waitcnt vmcnt(21)
    v_mfma_f32_32x32x16_bf16 v[152:167], v[188:191], v[76:79], v[152:167]
    buffer_load_dwordx4 v[188:191], v1, s[12:15], s17 offen offset:3072
    s_add_u32 s17, s17, 4096
    v_add_f32 v8, 1.0, v8
    v_rcp_f32 v7, v7
    v_rcp_f32 v8, v8
    v_mul_f32 v136, v136, v7
    v_mul_f32 v137, v137, v8
    v_cvt_pk_bf16_f32 v40, v136, v137
    v_cvt_pk_bf16_f32 v6, v138, v139
    v_lshlrev_b32 v138, 16, v6
    s_waitcnt vmcnt(21)
    v_mfma_f32_32x32x16_bf16 v[152:167], v[192:195], v[80:83], v[152:167]
    buffer_load_dwordx4 v[192:195], v1, s[12:15], s17 offen offset:0
    v_and_b32 v139, 0xffff0000, v6
    v_mul_f32 v9, 0xbfb8aa3b, v138
    v_mul_f32 v10, 0xbfb8aa3b, v139
    v_exp_f32 v9, v9
    v_exp_f32 v10, v10
    v_add_f32 v9, 1.0, v9
    v_add_f32 v10, 1.0, v10
    v_rcp_f32 v9, v9
    s_waitcnt vmcnt(21)
    v_mfma_f32_32x32x16_bf16 v[152:167], v[196:199], v[84:87], v[152:167]
    buffer_load_dwordx4 v[196:199], v1, s[12:15], s17 offen offset:1024
    v_rcp_f32 v10, v10
    v_mul_f32 v138, v138, v9
    v_mul_f32 v139, v139, v10
    v_cvt_pk_bf16_f32 v41, v138, v139
    v_cvt_pk_bf16_f32 v6, v140, v141
    v_lshlrev_b32 v140, 16, v6
    v_and_b32 v141, 0xffff0000, v6
    v_mul_f32 v7, 0xbfb8aa3b, v140
    s_waitcnt vmcnt(21)
    v_mfma_f32_32x32x16_bf16 v[152:167], v[200:203], v[88:91], v[152:167]
    buffer_load_dwordx4 v[200:203], v1, s[12:15], s17 offen offset:2048
    v_mul_f32 v8, 0xbfb8aa3b, v141
    v_exp_f32 v7, v7
    v_exp_f32 v8, v8
    v_add_f32 v7, 1.0, v7
    v_add_f32 v8, 1.0, v8
    v_rcp_f32 v7, v7
    v_rcp_f32 v8, v8
    v_mul_f32 v140, v140, v7
    s_waitcnt vmcnt(21)
    v_mfma_f32_32x32x16_bf16 v[152:167], v[204:207], v[92:95], v[152:167]
    buffer_load_dwordx4 v[204:207], v1, s[12:15], s17 offen offset:3072
    s_add_u32 s17, s17, 4096
    v_mul_f32 v141, v141, v8
    v_cvt_pk_bf16_f32 v42, v140, v141
    v_cvt_pk_bf16_f32 v6, v142, v143
    v_lshlrev_b32 v142, 16, v6
    v_and_b32 v143, 0xffff0000, v6
    v_mul_f32 v9, 0xbfb8aa3b, v142
    v_mul_f32 v10, 0xbfb8aa3b, v143
    v_exp_f32 v9, v9
    s_waitcnt vmcnt(21)
    v_mfma_f32_32x32x16_bf16 v[152:167], v[208:211], v[96:99], v[152:167]
    buffer_load_dwordx4 v[208:211], v1, s[12:15], s17 offen offset:0
    v_exp_f32 v10, v10
    v_add_f32 v9, 1.0, v9
    v_add_f32 v10, 1.0, v10
    v_rcp_f32 v9, v9
    v_rcp_f32 v10, v10
    v_mul_f32 v142, v142, v9
    v_mul_f32 v143, v143, v10
    v_cvt_pk_bf16_f32 v43, v142, v143
    s_waitcnt vmcnt(21)
    v_mfma_f32_32x32x16_bf16 v[152:167], v[212:215], v[100:103], v[152:167]
    buffer_load_dwordx4 v[212:215], v1, s[12:15], s17 offen offset:1024
    v_cvt_pk_bf16_f32 v6, v144, v145
    v_lshlrev_b32 v144, 16, v6
    v_and_b32 v145, 0xffff0000, v6
    v_mul_f32 v7, 0xbfb8aa3b, v144
    v_mul_f32 v8, 0xbfb8aa3b, v145
    v_exp_f32 v7, v7
    v_exp_f32 v8, v8
    v_add_f32 v7, 1.0, v7
    s_waitcnt vmcnt(21)
    v_mfma_f32_32x32x16_bf16 v[152:167], v[216:219], v[104:107], v[152:167]
    buffer_load_dwordx4 v[216:219], v1, s[12:15], s17 offen offset:2048
    v_add_f32 v8, 1.0, v8
    v_rcp_f32 v7, v7
    v_rcp_f32 v8, v8
    v_mul_f32 v144, v144, v7
    v_mul_f32 v145, v145, v8
    v_cvt_pk_bf16_f32 v44, v144, v145
    v_cvt_pk_bf16_f32 v6, v146, v147
    v_lshlrev_b32 v146, 16, v6
    s_waitcnt vmcnt(21)
    v_mfma_f32_32x32x16_bf16 v[152:167], v[220:223], v[108:111], v[152:167]
    buffer_load_dwordx4 v[220:223], v1, s[12:15], s17 offen offset:3072
    s_add_u32 s17, s17, 4096
    v_and_b32 v147, 0xffff0000, v6
    v_mul_f32 v9, 0xbfb8aa3b, v146
    v_mul_f32 v10, 0xbfb8aa3b, v147
    v_exp_f32 v9, v9
    v_exp_f32 v10, v10
    v_add_f32 v9, 1.0, v9
    v_add_f32 v10, 1.0, v10
    v_rcp_f32 v9, v9
    s_waitcnt vmcnt(21)
    v_mfma_f32_32x32x16_bf16 v[152:167], v[224:227], v[112:115], v[152:167]
    buffer_load_dwordx4 v[224:227], v1, s[12:15], s17 offen offset:0
    v_rcp_f32 v10, v10
    v_mul_f32 v146, v146, v9
    v_mul_f32 v147, v147, v10
    v_cvt_pk_bf16_f32 v45, v146, v147
    v_cvt_pk_bf16_f32 v6, v148, v149
    v_lshlrev_b32 v148, 16, v6
    v_and_b32 v149, 0xffff0000, v6
    v_mul_f32 v7, 0xbfb8aa3b, v148
    s_waitcnt vmcnt(21)
    v_mfma_f32_32x32x16_bf16 v[152:167], v[228:231], v[116:119], v[152:167]
    buffer_load_dwordx4 v[228:231], v1, s[12:15], s17 offen offset:1024
    v_mul_f32 v8, 0xbfb8aa3b, v149
    v_exp_f32 v7, v7
    v_exp_f32 v8, v8
    v_add_f32 v7, 1.0, v7
    v_add_f32 v8, 1.0, v8
    v_rcp_f32 v7, v7
    v_rcp_f32 v8, v8
    v_mul_f32 v148, v148, v7
    s_waitcnt vmcnt(21)
    v_mfma_f32_32x32x16_bf16 v[152:167], v[232:235], v[120:123], v[152:167]
    buffer_load_dwordx4 v[232:235], v1, s[12:15], s17 offen offset:2048
    v_mul_f32 v149, v149, v8
    v_cvt_pk_bf16_f32 v46, v148, v149
    v_cvt_pk_bf16_f32 v6, v150, v151
    v_lshlrev_b32 v150, 16, v6
    v_and_b32 v151, 0xffff0000, v6
    v_mul_f32 v9, 0xbfb8aa3b, v150
    v_mul_f32 v10, 0xbfb8aa3b, v151
    v_exp_f32 v9, v9
    s_waitcnt vmcnt(21)
    v_mfma_f32_32x32x16_bf16 v[152:167], v[236:239], v[124:127], v[152:167]
    buffer_load_dwordx4 v[236:239], v1, s[12:15], s17 offen offset:3072
    s_add_u32 s17, s17, 4096
    v_exp_f32 v10, v10
    v_add_f32 v9, 1.0, v9
    v_add_f32 v10, 1.0, v10
    v_rcp_f32 v9, v9
    v_rcp_f32 v10, v10
    v_mul_f32 v150, v150, v9
    v_mul_f32 v151, v151, v10
    v_cvt_pk_bf16_f32 v47, v150, v151
    s_waitcnt vmcnt(21)
    v_mfma_f32_32x32x16_bf16 v[152:167], v[240:243], v[128:131], v[152:167]
    buffer_load_dwordx4 v[240:243], v1, s[12:15], s17 offen offset:0
    ds_write_b128 v0, v[40:43] offset:4096
    ds_write_b128 v0, v[44:47] offset:5120
    s_waitcnt vmcnt(21)
    v_mfma_f32_32x32x16_bf16 v[152:167], v[244:247], v[132:135], v[152:167]
    buffer_load_dwordx4 v[244:247], v1, s[12:15], s17 offen offset:1024
    s_nop 10
    v_cvt_pk_bf16_f32 v11, v152, v153
    v_lshlrev_b32 v152, 16, v11
    v_and_b32 v153, 0xffff0000, v11
    v_mul_f32 v12, 0xbfb8aa3b, v152
    v_mul_f32 v13, 0xbfb8aa3b, v153
    v_exp_f32 v12, v12
    v_exp_f32 v13, v13
    v_add_f32 v12, 1.0, v12
    v_add_f32 v13, 1.0, v13
    v_rcp_f32 v12, v12
    v_rcp_f32 v13, v13
    v_mul_f32 v152, v152, v12
    v_mul_f32 v153, v153, v13
    v_cvt_pk_bf16_f32 v56, v152, v153
    v_cvt_pk_bf16_f32 v11, v154, v155
    v_lshlrev_b32 v154, 16, v11
    v_and_b32 v155, 0xffff0000, v11
    v_mul_f32 v14, 0xbfb8aa3b, v154
    v_mul_f32 v15, 0xbfb8aa3b, v155
    v_exp_f32 v14, v14
    v_exp_f32 v15, v15
    v_add_f32 v14, 1.0, v14
    v_add_f32 v15, 1.0, v15
    v_rcp_f32 v14, v14
    v_rcp_f32 v15, v15
    v_mul_f32 v154, v154, v14
    v_mul_f32 v155, v155, v15
    v_cvt_pk_bf16_f32 v57, v154, v155
    v_cvt_pk_bf16_f32 v11, v156, v157
    v_lshlrev_b32 v156, 16, v11
    v_and_b32 v157, 0xffff0000, v11
    v_mul_f32 v12, 0xbfb8aa3b, v156
    v_mul_f32 v13, 0xbfb8aa3b, v157
    v_exp_f32 v12, v12
    v_exp_f32 v13, v13
    v_add_f32 v12, 1.0, v12
    v_add_f32 v13, 1.0, v13
    v_rcp_f32 v12, v12
    v_rcp_f32 v13, v13
    v_mul_f32 v156, v156, v12
    v_mul_f32 v157, v157, v13
    v_cvt_pk_bf16_f32 v58, v156, v157
    v_cvt_pk_bf16_f32 v11, v158, v159
    v_lshlrev_b32 v158, 16, v11
    v_and_b32 v159, 0xffff0000, v11
    v_mul_f32 v14, 0xbfb8aa3b, v158
    v_mul_f32 v15, 0xbfb8aa3b, v159
    v_exp_f32 v14, v14
    v_exp_f32 v15, v15
    v_add_f32 v14, 1.0, v14
    v_add_f32 v15, 1.0, v15
    v_rcp_f32 v14, v14
    v_rcp_f32 v15, v15
    v_mul_f32 v158, v158, v14
    v_mul_f32 v159, v159, v15
    v_cvt_pk_bf16_f32 v59, v158, v159
    v_cvt_pk_bf16_f32 v11, v160, v161
    v_lshlrev_b32 v160, 16, v11
    v_and_b32 v161, 0xffff0000, v11
    v_mul_f32 v12, 0xbfb8aa3b, v160
    v_mul_f32 v13, 0xbfb8aa3b, v161
    v_exp_f32 v12, v12
    v_exp_f32 v13, v13
    v_add_f32 v12, 1.0, v12
    v_add_f32 v13, 1.0, v13
    v_rcp_f32 v12, v12
    v_rcp_f32 v13, v13
    v_mul_f32 v160, v160, v12
    v_mul_f32 v161, v161, v13
    v_cvt_pk_bf16_f32 v60, v160, v161
    v_cvt_pk_bf16_f32 v11, v162, v163
    v_lshlrev_b32 v162, 16, v11
    v_and_b32 v163, 0xffff0000, v11
    v_mul_f32 v14, 0xbfb8aa3b, v162
    v_mul_f32 v15, 0xbfb8aa3b, v163
    v_exp_f32 v14, v14
    v_exp_f32 v15, v15
    v_add_f32 v14, 1.0, v14
    v_add_f32 v15, 1.0, v15
    v_rcp_f32 v14, v14
    v_rcp_f32 v15, v15
    v_mul_f32 v162, v162, v14
    v_mul_f32 v163, v163, v15
    v_cvt_pk_bf16_f32 v61, v162, v163
    v_cvt_pk_bf16_f32 v11, v164, v165
    v_lshlrev_b32 v164, 16, v11
    v_and_b32 v165, 0xffff0000, v11
    v_mul_f32 v12, 0xbfb8aa3b, v164
    v_mul_f32 v13, 0xbfb8aa3b, v165
    v_exp_f32 v12, v12
    v_exp_f32 v13, v13
    v_add_f32 v12, 1.0, v12
    v_add_f32 v13, 1.0, v13
    v_rcp_f32 v12, v12
    v_rcp_f32 v13, v13
    v_mul_f32 v164, v164, v12
    v_mul_f32 v165, v165, v13
    v_cvt_pk_bf16_f32 v62, v164, v165
    v_cvt_pk_bf16_f32 v11, v166, v167
    v_lshlrev_b32 v166, 16, v11
    v_and_b32 v167, 0xffff0000, v11
    v_mul_f32 v14, 0xbfb8aa3b, v166
    v_mul_f32 v15, 0xbfb8aa3b, v167
    v_exp_f32 v14, v14
    v_exp_f32 v15, v15
    v_add_f32 v14, 1.0, v14
    v_add_f32 v15, 1.0, v15
    v_rcp_f32 v14, v14
    v_rcp_f32 v15, v15
    v_mul_f32 v166, v166, v14
    v_mul_f32 v167, v167, v15
    v_cvt_pk_bf16_f32 v63, v166, v167
    ds_write_b128 v0, v[56:59] offset:6144
    ds_write_b128 v0, v[60:63] offset:7168
    s_waitcnt lgkmcnt(0)
    s_barrier
    ds_read_b128 v[72:75], v1 offset:0
    ds_read_b128 v[76:79], v1 offset:1024
    ds_read_b128 v[80:83], v1 offset:2048
    ds_read_b128 v[84:87], v1 offset:3072
    ds_read_b128 v[88:91], v1 offset:4096
    ds_read_b128 v[92:95], v1 offset:5120
    ds_read_b128 v[96:99], v1 offset:6144
    ds_read_b128 v[100:103], v1 offset:7168
    s_waitcnt vmcnt(21)
    s_waitcnt lgkmcnt(7)
    v_mfma_f32_32x32x16_bf16 v[136:151], v[248:251], v[72:75], 0
    buffer_load_dwordx4 v[248:251], v1, s[12:15], s17 offen offset:2048
    ds_read_b128 v[72:75], v1 offset:8192
    s_waitcnt vmcnt(21)
    s_waitcnt lgkmcnt(7)
    v_mfma_f32_32x32x16_bf16 v[136:151], v[252:255], v[76:79], v[136:151]
    buffer_load_dwordx4 v[252:255], v1, s[12:15], s17 offen offset:3072
    s_add_u32 s17, s17, 4096
    ds_read_b128 v[76:79], v1 offset:9216
    s_waitcnt vmcnt(21)
    s_waitcnt lgkmcnt(7)
    v_mfma_f32_32x32x16_bf16 v[136:151], v[168:171], v[80:83], v[136:151]
    buffer_load_dwordx4 v[168:171], v1, s[12:15], s17 offen offset:0
    ds_read_b128 v[80:83], v1 offset:10240
    s_waitcnt vmcnt(21)
    s_waitcnt lgkmcnt(7)
    v_mfma_f32_32x32x16_bf16 v[136:151], v[172:175], v[84:87], v[136:151]
    buffer_load_dwordx4 v[172:175], v1, s[12:15], s17 offen offset:1024
    ds_read_b128 v[84:87], v1 offset:11264
    s_waitcnt vmcnt(21)
    s_waitcnt lgkmcnt(7)
    v_mfma_f32_32x32x16_bf16 v[136:151], v[176:179], v[88:91], v[136:151]
    buffer_load_dwordx4 v[176:179], v1, s[12:15], s17 offen offset:2048
    ds_read_b128 v[88:91], v1 offset:12288
    s_waitcnt vmcnt(21)
    s_waitcnt lgkmcnt(7)
    v_mfma_f32_32x32x16_bf16 v[136:151], v[180:183], v[92:95], v[136:151]
    buffer_load_dwordx4 v[180:183], v1, s[12:15], s17 offen offset:3072
    s_add_u32 s17, s17, 4096
    ds_read_b128 v[92:95], v1 offset:13312
    s_waitcnt vmcnt(21)
    s_waitcnt lgkmcnt(7)
    v_mfma_f32_32x32x16_bf16 v[136:151], v[184:187], v[96:99], v[136:151]
    buffer_load_dwordx4 v[184:187], v1, s[12:15], s17 offen offset:0
    ds_read_b128 v[96:99], v1 offset:14336
    s_waitcnt vmcnt(21)
    s_waitcnt lgkmcnt(7)
    v_mfma_f32_32x32x16_bf16 v[136:151], v[188:191], v[100:103], v[136:151]
    buffer_load_dwordx4 v[188:191], v1, s[12:15], s17 offen offset:1024
    ds_read_b128 v[100:103], v1 offset:15360
    s_waitcnt vmcnt(21)
    s_waitcnt lgkmcnt(7)
    v_mfma_f32_32x32x16_bf16 v[136:151], v[192:195], v[72:75], v[136:151]
    buffer_load_dwordx4 v[192:195], v1, s[12:15], s17 offen offset:2048
    ds_read_b128 v[72:75], v1 offset:16384
    s_waitcnt vmcnt(21)
    s_waitcnt lgkmcnt(7)
    v_mfma_f32_32x32x16_bf16 v[136:151], v[196:199], v[76:79], v[136:151]
    buffer_load_dwordx4 v[196:199], v1, s[12:15], s17 offen offset:3072
    s_add_u32 s17, s17, 4096
    ds_read_b128 v[76:79], v1 offset:17408
    s_waitcnt vmcnt(21)
    s_waitcnt lgkmcnt(7)
    v_mfma_f32_32x32x16_bf16 v[136:151], v[200:203], v[80:83], v[136:151]
    buffer_load_dwordx4 v[200:203], v1, s[12:15], s17 offen offset:0
    ds_read_b128 v[80:83], v1 offset:18432
    s_waitcnt vmcnt(21)
    s_waitcnt lgkmcnt(7)
    v_mfma_f32_32x32x16_bf16 v[136:151], v[204:207], v[84:87], v[136:151]
    buffer_load_dwordx4 v[204:207], v1, s[12:15], s17 offen offset:1024
    ds_read_b128 v[84:87], v1 offset:19456
    s_waitcnt vmcnt(21)
    s_waitcnt lgkmcnt(7)
    v_mfma_f32_32x32x16_bf16 v[136:151], v[208:211], v[88:91], v[136:151]
    buffer_load_dwordx4 v[208:211], v1, s[12:15], s17 offen offset:2048
    ds_read_b128 v[88:91], v1 offset:20480
    s_waitcnt vmcnt(21)
    s_waitcnt lgkmcnt(7)
    v_mfma_f32_32x32x16_bf16 v[136:151], v[212:215], v[92:95], v[136:151]
    buffer_load_dwordx4 v[212:215], v1, s[12:15], s17 offen offset:3072
    s_add_u32 s17, s17, 4096
    ds_read_b128 v[92:95], v1 offset:21504
    s_waitcnt vmcnt(21)
    s_waitcnt lgkmcnt(7)
    v_mfma_f32_32x32x16_bf16 v[136:151], v[216:219], v[96:99], v[136:151]
    buffer_load_dwordx4 v[216:219], v1, s[12:15], s17 offen offset:0
    ds_read_b128 v[96:99], v1 offset:22528
    s_waitcnt vmcnt(21)
    s_waitcnt lgkmcnt(7)
    v_mfma_f32_32x32x16_bf16 v[136:151], v[220:223], v[100:103], v[136:151]
    buffer_load_dwordx4 v[220:223], v1, s[12:15], s17 offen offset:1024
    ds_read_b128 v[100:103], v1 offset:23552
    s_waitcnt vmcnt(21)
    s_waitcnt lgkmcnt(7)
    v_mfma_f32_32x32x16_bf16 v[136:151], v[224:227], v[72:75], v[136:151]
    buffer_load_dwordx4 v[224:227], v1, s[12:15], s17 offen offset:2048
    ds_read_b128 v[72:75], v1 offset:24576
    s_waitcnt vmcnt(21)
    s_waitcnt lgkmcnt(7)
    v_mfma_f32_32x32x16_bf16 v[136:151], v[228:231], v[76:79], v[136:151]
    buffer_load_dwordx4 v[228:231], v1, s[12:15], s17 offen offset:3072
    s_add_u32 s17, s17, 4096
    ds_read_b128 v[76:79], v1 offset:25600
    s_waitcnt vmcnt(21)
    s_waitcnt lgkmcnt(7)
    v_mfma_f32_32x32x16_bf16 v[136:151], v[232:235], v[80:83], v[136:151]
    buffer_load_dwordx4 v[232:235], v1, s[12:15], s17 offen offset:0
    ds_read_b128 v[80:83], v1 offset:26624
    s_waitcnt vmcnt(21)
    s_waitcnt lgkmcnt(7)
    v_mfma_f32_32x32x16_bf16 v[136:151], v[236:239], v[84:87], v[136:151]
    buffer_load_dwordx4 v[236:239], v1, s[12:15], s17 offen offset:1024
    ds_read_b128 v[84:87], v1 offset:27648
    s_waitcnt vmcnt(21)
    s_waitcnt lgkmcnt(7)
    v_mfma_f32_32x32x16_bf16 v[136:151], v[240:243], v[88:91], v[136:151]
    buffer_load_dwordx4 v[240:243], v1, s[12:15], s17 offen offset:2048
    ds_read_b128 v[88:91], v1 offset:28672
    s_waitcnt vmcnt(21)
    s_waitcnt lgkmcnt(7)
    v_mfma_f32_32x32x16_bf16 v[136:151], v[244:247], v[92:95], v[136:151]
    buffer_load_dwordx4 v[244:247], v1, s[12:15], s17 offen offset:3072
    s_add_u32 s17, s17, 4096
    ds_read_b128 v[92:95], v1 offset:29696
    s_waitcnt vmcnt(21)
    s_waitcnt lgkmcnt(7)
    v_mfma_f32_32x32x16_bf16 v[136:151], v[248:251], v[96:99], v[136:151]
    buffer_load_dwordx4 v[248:251], v1, s[12:15], s17 offen offset:0
    ds_read_b128 v[96:99], v1 offset:30720
    s_waitcnt vmcnt(21)
    s_waitcnt lgkmcnt(7)
    v_mfma_f32_32x32x16_bf16 v[136:151], v[252:255], v[100:103], v[136:151]
    buffer_load_dwordx4 v[252:255], v1, s[12:15], s17 offen offset:1024
    ds_read_b128 v[100:103], v1 offset:31744
    s_waitcnt vmcnt(21)
    s_waitcnt lgkmcnt(7)
    v_mfma_f32_32x32x16_bf16 v[136:151], v[168:171], v[72:75], v[136:151]
    buffer_load_dwordx4 v[168:171], v1, s[12:15], s17 offen offset:2048
    ds_read_b128 v[72:75], v1 offset:32768
    s_waitcnt vmcnt(21)
    s_waitcnt lgkmcnt(7)
    v_mfma_f32_32x32x16_bf16 v[136:151], v[172:175], v[76:79], v[136:151]
    buffer_load_dwordx4 v[172:175], v1, s[12:15], s17 offen offset:3072
    s_add_u32 s17, s17, 4096
    ds_read_b128 v[76:79], v1 offset:33792
    s_waitcnt vmcnt(21)
    s_waitcnt lgkmcnt(7)
    v_mfma_f32_32x32x16_bf16 v[136:151], v[176:179], v[80:83], v[136:151]
    buffer_load_dwordx4 v[176:179], v1, s[12:15], s17 offen offset:0
    ds_read_b128 v[80:83], v1 offset:34816
    s_waitcnt vmcnt(21)
    s_waitcnt lgkmcnt(7)
    v_mfma_f32_32x32x16_bf16 v[136:151], v[180:183], v[84:87], v[136:151]
    buffer_load_dwordx4 v[180:183], v1, s[12:15], s17 offen offset:1024
    ds_read_b128 v[84:87], v1 offset:35840
    s_waitcnt vmcnt(21)
    s_waitcnt lgkmcnt(7)
    v_mfma_f32_32x32x16_bf16 v[136:151], v[184:187], v[88:91], v[136:151]
    buffer_load_dwordx4 v[184:187], v1, s[12:15], s17 offen offset:2048
    ds_read_b128 v[88:91], v1 offset:36864
    s_waitcnt vmcnt(21)
    s_waitcnt lgkmcnt(7)
    v_mfma_f32_32x32x16_bf16 v[136:151], v[188:191], v[92:95], v[136:151]
    buffer_load_dwordx4 v[188:191], v1, s[12:15], s17 offen offset:3072
    s_add_u32 s17, s17, 4096
    ds_read_b128 v[92:95], v1 offset:37888
    s_waitcnt vmcnt(21)
    s_waitcnt lgkmcnt(7)
    v_mfma_f32_32x32x16_bf16 v[136:151], v[192:195], v[96:99], v[136:151]
    buffer_load_dwordx4 v[192:195], v1, s[12:15], s17 offen offset:0
    ds_read_b128 v[96:99], v1 offset:38912
    s_waitcnt vmcnt(21)
    s_waitcnt lgkmcnt(7)
    v_mfma_f32_32x32x16_bf16 v[136:151], v[196:199], v[100:103], v[136:151]
    buffer_load_dwordx4 v[196:199], v1, s[12:15], s17 offen offset:1024
    ds_read_b128 v[100:103], v1 offset:39936
    s_waitcnt vmcnt(21)
    s_waitcnt lgkmcnt(7)
    v_mfma_f32_32x32x16_bf16 v[136:151], v[200:203], v[72:75], v[136:151]
    buffer_load_dwordx4 v[200:203], v1, s[12:15], s17 offen offset:2048
    ds_read_b128 v[72:75], v1 offset:40960
    s_waitcnt vmcnt(21)
    s_waitcnt lgkmcnt(7)
    v_mfma_f32_32x32x16_bf16 v[136:151], v[204:207], v[76:79], v[136:151]
    buffer_load_dwordx4 v[204:207], v1, s[12:15], s17 offen offset:3072
    s_add_u32 s17, s17, 4096
    ds_read_b128 v[76:79], v1 offset:41984
    s_waitcnt vmcnt(21)
    s_waitcnt lgkmcnt(7)
    v_mfma_f32_32x32x16_bf16 v[136:151], v[208:211], v[80:83], v[136:151]
    buffer_load_dwordx4 v[208:211], v1, s[12:15], s17 offen offset:0
    ds_read_b128 v[80:83], v1 offset:43008
    s_waitcnt vmcnt(21)
    s_waitcnt lgkmcnt(7)
    v_mfma_f32_32x32x16_bf16 v[136:151], v[212:215], v[84:87], v[136:151]
    buffer_load_dwordx4 v[212:215], v1, s[12:15], s17 offen offset:1024
    ds_read_b128 v[84:87], v1 offset:44032
    s_waitcnt vmcnt(21)
    s_waitcnt lgkmcnt(7)
    v_mfma_f32_32x32x16_bf16 v[136:151], v[216:219], v[88:91], v[136:151]
    buffer_load_dwordx4 v[216:219], v1, s[12:15], s17 offen offset:2048
    ds_read_b128 v[88:91], v1 offset:45056
    s_waitcnt vmcnt(21)
    s_waitcnt lgkmcnt(7)
    v_mfma_f32_32x32x16_bf16 v[136:151], v[220:223], v[92:95], v[136:151]
    buffer_load_dwordx4 v[220:223], v1, s[12:15], s17 offen offset:3072
    s_add_u32 s17, s17, 4096
    ds_read_b128 v[92:95], v1 offset:46080
    s_waitcnt vmcnt(21)
    s_waitcnt lgkmcnt(7)
    v_mfma_f32_32x32x16_bf16 v[136:151], v[224:227], v[96:99], v[136:151]
    buffer_load_dwordx4 v[224:227], v1, s[12:15], s17 offen offset:0
    ds_read_b128 v[96:99], v1 offset:47104
    s_waitcnt vmcnt(21)
    s_waitcnt lgkmcnt(7)
    v_mfma_f32_32x32x16_bf16 v[136:151], v[228:231], v[100:103], v[136:151]
    buffer_load_dwordx4 v[228:231], v1, s[12:15], s17 offen offset:1024
    ds_read_b128 v[100:103], v1 offset:48128
    s_waitcnt vmcnt(21)
    s_waitcnt lgkmcnt(7)
    v_mfma_f32_32x32x16_bf16 v[136:151], v[232:235], v[72:75], v[136:151]
    buffer_load_dwordx4 v[232:235], v1, s[12:15], s17 offen offset:2048
    ds_read_b128 v[72:75], v1 offset:49152
    s_waitcnt vmcnt(21)
    s_waitcnt lgkmcnt(7)
    v_mfma_f32_32x32x16_bf16 v[136:151], v[236:239], v[76:79], v[136:151]
    buffer_load_dwordx4 v[236:239], v1, s[12:15], s17 offen offset:3072
    s_add_u32 s17, s17, 4096
    ds_read_b128 v[76:79], v1 offset:50176
    s_waitcnt vmcnt(21)
    s_waitcnt lgkmcnt(7)
    v_mfma_f32_32x32x16_bf16 v[136:151], v[240:243], v[80:83], v[136:151]
    buffer_load_dwordx4 v[240:243], v1, s[12:15], s17 offen offset:0
    ds_read_b128 v[80:83], v1 offset:51200
    s_waitcnt vmcnt(21)
    s_waitcnt lgkmcnt(7)
    v_mfma_f32_32x32x16_bf16 v[136:151], v[244:247], v[84:87], v[136:151]
    buffer_load_dwordx4 v[244:247], v1, s[12:15], s17 offen offset:1024
    ds_read_b128 v[84:87], v1 offset:52224
    s_waitcnt vmcnt(21)
    s_waitcnt lgkmcnt(7)
    v_mfma_f32_32x32x16_bf16 v[136:151], v[248:251], v[88:91], v[136:151]
    buffer_load_dwordx4 v[248:251], v1, s[12:15], s17 offen offset:2048
    ds_read_b128 v[88:91], v1 offset:53248
    s_waitcnt vmcnt(21)
    s_waitcnt lgkmcnt(7)
    v_mfma_f32_32x32x16_bf16 v[136:151], v[252:255], v[92:95], v[136:151]
    buffer_load_dwordx4 v[252:255], v1, s[12:15], s17 offen offset:3072
    s_add_u32 s17, s17, 4096
    ds_read_b128 v[92:95], v1 offset:54272
    s_waitcnt vmcnt(21)
    s_waitcnt lgkmcnt(7)
    v_mfma_f32_32x32x16_bf16 v[136:151], v[168:171], v[96:99], v[136:151]
    buffer_load_dwordx4 v[168:171], v1, s[12:15], s17 offen offset:0
    ds_read_b128 v[96:99], v1 offset:55296
    s_waitcnt vmcnt(21)
    s_waitcnt lgkmcnt(7)
    v_mfma_f32_32x32x16_bf16 v[136:151], v[172:175], v[100:103], v[136:151]
    buffer_load_dwordx4 v[172:175], v1, s[12:15], s17 offen offset:1024
    ds_read_b128 v[100:103], v1 offset:56320
    s_waitcnt vmcnt(21)
    s_waitcnt lgkmcnt(7)
    v_mfma_f32_32x32x16_bf16 v[136:151], v[176:179], v[72:75], v[136:151]
    buffer_load_dwordx4 v[176:179], v1, s[12:15], s17 offen offset:2048
    ds_read_b128 v[72:75], v1 offset:57344
    s_waitcnt vmcnt(21)
    s_waitcnt lgkmcnt(7)
    v_mfma_f32_32x32x16_bf16 v[136:151], v[180:183], v[76:79], v[136:151]
    buffer_load_dwordx4 v[180:183], v1, s[12:15], s17 offen offset:3072
    s_add_u32 s17, s17, 4096
    ds_read_b128 v[76:79], v1 offset:58368
    s_waitcnt vmcnt(21)
    s_waitcnt lgkmcnt(7)
    v_mfma_f32_32x32x16_bf16 v[136:151], v[184:187], v[80:83], v[136:151]
    buffer_load_dwordx4 v[184:187], v1, s[12:15], s17 offen offset:0
    ds_read_b128 v[80:83], v1 offset:59392
    s_waitcnt vmcnt(21)
    s_waitcnt lgkmcnt(7)
    v_mfma_f32_32x32x16_bf16 v[136:151], v[188:191], v[84:87], v[136:151]
    buffer_load_dwordx4 v[188:191], v1, s[12:15], s17 offen offset:1024
    ds_read_b128 v[84:87], v1 offset:60416
    s_waitcnt vmcnt(21)
    s_waitcnt lgkmcnt(7)
    v_mfma_f32_32x32x16_bf16 v[136:151], v[192:195], v[88:91], v[136:151]
    buffer_load_dwordx4 v[192:195], v1, s[12:15], s17 offen offset:2048
    ds_read_b128 v[88:91], v1 offset:61440
    s_waitcnt vmcnt(21)
    s_waitcnt lgkmcnt(7)
    v_mfma_f32_32x32x16_bf16 v[136:151], v[196:199], v[92:95], v[136:151]
    buffer_load_dwordx4 v[196:199], v1, s[12:15], s17 offen offset:3072
    s_add_u32 s17, s17, 4096
    ds_read_b128 v[92:95], v1 offset:62464
    s_waitcnt vmcnt(21)
    s_waitcnt lgkmcnt(7)
    v_mfma_f32_32x32x16_bf16 v[136:151], v[200:203], v[96:99], v[136:151]
    buffer_load_dwordx4 v[200:203], v1, s[12:15], s17 offen offset:0
    ds_read_b128 v[96:99], v1 offset:63488
    s_waitcnt vmcnt(21)
    s_waitcnt lgkmcnt(7)
    v_mfma_f32_32x32x16_bf16 v[136:151], v[204:207], v[100:103], v[136:151]
    buffer_load_dwordx4 v[204:207], v1, s[12:15], s17 offen offset:1024
    ds_read_b128 v[100:103], v1 offset:64512
    s_waitcnt vmcnt(21)
    s_waitcnt lgkmcnt(7)
    v_mfma_f32_32x32x16_bf16 v[136:151], v[208:211], v[72:75], v[136:151]
    buffer_load_dwordx4 v[208:211], v1, s[12:15], s17 offen offset:2048
    s_waitcnt vmcnt(21)
    s_waitcnt lgkmcnt(6)
    v_mfma_f32_32x32x16_bf16 v[136:151], v[212:215], v[76:79], v[136:151]
    buffer_load_dwordx4 v[212:215], v1, s[12:15], s17 offen offset:3072
    s_add_u32 s17, s17, 4096
    s_waitcnt vmcnt(21)
    s_waitcnt lgkmcnt(5)
    v_mfma_f32_32x32x16_bf16 v[136:151], v[216:219], v[80:83], v[136:151]
    buffer_load_dwordx4 v[216:219], v1, s[12:15], s17 offen offset:0
    s_waitcnt vmcnt(21)
    s_waitcnt lgkmcnt(4)
    v_mfma_f32_32x32x16_bf16 v[136:151], v[220:223], v[84:87], v[136:151]
    buffer_load_dwordx4 v[220:223], v1, s[12:15], s17 offen offset:1024
    s_waitcnt vmcnt(21)
    s_waitcnt lgkmcnt(3)
    v_mfma_f32_32x32x16_bf16 v[136:151], v[224:227], v[88:91], v[136:151]
    buffer_load_dwordx4 v[224:227], v1, s[12:15], s17 offen offset:2048
    s_waitcnt vmcnt(21)
    s_waitcnt lgkmcnt(2)
    v_mfma_f32_32x32x16_bf16 v[136:151], v[228:231], v[92:95], v[136:151]
    buffer_load_dwordx4 v[228:231], v1, s[12:15], s17 offen offset:3072
    s_add_u32 s17, s17, 4096
    s_waitcnt vmcnt(21)
    s_waitcnt lgkmcnt(1)
    v_mfma_f32_32x32x16_bf16 v[136:151], v[232:235], v[96:99], v[136:151]
    buffer_load_dwordx4 v[232:235], v1, s[12:15], s17 offen offset:0
    s_waitcnt vmcnt(21)
    s_waitcnt lgkmcnt(0)
    v_mfma_f32_32x32x16_bf16 v[136:151], v[236:239], v[100:103], v[136:151]
    buffer_load_dwordx4 v[236:239], v1, s[12:15], s17 offen offset:1024
    s_nop 10
    v_cvt_pk_bf16_f32 v6, v136, v137
    v_lshlrev_b32 v136, 16, v6
    v_and_b32 v137, 0xffff0000, v6
    v_cvt_pk_bf16_f32 v6, v138, v139
    v_lshlrev_b32 v138, 16, v6
    v_and_b32 v139, 0xffff0000, v6
    v_cvt_pk_bf16_f32 v6, v140, v141
    v_lshlrev_b32 v140, 16, v6
    v_and_b32 v141, 0xffff0000, v6
    v_cvt_pk_bf16_f32 v6, v142, v143
    v_lshlrev_b32 v142, 16, v6
    v_and_b32 v143, 0xffff0000, v6
    v_cvt_pk_bf16_f32 v6, v144, v145
    v_lshlrev_b32 v144, 16, v6
    v_and_b32 v145, 0xffff0000, v6
    v_cvt_pk_bf16_f32 v6, v146, v147
    v_lshlrev_b32 v146, 16, v6
    v_and_b32 v147, 0xffff0000, v6
    v_cvt_pk_bf16_f32 v6, v148, v149
    v_lshlrev_b32 v148, 16, v6
    v_and_b32 v149, 0xffff0000, v6
    v_cvt_pk_bf16_f32 v6, v150, v151
    v_lshlrev_b32 v150, 16, v6
    v_and_b32 v151, 0xffff0000, v6
    v_lshlrev_b32 v24, 16, v16
    v_and_b32 v25, 0xffff0000, v16
    v_lshlrev_b32 v26, 16, v17
    v_and_b32 v27, 0xffff0000, v17
    v_lshlrev_b32 v28, 16, v18
    v_and_b32 v29, 0xffff0000, v18
    v_lshlrev_b32 v30, 16, v19
    v_and_b32 v31, 0xffff0000, v19
    v_lshlrev_b32 v32, 16, v20
    v_and_b32 v33, 0xffff0000, v20
    v_lshlrev_b32 v34, 16, v21
    v_and_b32 v35, 0xffff0000, v21
    v_lshlrev_b32 v36, 16, v22
    v_and_b32 v37, 0xffff0000, v22
    v_lshlrev_b32 v38, 16, v23
    v_and_b32 v39, 0xffff0000, v23
    v_fmac_f32 v24, 0.5, v136
    v_fmac_f32 v25, 0.5, v137
    v_fmac_f32 v26, 0.5, v138
    v_fmac_f32 v27, 0.5, v139
    v_fmac_f32 v28, 0.5, v140
    v_fmac_f32 v29, 0.5, v141
    v_fmac_f32 v30, 0.5, v142
    v_fmac_f32 v31, 0.5, v143
    v_fmac_f32 v32, 0.5, v144
    v_fmac_f32 v33, 0.5, v145
    v_fmac_f32 v34, 0.5, v146
    v_fmac_f32 v35, 0.5, v147
    v_fmac_f32 v36, 0.5, v148
    v_fmac_f32 v37, 0.5, v149
    v_fmac_f32 v38, 0.5, v150
    v_fmac_f32 v39, 0.5, v151
    v_cvt_pk_bf16_f32 v16, v24, v25
    v_cvt_pk_bf16_f32 v17, v26, v27
    v_cvt_pk_bf16_f32 v18, v28, v29
    v_cvt_pk_bf16_f32 v19, v30, v31
    v_cvt_pk_bf16_f32 v20, v32, v33
    v_cvt_pk_bf16_f32 v21, v34, v35
    v_cvt_pk_bf16_f32 v22, v36, v37
    v_cvt_pk_bf16_f32 v23, v38, v39
    v_lshlrev_b32 v24, 16, v16
    v_and_b32 v25, 0xffff0000, v16
    v_lshlrev_b32 v26, 16, v17
    v_and_b32 v27, 0xffff0000, v17
    v_lshlrev_b32 v28, 16, v18
    v_and_b32 v29, 0xffff0000, v18
    v_lshlrev_b32 v30, 16, v19
    v_and_b32 v31, 0xffff0000, v19
    v_lshlrev_b32 v32, 16, v20
    v_and_b32 v33, 0xffff0000, v20
    v_lshlrev_b32 v34, 16, v21
    v_and_b32 v35, 0xffff0000, v21
    v_lshlrev_b32 v36, 16, v22
    v_and_b32 v37, 0xffff0000, v22
    v_lshlrev_b32 v38, 16, v23
    v_and_b32 v39, 0xffff0000, v23
    s_lshl_b32 s20, s2, 14
    s_lshl_b32 s21, s16, 11
    s_add_u32 s20, s20, s21
    s_add_u32 s20, s20, 4194304
    buffer_store_dwordx4 v[16:19], v1, s[12:15], s20 offen
    buffer_store_dwordx4 v[20:23], v1, s[12:15], s20 offen offset:1024
    v_pk_add_f32 v[6:7], v[24:25], v[26:27]
    v_pk_add_f32 v[8:9], v[28:29], v[30:31]
    v_pk_add_f32 v[10:11], v[32:33], v[34:35]
    v_pk_add_f32 v[12:13], v[36:37], v[38:39]
    v_pk_add_f32 v[6:7], v[6:7], v[8:9]
    v_pk_add_f32 v[10:11], v[10:11], v[12:13]
    v_pk_add_f32 v[6:7], v[6:7], v[10:11]
    v_add_f32 v6, v6, v7
    v_mul_f32 v6, 0x3d800000, v6
    v_pk_add_f32 v[10:11], v[24:25], v[6:7] op_sel_hi:[1,0] neg_lo:[0,1] neg_hi:[0,1]
    v_pk_mul_f32 v[8:9], v[10:11], v[10:11]
    v_pk_add_f32 v[12:13], v[26:27], v[6:7] op_sel_hi:[1,0] neg_lo:[0,1] neg_hi:[0,1]
    v_pk_fma_f32 v[8:9], v[12:13], v[12:13], v[8:9]
    v_pk_add_f32 v[10:11], v[28:29], v[6:7] op_sel_hi:[1,0] neg_lo:[0,1] neg_hi:[0,1]
    v_pk_fma_f32 v[8:9], v[10:11], v[10:11], v[8:9]
    v_pk_add_f32 v[12:13], v[30:31], v[6:7] op_sel_hi:[1,0] neg_lo:[0,1] neg_hi:[0,1]
    v_pk_fma_f32 v[8:9], v[12:13], v[12:13], v[8:9]
    v_pk_add_f32 v[10:11], v[32:33], v[6:7] op_sel_hi:[1,0] neg_lo:[0,1] neg_hi:[0,1]
    v_pk_fma_f32 v[8:9], v[10:11], v[10:11], v[8:9]
    v_pk_add_f32 v[12:13], v[34:35], v[6:7] op_sel_hi:[1,0] neg_lo:[0,1] neg_hi:[0,1]
    v_pk_fma_f32 v[8:9], v[12:13], v[12:13], v[8:9]
    v_pk_add_f32 v[10:11], v[36:37], v[6:7] op_sel_hi:[1,0] neg_lo:[0,1] neg_hi:[0,1]
    v_pk_fma_f32 v[8:9], v[10:11], v[10:11], v[8:9]
    v_pk_add_f32 v[12:13], v[38:39], v[6:7] op_sel_hi:[1,0] neg_lo:[0,1] neg_hi:[0,1]
    v_pk_fma_f32 v[8:9], v[12:13], v[12:13], v[8:9]
    v_add_f32 v8, v8, v9
    ds_write_b32 v2, v6 offset:0
    ds_write_b32 v2, v8 offset:2560
    s_waitcnt lgkmcnt(0)
    s_barrier
    ds_read_b128 v[40:43], v3 offset:0
    ds_read_b128 v[44:47], v3 offset:16
    ds_read_b128 v[48:51], v3 offset:32
    ds_read_b128 v[52:55], v3 offset:48
    ds_read_b128 v[56:59], v3 offset:2560
    ds_read_b128 v[60:63], v3 offset:2576
    ds_read_b128 v[64:67], v3 offset:2592
    ds_read_b128 v[68:71], v3 offset:2608
    s_waitcnt lgkmcnt(4)
    v_pk_add_f32 v[6:7], v[40:41], v[42:43]
    v_pk_add_f32 v[8:9], v[44:45], v[46:47]
    v_pk_add_f32 v[10:11], v[48:49], v[50:51]
    v_pk_add_f32 v[12:13], v[52:53], v[54:55]
    v_pk_add_f32 v[6:7], v[6:7], v[8:9]
    v_pk_add_f32 v[10:11], v[10:11], v[12:13]
    v_pk_add_f32 v[6:7], v[6:7], v[10:11]
    v_add_f32 v6, v6, v7
    v_mul_f32 v6, 0x3d800000, v6
    v_pk_add_f32 v[10:11], v[40:41], v[6:7] op_sel_hi:[1,0] neg_lo:[0,1] neg_hi:[0,1]
    v_pk_mul_f32 v[8:9], v[10:11], v[10:11]
    v_pk_add_f32 v[12:13], v[42:43], v[6:7] op_sel_hi:[1,0] neg_lo:[0,1] neg_hi:[0,1]
    v_pk_fma_f32 v[8:9], v[12:13], v[12:13], v[8:9]
    v_pk_add_f32 v[10:11], v[44:45], v[6:7] op_sel_hi:[1,0] neg_lo:[0,1] neg_hi:[0,1]
    v_pk_fma_f32 v[8:9], v[10:11], v[10:11], v[8:9]
    v_pk_add_f32 v[12:13], v[46:47], v[6:7] op_sel_hi:[1,0] neg_lo:[0,1] neg_hi:[0,1]
    v_pk_fma_f32 v[8:9], v[12:13], v[12:13], v[8:9]
    v_pk_add_f32 v[10:11], v[48:49], v[6:7] op_sel_hi:[1,0] neg_lo:[0,1] neg_hi:[0,1]
    v_pk_fma_f32 v[8:9], v[10:11], v[10:11], v[8:9]
    v_pk_add_f32 v[12:13], v[50:51], v[6:7] op_sel_hi:[1,0] neg_lo:[0,1] neg_hi:[0,1]
    v_pk_fma_f32 v[8:9], v[12:13], v[12:13], v[8:9]
    v_pk_add_f32 v[10:11], v[52:53], v[6:7] op_sel_hi:[1,0] neg_lo:[0,1] neg_hi:[0,1]
    v_pk_fma_f32 v[8:9], v[10:11], v[10:11], v[8:9]
    v_pk_add_f32 v[12:13], v[54:55], v[6:7] op_sel_hi:[1,0] neg_lo:[0,1] neg_hi:[0,1]
    v_pk_fma_f32 v[8:9], v[12:13], v[12:13], v[8:9]
    v_add_f32 v8, v8, v9
    s_waitcnt lgkmcnt(0)
    v_pk_add_f32 v[40:41], v[56:57], v[58:59]
    v_pk_add_f32 v[42:43], v[60:61], v[62:63]
    v_pk_add_f32 v[44:45], v[64:65], v[66:67]
    v_pk_add_f32 v[46:47], v[68:69], v[70:71]
    v_pk_add_f32 v[40:41], v[40:41], v[42:43]
    v_pk_add_f32 v[44:45], v[44:45], v[46:47]
    v_pk_add_f32 v[40:41], v[40:41], v[44:45]
    v_add_f32 v40, v40, v41
    v_fmac_f32 v40, 0x41800000, v8
    v_mul_f32 v8, 0x3b800000, v40
    v_cvt_pk_bf16_f32 v10, v6, v8
    v_lshlrev_b32 v6, 16, v10
    v_and_b32 v8, 0xffff0000, v10
    v_add_f32 v8, 0x3727c5ac, v8
    v_cvt_pk_bf16_f32 v10, v8, v8
    v_lshlrev_b32 v8, 16, v10
    v_sqrt_f32 v8, v8
    v_pk_add_f32 v[40:41], v[24:25], v[6:7] op_sel_hi:[1,0] neg_lo:[0,1] neg_hi:[0,1]
    v_pk_add_f32 v[42:43], v[26:27], v[6:7] op_sel_hi:[1,0] neg_lo:[0,1] neg_hi:[0,1]
    v_pk_add_f32 v[44:45], v[28:29], v[6:7] op_sel_hi:[1,0] neg_lo:[0,1] neg_hi:[0,1]
    v_pk_add_f32 v[46:47], v[30:31], v[6:7] op_sel_hi:[1,0] neg_lo:[0,1] neg_hi:[0,1]
    v_pk_add_f32 v[48:49], v[32:33], v[6:7] op_sel_hi:[1,0] neg_lo:[0,1] neg_hi:[0,1]
    v_pk_add_f32 v[50:51], v[34:35], v[6:7] op_sel_hi:[1,0] neg_lo:[0,1] neg_hi:[0,1]
    v_pk_add_f32 v[52:53], v[36:37], v[6:7] op_sel_hi:[1,0] neg_lo:[0,1] neg_hi:[0,1]
    v_pk_add_f32 v[54:55], v[38:39], v[6:7] op_sel_hi:[1,0] neg_lo:[0,1] neg_hi:[0,1]
    v_cvt_pk_bf16_f32 v10, v8, v8
    v_lshlrev_b32 v8, 16, v10
    v_rcp_f32 v8, v8
    v_cvt_pk_bf16_f32 v10, v40, v41
    v_lshlrev_b32 v40, 16, v10
    v_and_b32 v41, 0xffff0000, v10
    v_cvt_pk_bf16_f32 v10, v42, v43
    v_lshlrev_b32 v42, 16, v10
    v_and_b32 v43, 0xffff0000, v10
    v_cvt_pk_bf16_f32 v10, v44, v45
    v_lshlrev_b32 v44, 16, v10
    v_and_b32 v45, 0xffff0000, v10
    v_cvt_pk_bf16_f32 v10, v46, v47
    v_lshlrev_b32 v46, 16, v10
    v_and_b32 v47, 0xffff0000, v10
    v_cvt_pk_bf16_f32 v10, v48, v49
    v_lshlrev_b32 v48, 16, v10
    v_and_b32 v49, 0xffff0000, v10
    v_cvt_pk_bf16_f32 v10, v50, v51
    v_lshlrev_b32 v50, 16, v10
    v_and_b32 v51, 0xffff0000, v10
    v_cvt_pk_bf16_f32 v10, v52, v53
    v_lshlrev_b32 v52, 16, v10
    v_and_b32 v53, 0xffff0000, v10
    v_cvt_pk_bf16_f32 v10, v54, v55
    v_lshlrev_b32 v54, 16, v10
    v_and_b32 v55, 0xffff0000, v10
    v_pk_mul_f32 v[40:41], v[40:41], v[8:9] op_sel_hi:[1,0]
    v_pk_mul_f32 v[42:43], v[42:43], v[8:9] op_sel_hi:[1,0]
    v_pk_mul_f32 v[44:45], v[44:45], v[8:9] op_sel_hi:[1,0]
    v_pk_mul_f32 v[46:47], v[46:47], v[8:9] op_sel_hi:[1,0]
    v_pk_mul_f32 v[48:49], v[48:49], v[8:9] op_sel_hi:[1,0]
    v_pk_mul_f32 v[50:51], v[50:51], v[8:9] op_sel_hi:[1,0]
    v_pk_mul_f32 v[52:53], v[52:53], v[8:9] op_sel_hi:[1,0]
    v_pk_mul_f32 v[54:55], v[54:55], v[8:9] op_sel_hi:[1,0]
    v_cvt_pk_bf16_f32 v56, v40, v41
    v_cvt_pk_bf16_f32 v57, v42, v43
    v_cvt_pk_bf16_f32 v58, v44, v45
    v_cvt_pk_bf16_f32 v59, v46, v47
    v_cvt_pk_bf16_f32 v60, v48, v49
    v_cvt_pk_bf16_f32 v61, v50, v51
    v_cvt_pk_bf16_f32 v62, v52, v53
    v_cvt_pk_bf16_f32 v63, v54, v55
    ds_write_b128 v4, v[56:59] offset:0
    ds_write_b128 v4, v[60:63] offset:1024
    s_waitcnt lgkmcnt(0)
    s_barrier
    ds_read_b128 v[72:75], v5 offset:0
    ds_read_b128 v[76:79], v5 offset:1024
    ds_read_b128 v[80:83], v5 offset:2048
    ds_read_b128 v[84:87], v5 offset:3072
    ds_read_b128 v[88:91], v5 offset:4096
    ds_read_b128 v[92:95], v5 offset:5120
    ds_read_b128 v[96:99], v5 offset:6144
    ds_read_b128 v[100:103], v5 offset:7168
    ds_read_b128 v[104:107], v5 offset:8192
    ds_read_b128 v[108:111], v5 offset:9216
    ds_read_b128 v[112:115], v5 offset:10240
    ds_read_b128 v[116:119], v5 offset:11264
    ds_read_b128 v[120:123], v5 offset:12288
    ds_read_b128 v[124:127], v5 offset:13312
    ds_read_b128 v[128:131], v5 offset:14336
    ds_read_b128 v[132:135], v5 offset:15360
    s_waitcnt lgkmcnt(0)
    s_cmp_ge_u32 s2, 125
    s_cselect_b32 s22, 1, 0
    s_mul_i32 s23, s22, 125
    s_sub_u32 s23, s2, s23
    s_lshl_b32 s22, s22, 2
    s_lshr_b32 s24, s16, 1
    s_add_u32 s22, s22, s24
    s_and_b32 s25, s16, 1
    s_lshl_b32 s25, s25, 11
    s_lshl_b32 s26, s22, 19
    s_lshl_b32 s27, s23, 12
    s_add_u32 s26, s26, s27
    s_add_u32 s26, s26, s25
    s_add_u32 s26, s26, 8388608
    s_lshl_b32 s27, s22, 20
    s_lshl_b32 s28, s23, 13
    s_add_u32 s27, s27, s28
    s_add_u32 s27, s27, s25
    s_add_u32 s27, s27, 16777216
    s_add_u32 s28, s27, 4096
    s_waitcnt vmcnt(23)
    v_mfma_f32_32x32x16_bf16 v[136:151], v[240:243], v[72:75], 0
    buffer_load_dwordx4 v[240:243], v1, s[12:15], s17 offen offset:2048
    s_waitcnt vmcnt(23)
    v_mfma_f32_32x32x16_bf16 v[136:151], v[244:247], v[76:79], v[136:151]
    buffer_load_dwordx4 v[244:247], v1, s[12:15], s17 offen offset:3072
    s_add_u32 s17, s17, 4096
    s_waitcnt vmcnt(23)
    v_mfma_f32_32x32x16_bf16 v[136:151], v[248:251], v[80:83], v[136:151]
    buffer_load_dwordx4 v[248:251], v1, s[12:15], s17 offen offset:0
    s_waitcnt vmcnt(23)
    v_mfma_f32_32x32x16_bf16 v[136:151], v[252:255], v[84:87], v[136:151]
    buffer_load_dwordx4 v[252:255], v1, s[12:15], s17 offen offset:1024
    s_waitcnt vmcnt(23)
    v_mfma_f32_32x32x16_bf16 v[136:151], v[168:171], v[88:91], v[136:151]
    buffer_load_dwordx4 v[168:171], v1, s[12:15], s17 offen offset:2048
    s_waitcnt vmcnt(23)
    v_mfma_f32_32x32x16_bf16 v[136:151], v[172:175], v[92:95], v[136:151]
    buffer_load_dwordx4 v[172:175], v1, s[12:15], s17 offen offset:3072
    s_add_u32 s17, s17, 4096
    s_waitcnt vmcnt(23)
    v_mfma_f32_32x32x16_bf16 v[136:151], v[176:179], v[96:99], v[136:151]
    buffer_load_dwordx4 v[176:179], v1, s[12:15], s17 offen offset:0
    s_waitcnt vmcnt(23)
    v_mfma_f32_32x32x16_bf16 v[136:151], v[180:183], v[100:103], v[136:151]
    buffer_load_dwordx4 v[180:183], v1, s[12:15], s17 offen offset:1024
    s_waitcnt vmcnt(23)
    v_mfma_f32_32x32x16_bf16 v[136:151], v[184:187], v[104:107], v[136:151]
    buffer_load_dwordx4 v[184:187], v1, s[12:15], s17 offen offset:2048
    s_waitcnt vmcnt(23)
    v_mfma_f32_32x32x16_bf16 v[136:151], v[188:191], v[108:111], v[136:151]
    buffer_load_dwordx4 v[188:191], v1, s[12:15], s17 offen offset:3072
    s_add_u32 s17, s17, 4096
    s_waitcnt vmcnt(23)
    v_mfma_f32_32x32x16_bf16 v[136:151], v[192:195], v[112:115], v[136:151]
    buffer_load_dwordx4 v[192:195], v1, s[12:15], s17 offen offset:0
    s_waitcnt vmcnt(23)
    v_mfma_f32_32x32x16_bf16 v[136:151], v[196:199], v[116:119], v[136:151]
    buffer_load_dwordx4 v[196:199], v1, s[12:15], s17 offen offset:1024
    s_waitcnt vmcnt(23)
    v_mfma_f32_32x32x16_bf16 v[136:151], v[200:203], v[120:123], v[136:151]
    buffer_load_dwordx4 v[200:203], v1, s[12:15], s17 offen offset:2048
    s_waitcnt vmcnt(23)
    v_mfma_f32_32x32x16_bf16 v[136:151], v[204:207], v[124:127], v[136:151]
    buffer_load_dwordx4 v[204:207], v1, s[12:15], s17 offen offset:3072
    s_add_u32 s17, s17, 4096
    s_waitcnt vmcnt(23)
    v_mfma_f32_32x32x16_bf16 v[136:151], v[208:211], v[128:131], v[136:151]
    buffer_load_dwordx4 v[208:211], v1, s[12:15], s17 offen offset:0
    s_waitcnt vmcnt(23)
    v_mfma_f32_32x32x16_bf16 v[136:151], v[212:215], v[132:135], v[136:151]
    buffer_load_dwordx4 v[212:215], v1, s[12:15], s17 offen offset:1024
    s_nop 10
    v_mul_f32 v136, 0x3e38aa3b, v136
    v_mul_f32 v137, 0x3e38aa3b, v137
    v_mul_f32 v138, 0x3e38aa3b, v138
    v_mul_f32 v139, 0x3e38aa3b, v139
    v_mul_f32 v140, 0x3e38aa3b, v140
    v_mul_f32 v141, 0x3e38aa3b, v141
    v_mul_f32 v142, 0x3e38aa3b, v142
    v_mul_f32 v143, 0x3e38aa3b, v143
    v_mul_f32 v144, 0x3e38aa3b, v144
    v_mul_f32 v145, 0x3e38aa3b, v145
    v_mul_f32 v146, 0x3e38aa3b, v146
    v_mul_f32 v147, 0x3e38aa3b, v147
    v_mul_f32 v148, 0x3e38aa3b, v148
    v_mul_f32 v149, 0x3e38aa3b, v149
    v_mul_f32 v150, 0x3e38aa3b, v150
    v_mul_f32 v151, 0x3e38aa3b, v151
    v_cvt_pk_bf16_f32 v40, v136, v137
    v_cvt_pk_bf16_f32 v41, v138, v139
    v_cvt_pk_bf16_f32 v42, v140, v141
    v_cvt_pk_bf16_f32 v43, v142, v143
    v_cvt_pk_bf16_f32 v44, v144, v145
    v_cvt_pk_bf16_f32 v45, v146, v147
    v_cvt_pk_bf16_f32 v46, v148, v149
    v_cvt_pk_bf16_f32 v47, v150, v151
    buffer_store_dwordx4 v[40:43], v1, s[12:15], s26 offen
    buffer_store_dwordx4 v[44:47], v1, s[12:15], s26 offen offset:1024
    s_waitcnt vmcnt(25)
    v_mfma_f32_32x32x16_bf16 v[152:167], v[216:219], v[72:75], 0
    buffer_load_dwordx4 v[216:219], v1, s[12:15], s17 offen offset:2048
    s_waitcnt vmcnt(25)
    v_mfma_f32_32x32x16_bf16 v[152:167], v[220:223], v[76:79], v[152:167]
    buffer_load_dwordx4 v[220:223], v1, s[12:15], s17 offen offset:3072
    s_add_u32 s17, s17, 4096
    s_waitcnt vmcnt(25)
    v_mfma_f32_32x32x16_bf16 v[152:167], v[224:227], v[80:83], v[152:167]
    buffer_load_dwordx4 v[224:227], v1, s[12:15], s17 offen offset:0
    s_waitcnt vmcnt(25)
    v_mfma_f32_32x32x16_bf16 v[152:167], v[228:231], v[84:87], v[152:167]
    buffer_load_dwordx4 v[228:231], v1, s[12:15], s17 offen offset:1024
    s_waitcnt vmcnt(25)
    v_mfma_f32_32x32x16_bf16 v[152:167], v[232:235], v[88:91], v[152:167]
    buffer_load_dwordx4 v[232:235], v1, s[12:15], s17 offen offset:2048
    s_waitcnt vmcnt(25)
    v_mfma_f32_32x32x16_bf16 v[152:167], v[236:239], v[92:95], v[152:167]
    buffer_load_dwordx4 v[236:239], v1, s[12:15], s17 offen offset:3072
    s_add_u32 s17, s17, 4096
    s_waitcnt vmcnt(23)
    v_mfma_f32_32x32x16_bf16 v[152:167], v[240:243], v[96:99], v[152:167]
    buffer_load_dwordx4 v[240:243], v1, s[12:15], s17 offen offset:0
    s_waitcnt vmcnt(23)
    v_mfma_f32_32x32x16_bf16 v[152:167], v[244:247], v[100:103], v[152:167]
    buffer_load_dwordx4 v[244:247], v1, s[12:15], s17 offen offset:1024
    s_waitcnt vmcnt(23)
    v_mfma_f32_32x32x16_bf16 v[152:167], v[248:251], v[104:107], v[152:167]
    buffer_load_dwordx4 v[248:251], v1, s[12:15], s17 offen offset:2048
    s_waitcnt vmcnt(23)
    v_mfma_f32_32x32x16_bf16 v[152:167], v[252:255], v[108:111], v[152:167]
    buffer_load_dwordx4 v[252:255], v1, s[12:15], s17 offen offset:3072
    s_add_u32 s17, s17, 4096
    s_waitcnt vmcnt(23)
    v_mfma_f32_32x32x16_bf16 v[152:167], v[168:171], v[112:115], v[152:167]
    s_waitcnt vmcnt(22)
    v_mfma_f32_32x32x16_bf16 v[152:167], v[172:175], v[116:119], v[152:167]
    s_waitcnt vmcnt(21)
    v_mfma_f32_32x32x16_bf16 v[152:167], v[176:179], v[120:123], v[152:167]
    s_waitcnt vmcnt(20)
    v_mfma_f32_32x32x16_bf16 v[152:167], v[180:183], v[124:127], v[152:167]
    s_waitcnt vmcnt(19)
    v_mfma_f32_32x32x16_bf16 v[152:167], v[184:187], v[128:131], v[152:167]
    s_waitcnt vmcnt(18)
    v_mfma_f32_32x32x16_bf16 v[152:167], v[188:191], v[132:135], v[152:167]
    s_nop 11
    v_cvt_pk_bf16_f32 v56, v152, v153
    v_cvt_pk_bf16_f32 v57, v154, v155
    v_cvt_pk_bf16_f32 v58, v156, v157
    v_cvt_pk_bf16_f32 v59, v158, v159
    v_cvt_pk_bf16_f32 v60, v160, v161
    v_cvt_pk_bf16_f32 v61, v162, v163
    v_cvt_pk_bf16_f32 v62, v164, v165
    v_cvt_pk_bf16_f32 v63, v166, v167
    buffer_store_dwordx4 v[56:59], v1, s[12:15], s27 offen
    buffer_store_dwordx4 v[60:63], v1, s[12:15], s27 offen offset:1024
    s_waitcnt vmcnt(19)
    v_mfma_f32_32x32x16_bf16 v[136:151], v[72:75], v[192:195], 0
    s_waitcnt vmcnt(18)
    v_mfma_f32_32x32x16_bf16 v[136:151], v[76:79], v[196:199], v[136:151]
    s_waitcnt vmcnt(17)
    v_mfma_f32_32x32x16_bf16 v[136:151], v[80:83], v[200:203], v[136:151]
    s_waitcnt vmcnt(16)
    v_mfma_f32_32x32x16_bf16 v[136:151], v[84:87], v[204:207], v[136:151]
    s_waitcnt vmcnt(15)
    v_mfma_f32_32x32x16_bf16 v[136:151], v[88:91], v[208:211], v[136:151]
    s_waitcnt vmcnt(14)
    v_mfma_f32_32x32x16_bf16 v[136:151], v[92:95], v[212:215], v[136:151]
    s_waitcnt vmcnt(11)
    v_mfma_f32_32x32x16_bf16 v[136:151], v[96:99], v[216:219], v[136:151]
    s_waitcnt vmcnt(10)
    v_mfma_f32_32x32x16_bf16 v[136:151], v[100:103], v[220:223], v[136:151]
    s_waitcnt vmcnt(9)
    v_mfma_f32_32x32x16_bf16 v[136:151], v[104:107], v[224:227], v[136:151]
    s_waitcnt vmcnt(8)
    v_mfma_f32_32x32x16_bf16 v[136:151], v[108:111], v[228:231], v[136:151]
    s_waitcnt vmcnt(7)
    v_mfma_f32_32x32x16_bf16 v[136:151], v[112:115], v[232:235], v[136:151]
    s_waitcnt vmcnt(6)
    v_mfma_f32_32x32x16_bf16 v[136:151], v[116:119], v[236:239], v[136:151]
    s_waitcnt vmcnt(5)
    v_mfma_f32_32x32x16_bf16 v[136:151], v[120:123], v[240:243], v[136:151]
    s_waitcnt vmcnt(4)
    v_mfma_f32_32x32x16_bf16 v[136:151], v[124:127], v[244:247], v[136:151]
    s_waitcnt vmcnt(3)
    v_mfma_f32_32x32x16_bf16 v[136:151], v[128:131], v[248:251], v[136:151]
    s_waitcnt vmcnt(2)
    v_mfma_f32_32x32x16_bf16 v[136:151], v[132:135], v[252:255], v[136:151]
    s_nop 11
    v_cvt_pk_bf16_f32 v40, v136, v137
    v_cvt_pk_bf16_f32 v41, v138, v139
    v_cvt_pk_bf16_f32 v42, v140, v141
    v_cvt_pk_bf16_f32 v43, v142, v143
    v_cvt_pk_bf16_f32 v44, v144, v145
    v_cvt_pk_bf16_f32 v45, v146, v147
    v_cvt_pk_bf16_f32 v46, v148, v149
    v_cvt_pk_bf16_f32 v47, v150, v151
    buffer_store_dwordx4 v[40:43], v1, s[12:15], s28 offen
    buffer_store_dwordx4 v[44:47], v1, s[12:15], s28 offen offset:1024
    s_nop 0
L_k1_end_ff1qkv_kernel:
    s_endpgm
.globl attn_kernel
.p2align 8
.type attn_kernel,@function
attn_kernel:
    s_cmp_ge_u32 s2, 256
    s_cbranch_scc1 L_k2_end_attn_kernel
    s_load_dwordx2 s[6:7], s[0:1], 96
    v_lshrrev_b32 v10, 6, v0
    v_and_b32 v11, 63, v0
    v_readfirstlane_b32 s16, v10
    v_lshlrev_b32 v1, 4, v11
    s_and_b32 s17, s16, 1
    s_lshr_b32 s18, s16, 1
    s_and_b32 s19, s2, 7
    s_lshr_b32 s20, s2, 3
    s_lshl_b32 s21, s20, 2
    s_lshl_b32 s22, s17, 1
    s_add_u32 s21, s21, s22
    s_add_u32 s22, s21, 1
    s_min_u32 s23, s21, 124
    s_min_u32 s24, s22, 124
    s_lshl_b32 s25, s19, 19
    s_add_u32 s25, s25, 8388608
    s_lshl_b32 s23, s23, 12
    s_lshl_b32 s24, s24, 12
    s_add_u32 s23, s23, s25
    s_add_u32 s24, s24, s25
    s_lshl_b32 s26, s19, 20
    s_lshl_b32 s27, s18, 18
    s_add_u32 s26, s26, s27
    s_lshl_b32 s27, s17, 12
    s_add_u32 s26, s26, s27
    s_add_u32 s26, s26, 16777216
    s_xor_b32 s27, s17, 1
    s_lshl_b32 s27, s27, 13
    s_add_u32 s28, s26, s27
    s_lshl_b32 s27, s18, 13
    s_lshl_b32 s29, s17, 12
    s_add_u32 s27, s27, s29
    s_add_u32 s32, s27, 0
    s_add_u32 s33, s27, 32768
    s_add_u32 s34, s27, 65536
    s_add_u32 s35, s27, 98304
    s_lshl_b32 s27, s18, 13
    v_add_u32 v2, s27, v1
    v_add_u32 v3, 0x10000, v2
    s_waitcnt lgkmcnt(0)
    s_mov_b32 s12, s6
    s_and_b32 s13, s7, 0xffff
    s_mov_b32 s14, 41943040
    s_mov_b32 s15, 0x20000
    buffer_load_dwordx4 v[16:19], v1, s[12:15], s23 offen offset:0
    buffer_load_dwordx4 v[20:23], v1, s[12:15], s23 offen offset:1024
    buffer_load_dwordx4 v[24:27], v1, s[12:15], s23 offen offset:2048
    buffer_load_dwordx4 v[28:31], v1, s[12:15], s23 offen offset:3072
    buffer_load_dwordx4 v[32:35], v1, s[12:15], s24 offen offset:0
    buffer_load_dwordx4 v[36:39], v1, s[12:15], s24 offen offset:1024
    buffer_load_dwordx4 v[40:43], v1, s[12:15], s24 offen offset:2048
    buffer_load_dwordx4 v[44:47], v1, s[12:15], s24 offen offset:3072
    s_mov_b32 m0, s35
    s_nop 0
    buffer_load_dwordx4 v1, s[12:15], s26 offen offset:0 lds
    buffer_load_dwordx4 v1, s[12:15], s26 offen offset:1024 lds
    buffer_load_dwordx4 v1, s[12:15], s26 offen offset:2048 lds
    buffer_load_dwordx4 v1, s[12:15], s26 offen offset:3072 lds
    s_mov_b32 m0, s32
    s_nop 0
    buffer_load_dwordx4 v1, s[12:15], s28 offen lds
    buffer_load_dwordx4 v1, s[12:15], s28 offen offset:1024 lds
    buffer_load_dwordx4 v1, s[12:15], s28 offen offset:2048 lds
    buffer_load_dwordx4 v1, s[12:15], s28 offen offset:3072 lds
    s_add_u32 s28, s28, 8192
    s_mov_b32 m0, s33
    s_nop 0
    buffer_load_dwordx4 v1, s[12:15], s28 offen lds
    buffer_load_dwordx4 v1, s[12:15], s28 offen offset:1024 lds
    buffer_load_dwordx4 v1, s[12:15], s28 offen offset:2048 lds
    buffer_load_dwordx4 v1, s[12:15], s28 offen offset:3072 lds
    s_add_u32 s28, s28, 8192
    s_mov_b32 m0, s34
    s_nop 0
    buffer_load_dwordx4 v1, s[12:15], s28 offen lds
    buffer_load_dwordx4 v1, s[12:15], s28 offen offset:1024 lds
    buffer_load_dwordx4 v1, s[12:15], s28 offen offset:2048 lds
    buffer_load_dwordx4 v1, s[12:15], s28 offen offset:3072 lds
    s_add_u32 s28, s28, 8192
    v_mov_b32 v4, 0
    v_mov_b32 v5, 0
    v_mov_b32 v8, 0
    v_mov_b32 v80, 0
    v_mov_b32 v81, 0
    v_mov_b32 v82, 0
    v_mov_b32 v83, 0
    v_mov_b32 v84, 0
    v_mov_b32 v85, 0
    v_mov_b32 v86, 0
    v_mov_b32 v87, 0
    v_mov_b32 v88, 0
    v_mov_b32 v89, 0
    v_mov_b32 v90, 0
    v_mov_b32 v91, 0
    v_mov_b32 v92, 0
    v_mov_b32 v93, 0
    v_mov_b32 v94, 0
    v_mov_b32 v95, 0
    v_mov_b32 v112, 0
    v_mov_b32 v113, 0
    v_mov_b32 v114, 0
    v_mov_b32 v115, 0
    v_mov_b32 v116, 0
    v_mov_b32 v117, 0
    v_mov_b32 v118, 0
    v_mov_b32 v119, 0
    v_mov_b32 v120, 0
    v_mov_b32 v121, 0
    v_mov_b32 v122, 0
    v_mov_b32 v123, 0
    v_mov_b32 v124, 0
    v_mov_b32 v125, 0
    v_mov_b32 v126, 0
    v_mov_b32 v127, 0
    v_mov_b32 v128, 0
    v_mov_b32 v129, 0
    v_mov_b32 v130, 0
    v_mov_b32 v131, 0
    v_mov_b32 v132, 0
    v_mov_b32 v133, 0
    v_mov_b32 v134, 0
    v_mov_b32 v135, 0
    v_mov_b32 v136, 0
    v_mov_b32 v137, 0
    v_mov_b32 v138, 0
    v_mov_b32 v139, 0
    v_mov_b32 v140, 0
    v_mov_b32 v141, 0
    v_mov_b32 v142, 0
    v_mov_b32 v143, 0
    v_mov_b32 v6, 0
    v_mov_b32 v7, 0
    v_mov_b32 v9, 0
    v_mov_b32 v96, 0
    v_mov_b32 v97, 0
    v_mov_b32 v98, 0
    v_mov_b32 v99, 0
    v_mov_b32 v100, 0
    v_mov_b32 v101, 0
    v_mov_b32 v102, 0
    v_mov_b32 v103, 0
    v_mov_b32 v104, 0
    v_mov_b32 v105, 0
    v_mov_b32 v106, 0
    v_mov_b32 v107, 0
    v_mov_b32 v108, 0
    v_mov_b32 v109, 0
    v_mov_b32 v110, 0
    v_mov_b32 v111, 0
    v_mov_b32 v144, 0
    v_mov_b32 v145, 0
    v_mov_b32 v146, 0
    v_mov_b32 v147, 0
    v_mov_b32 v148, 0
    v_mov_b32 v149, 0
    v_mov_b32 v150, 0
    v_mov_b32 v151, 0
    v_mov_b32 v152, 0
    v_mov_b32 v153, 0
    v_mov_b32 v154, 0
    v_mov_b32 v155, 0
    v_mov_b32 v156, 0
    v_mov_b32 v157, 0
    v_mov_b32 v158, 0
    v_mov_b32 v159, 0
    v_mov_b32 v160, 0
    v_mov_b32 v161, 0
    v_mov_b32 v162, 0
    v_mov_b32 v163, 0
    v_mov_b32 v164, 0
    v_mov_b32 v165, 0
    v_mov_b32 v166, 0
    v_mov_b32 v167, 0
    v_mov_b32 v168, 0
    v_mov_b32 v169, 0
    v_mov_b32 v170, 0
    v_mov_b32 v171, 0
    v_mov_b32 v172, 0
    v_mov_b32 v173, 0
    v_mov_b32 v174, 0
    v_mov_b32 v175, 0
    v_mov_b32 v0, 0x3f803f80
    s_waitcnt vmcnt(12)
    s_barrier
    ds_read_b128 v[192:195], v3 offset:32768
    ds_read_b128 v[196:199], v3 offset:33792
    ds_read_b128 v[200:203], v3 offset:34816
    ds_read_b128 v[204:207], v3 offset:35840
    s_waitcnt lgkmcnt(0)
    v_mfma_f32_32x32x16_bf16 v[48:63], v[192:195], v[16:19], v[80:95]
    v_mfma_f32_32x32x16_bf16 v[48:63], v[196:199], v[20:23], v[48:63]
    v_mfma_f32_32x32x16_bf16 v[48:63], v[200:203], v[24:27], v[48:63]
    v_mfma_f32_32x32x16_bf16 v[48:63], v[204:207], v[28:31], v[48:63]
    s_waitcnt vmcnt(8)
    s_barrier
    v_mfma_f32_32x32x16_bf16 v[64:79], v[192:195], v[32:35], v[96:111]
    ds_read_b128 v[208:211], v2 offset:0
    ds_read_b128 v[212:215], v2 offset:1024
    ds_read_b128 v[216:219], v2 offset:2048
    ds_read_b128 v[220:223], v2 offset:3072
    s_nop 4
    v_max3_f32 v10, v48, v49, v50
    v_max3_f32 v10, v10, v51, v52
    v_max3_f32 v10, v10, v53, v54
    v_max3_f32 v10, v10, v55, v56
    v_max3_f32 v10, v10, v57, v58
    v_max3_f32 v10, v10, v59, v60
    v_max3_f32 v10, v10, v61, v62
    v_max_f32 v10, v10, v63
    v_mov_b32 v11, v10
    v_mov_b32 v12, v10
    s_nop 1
    v_permlane32_swap_b32 v11, v12
    v_max_f32 v11, v11, v12
    v_add_f32 v8, v8, v11
    v_sub_f32 v48, v48, v11
    v_sub_f32 v49, v49, v11
    v_sub_f32 v50, v50, v11
    v_sub_f32 v51, v51, v11
    v_sub_f32 v52, v52, v11
    v_sub_f32 v53, v53, v11
    v_sub_f32 v54, v54, v11
    v_sub_f32 v55, v55, v11
    v_sub_f32 v56, v56, v11
    v_sub_f32 v57, v57, v11
    v_sub_f32 v58, v58, v11
    v_sub_f32 v59, v59, v11
    v_sub_f32 v60, v60, v11
    v_sub_f32 v61, v61, v11
    v_sub_f32 v62, v62, v11
    v_sub_f32 v63, v63, v11
    v_sub_f32 v80, v80, v11
    v_sub_f32 v81, v81, v11
    v_sub_f32 v82, v82, v11
    v_sub_f32 v83, v83, v11
    v_sub_f32 v84, v84, v11
    v_sub_f32 v85, v85, v11
    v_sub_f32 v86, v86, v11
    v_sub_f32 v87, v87, v11
    v_sub_f32 v88, v88, v11
    v_sub_f32 v89, v89, v11
    v_sub_f32 v90, v90, v11
    v_sub_f32 v91, v91, v11
    v_sub_f32 v92, v92, v11
    v_sub_f32 v93, v93, v11
    v_sub_f32 v94, v94, v11
    v_sub_f32 v95, v95, v11
    v_exp_f32 v48, v48
    v_exp_f32 v49, v49
    v_exp_f32 v50, v50
    v_mfma_f32_32x32x16_bf16 v[64:79], v[196:199], v[36:39], v[64:79]
    ds_read_b128 v[224:227], v2 offset:4096
    ds_read_b128 v[228:231], v2 offset:5120
    ds_read_b128 v[232:235], v2 offset:6144
    ds_read_b128 v[236:239], v2 offset:7168
    v_exp_f32 v51, v51
    v_cvt_pk_bf16_f32 v176, v48, v49
    v_exp_f32 v52, v52
    v_exp_f32 v53, v53
    v_cvt_pk_bf16_f32 v177, v50, v51
    v_add_f32 v14, v48, v50
    v_add_f32 v15, v49, v51
    v_exp_f32 v54, v54
    v_exp_f32 v55, v55
    v_cvt_pk_bf16_f32 v178, v52, v53
    v_add_f32 v14, v14, v52
    v_add_f32 v15, v15, v53
    v_mfma_f32_32x32x16_bf16 v[64:79], v[200:203], v[40:43], v[64:79]
    s_mov_b32 m0, s35
    s_nop 0
    buffer_load_dwordx4 v1, s[12:15], s28 offen lds
    buffer_load_dwordx4 v1, s[12:15], s28 offen offset:1024 lds
    buffer_load_dwordx4 v1, s[12:15], s28 offen offset:2048 lds
    buffer_load_dwordx4 v1, s[12:15], s28 offen offset:3072 lds
    s_add_u32 s28, s28, 8192
    v_exp_f32 v56, v56
    v_exp_f32 v57, v57
    v_cvt_pk_bf16_f32 v179, v54, v55
    v_add_f32 v14, v14, v54
    v_add_f32 v15, v15, v55
    v_exp_f32 v58, v58
    v_exp_f32 v59, v59
    v_cvt_pk_bf16_f32 v180, v56, v57
    v_add_f32 v14, v14, v56
    v_add_f32 v15, v15, v57
    v_exp_f32 v60, v60
    v_exp_f32 v61, v61
    v_cvt_pk_bf16_f32 v181, v58, v59
    v_mfma_f32_32x32x16_bf16 v[64:79], v[204:207], v[44:47], v[64:79]
    v_add_f32 v14, v14, v58
    v_add_f32 v15, v15, v59
    v_exp_f32 v62, v62
    v_exp_f32 v63, v63
    v_cvt_pk_bf16_f32 v182, v60, v61
    v_add_f32 v14, v14, v60
    v_add_f32 v15, v15, v61
    v_cvt_pk_bf16_f32 v183, v62, v63
    v_add_f32 v14, v14, v62
    v_add_f32 v15, v15, v63
    v_add_f32 v4, v4, v14
    v_add_f32 v5, v5, v15
    s_waitcnt lgkmcnt(0)
    v_mfma_f32_32x32x16_bf16 v[48:63], v[208:211], v[16:19], v[80:95]
    v_max3_f32 v10, v64, v65, v66
    v_max3_f32 v10, v10, v67, v68
    v_max3_f32 v10, v10, v69, v70
    v_max3_f32 v10, v10, v71, v72
    v_max3_f32 v10, v10, v73, v74
    v_max3_f32 v10, v10, v75, v76
    v_mfma_f32_32x32x16_bf16 v[48:63], v[212:215], v[20:23], v[48:63]
    v_max3_f32 v10, v10, v77, v78
    v_max_f32 v10, v10, v79
    v_mov_b32 v11, v10
    v_mov_b32 v12, v10
    s_nop 1
    v_permlane32_swap_b32 v11, v12
    v_max_f32 v11, v11, v12
    v_add_f32 v9, v9, v11
    v_sub_f32 v64, v64, v11
    v_sub_f32 v65, v65, v11
    v_sub_f32 v66, v66, v11
    v_sub_f32 v67, v67, v11
    v_sub_f32 v68, v68, v11
    v_sub_f32 v69, v69, v11
    v_sub_f32 v70, v70, v11
    v_sub_f32 v71, v71, v11
    v_sub_f32 v72, v72, v11
    v_sub_f32 v73, v73, v11
    v_sub_f32 v74, v74, v11
    v_sub_f32 v75, v75, v11
    v_sub_f32 v76, v76, v11
    v_sub_f32 v77, v77, v11
    v_sub_f32 v78, v78, v11
    v_sub_f32 v79, v79, v11
    v_sub_f32 v96, v96, v11
    v_sub_f32 v97, v97, v11
    v_sub_f32 v98, v98, v11
    v_sub_f32 v99, v99, v11
    v_sub_f32 v100, v100, v11
    v_sub_f32 v101, v101, v11
    v_sub_f32 v102, v102, v11
    v_sub_f32 v103, v103, v11
    v_sub_f32 v104, v104, v11
    v_sub_f32 v105, v105, v11
    v_sub_f32 v106, v106, v11
    v_sub_f32 v107, v107, v11
    v_sub_f32 v108, v108, v11
    v_sub_f32 v109, v109, v11
    v_sub_f32 v110, v110, v11
    v_sub_f32 v111, v111, v11
    v_exp_f32 v64, v64
    v_exp_f32 v65, v65
    v_exp_f32 v66, v66
    v_mfma_f32_32x32x16_bf16 v[48:63], v[216:219], v[24:27], v[48:63]
    v_exp_f32 v67, v67
    v_cvt_pk_bf16_f32 v184, v64, v65
    v_exp_f32 v68, v68
    v_exp_f32 v69, v69
    v_cvt_pk_bf16_f32 v185, v66, v67
    v_add_f32 v14, v64, v66
    v_mfma_f32_32x32x16_bf16 v[48:63], v[220:223], v[28:31], v[48:63]
    v_add_f32 v15, v65, v67
    v_exp_f32 v70, v70
    v_exp_f32 v71, v71
    v_cvt_pk_bf16_f32 v186, v68, v69
    v_add_f32 v14, v14, v68
    v_add_f32 v15, v15, v69
    v_mfma_f32_32x32x16_bf16 v[112:127], v[224:227], v[176:179], v[112:127]
    v_exp_f32 v72, v72
    v_exp_f32 v73, v73
    v_cvt_pk_bf16_f32 v187, v70, v71
    v_add_f32 v14, v14, v70
    v_add_f32 v15, v15, v71
    v_exp_f32 v74, v74
    v_exp_f32 v75, v75
    v_mfma_f32_32x32x16_bf16 v[128:143], v[232:235], v[176:179], v[128:143]
    v_cvt_pk_bf16_f32 v188, v72, v73
    v_add_f32 v14, v14, v72
    v_add_f32 v15, v15, v73
    v_exp_f32 v76, v76
    v_exp_f32 v77, v77
    v_cvt_pk_bf16_f32 v189, v74, v75
    v_mfma_f32_32x32x16_bf16 v[112:127], v[228:231], v[180:183], v[112:127]
    v_add_f32 v14, v14, v74
    v_add_f32 v15, v15, v75
    v_exp_f32 v78, v78
    v_exp_f32 v79, v79
    v_cvt_pk_bf16_f32 v190, v76, v77
    v_add_f32 v14, v14, v76
    v_mfma_f32_32x32x16_bf16 v[128:143], v[236:239], v[180:183], v[128:143]
    v_add_f32 v15, v15, v77
    v_cvt_pk_bf16_f32 v191, v78, v79
    v_add_f32 v14, v14, v78
    v_add_f32 v15, v15, v79
    v_add_f32 v6, v6, v14
    v_add_f32 v7, v7, v15
    s_mov_b32 s30, 6
    s_nop 3
L_k2_loop_attn_kernel:
    s_waitcnt vmcnt(8)
    s_barrier
    v_mfma_f32_32x32x16_bf16 v[64:79], v[208:211], v[32:35], v[96:111]
    ds_read_b128 v[192:195], v2 offset:32768
    ds_read_b128 v[196:199], v2 offset:33792
    v_exp_f32 v48, v48
    v_exp_f32 v49, v49
    v_exp_f32 v50, v50
    v_exp_f32 v51, v51
    v_cvt_pk_bf16_f32 v176, v48, v49
    v_mfma_f32_32x32x16_bf16 v[64:79], v[212:215], v[36:39], v[64:79]
    ds_read_b128 v[200:203], v2 offset:34816
    ds_read_b128 v[204:207], v2 offset:35840
    v_exp_f32 v52, v52
    v_exp_f32 v53, v53
    v_cvt_pk_bf16_f32 v177, v50, v51
    v_add_f32 v14, v48, v50
    v_add_f32 v15, v49, v51
    v_mfma_f32_32x32x16_bf16 v[64:79], v[216:219], v[40:43], v[64:79]
    ds_read_b128 v[240:243], v2 offset:36864
    ds_read_b128 v[244:247], v2 offset:37888
    v_exp_f32 v54, v54
    v_exp_f32 v55, v55
    v_cvt_pk_bf16_f32 v178, v52, v53
    v_add_f32 v14, v14, v52
    v_add_f32 v15, v15, v53
    v_exp_f32 v56, v56
    v_mfma_f32_32x32x16_bf16 v[64:79], v[220:223], v[44:47], v[64:79]
    ds_read_b128 v[248:251], v2 offset:38912
    ds_read_b128 v[252:255], v2 offset:39936
    v_exp_f32 v57, v57
    v_cvt_pk_bf16_f32 v179, v54, v55
    v_add_f32 v14, v14, v54
    v_add_f32 v15, v15, v55
    v_exp_f32 v58, v58
    v_mfma_f32_32x32x16_bf16 v[144:159], v[224:227], v[184:187], v[144:159]
    s_mov_b32 m0, s32
    s_nop 0
    buffer_load_dwordx4 v1, s[12:15], s28 offen lds
    buffer_load_dwordx4 v1, s[12:15], s28 offen offset:1024 lds
    v_exp_f32 v59, v59
    v_cvt_pk_bf16_f32 v180, v56, v57
    v_add_f32 v14, v14, v56
    v_add_f32 v15, v15, v57
    v_exp_f32 v60, v60
    v_mfma_f32_32x32x16_bf16 v[160:175], v[232:235], v[184:187], v[160:175]
    buffer_load_dwordx4 v1, s[12:15], s28 offen offset:2048 lds
    buffer_load_dwordx4 v1, s[12:15], s28 offen offset:3072 lds
    s_add_u32 s28, s28, 8192
    v_exp_f32 v61, v61
    v_cvt_pk_bf16_f32 v181, v58, v59
    v_add_f32 v14, v14, v58
    v_add_f32 v15, v15, v59
    v_exp_f32 v62, v62
    v_exp_f32 v63, v63
    v_mfma_f32_32x32x16_bf16 v[144:159], v[228:231], v[188:191], v[144:159]
    v_cvt_pk_bf16_f32 v182, v60, v61
    v_add_f32 v14, v14, v60
    v_add_f32 v15, v15, v61
    v_cvt_pk_bf16_f32 v183, v62, v63
    v_add_f32 v14, v14, v62
    v_mfma_f32_32x32x16_bf16 v[160:175], v[236:239], v[188:191], v[160:175]
    v_add_f32 v15, v15, v63
    v_add_f32 v13, v14, v15
    v_cmp_lt_f32 vcc, 0x44800000, v13
    s_nop 0
    s_cbranch_vccnz Lrs_attn_kernel_1
Lrs_attn_kernel_1_ret:
    v_add_f32 v4, v4, v14
    v_add_f32 v5, v5, v15
    s_waitcnt lgkmcnt(0)
    v_mfma_f32_32x32x16_bf16 v[48:63], v[192:195], v[16:19], v[80:95]
    v_exp_f32 v64, v64
    v_exp_f32 v65, v65
    v_exp_f32 v66, v66
    v_exp_f32 v67, v67
    v_cvt_pk_bf16_f32 v184, v64, v65
    v_mfma_f32_32x32x16_bf16 v[48:63], v[196:199], v[20:23], v[48:63]
    v_exp_f32 v68, v68
    v_exp_f32 v69, v69
    v_cvt_pk_bf16_f32 v185, v66, v67
    v_add_f32 v14, v64, v66
    v_add_f32 v15, v65, v67
    v_mfma_f32_32x32x16_bf16 v[48:63], v[200:203], v[24:27], v[48:63]
    v_exp_f32 v70, v70
    v_exp_f32 v71, v71
    v_cvt_pk_bf16_f32 v186, v68, v69
    v_add_f32 v14, v14, v68
    v_add_f32 v15, v15, v69
    v_exp_f32 v72, v72
    v_mfma_f32_32x32x16_bf16 v[48:63], v[204:207], v[28:31], v[48:63]
    v_exp_f32 v73, v73
    v_cvt_pk_bf16_f32 v187, v70, v71
    v_add_f32 v14, v14, v70
    v_add_f32 v15, v15, v71
    v_exp_f32 v74, v74
    v_mfma_f32_32x32x16_bf16 v[112:127], v[240:243], v[176:179], v[112:127]
    v_exp_f32 v75, v75
    v_cvt_pk_bf16_f32 v188, v72, v73
    v_add_f32 v14, v14, v72
    v_add_f32 v15, v15, v73
    v_exp_f32 v76, v76
    v_mfma_f32_32x32x16_bf16 v[128:143], v[248:251], v[176:179], v[128:143]
    v_exp_f32 v77, v77
    v_cvt_pk_bf16_f32 v189, v74, v75
    v_add_f32 v14, v14, v74
    v_add_f32 v15, v15, v75
    v_exp_f32 v78, v78
    v_exp_f32 v79, v79
    v_mfma_f32_32x32x16_bf16 v[112:127], v[244:247], v[180:183], v[112:127]
    v_cvt_pk_bf16_f32 v190, v76, v77
    v_add_f32 v14, v14, v76
    v_add_f32 v15, v15, v77
    v_cvt_pk_bf16_f32 v191, v78, v79
    v_add_f32 v14, v14, v78
    v_mfma_f32_32x32x16_bf16 v[128:143], v[252:255], v[180:183], v[128:143]
    v_add_f32 v15, v15, v79
    v_add_f32 v13, v14, v15
    v_cmp_lt_f32 vcc, 0x44800000, v13
    s_nop 0
    s_cbranch_vccnz Lrs_attn_kernel_2
Lrs_attn_kernel_2_ret:
    v_add_f32 v6, v6, v14
    v_add_f32 v7, v7, v15
    s_waitcnt vmcnt(8)
    s_barrier
    v_mfma_f32_32x32x16_bf16 v[64:79], v[192:195], v[32:35], v[96:111]
    ds_read_b128 v[208:211], v3 offset:0
    ds_read_b128 v[212:215], v3 offset:1024
    v_exp_f32 v48, v48
    v_exp_f32 v49, v49
    v_exp_f32 v50, v50
    v_exp_f32 v51, v51
    v_cvt_pk_bf16_f32 v176, v48, v49
    v_mfma_f32_32x32x16_bf16 v[64:79], v[196:199], v[36:39], v[64:79]
    ds_read_b128 v[216:219], v3 offset:2048
    ds_read_b128 v[220:223], v3 offset:3072
    v_exp_f32 v52, v52
    v_exp_f32 v53, v53
    v_cvt_pk_bf16_f32 v177, v50, v51
    v_add_f32 v14, v48, v50
    v_add_f32 v15, v49, v51
    v_mfma_f32_32x32x16_bf16 v[64:79], v[200:203], v[40:43], v[64:79]
    ds_read_b128 v[224:227], v3 offset:4096
    ds_read_b128 v[228:231], v3 offset:5120
    v_exp_f32 v54, v54
    v_exp_f32 v55, v55
    v_cvt_pk_bf16_f32 v178, v52, v53
    v_add_f32 v14, v14, v52
    v_add_f32 v15, v15, v53
    v_exp_f32 v56, v56
    v_mfma_f32_32x32x16_bf16 v[64:79], v[204:207], v[44:47], v[64:79]
    ds_read_b128 v[232:235], v3 offset:6144
    ds_read_b128 v[236:239], v3 offset:7168
    v_exp_f32 v57, v57
    v_cvt_pk_bf16_f32 v179, v54, v55
    v_add_f32 v14, v14, v54
    v_add_f32 v15, v15, v55
    v_exp_f32 v58, v58
    v_mfma_f32_32x32x16_bf16 v[144:159], v[240:243], v[184:187], v[144:159]
    s_mov_b32 m0, s33
    s_nop 0
    buffer_load_dwordx4 v1, s[12:15], s28 offen lds
    buffer_load_dwordx4 v1, s[12:15], s28 offen offset:1024 lds
    v_exp_f32 v59, v59
    v_cvt_pk_bf16_f32 v180, v56, v57
    v_add_f32 v14, v14, v56
    v_add_f32 v15, v15, v57
    v_exp_f32 v60, v60
    v_mfma_f32_32x32x16_bf16 v[160:175], v[248:251], v[184:187], v[160:175]
    buffer_load_dwordx4 v1, s[12:15], s28 offen offset:2048 lds
    buffer_load_dwordx4 v1, s[12:15], s28 offen offset:3072 lds
    s_add_u32 s28, s28, 8192
    v_exp_f32 v61, v61
    v_cvt_pk_bf16_f32 v181, v58, v59
    v_add_f32 v14, v14, v58
    v_add_f32 v15, v15, v59
    v_exp_f32 v62, v62
    v_exp_f32 v63, v63
    v_mfma_f32_32x32x16_bf16 v[144:159], v[244:247], v[188:191], v[144:159]
    v_cvt_pk_bf16_f32 v182, v60, v61
    v_add_f32 v14, v14, v60
    v_add_f32 v15, v15, v61
    v_cvt_pk_bf16_f32 v183, v62, v63
    v_add_f32 v14, v14, v62
    v_mfma_f32_32x32x16_bf16 v[160:175], v[252:255], v[188:191], v[160:175]
    v_add_f32 v15, v15, v63
    v_add_f32 v13, v14, v15
    v_cmp_lt_f32 vcc, 0x44800000, v13
    s_nop 0
    s_cbranch_vccnz Lrs_attn_kernel_3
Lrs_attn_kernel_3_ret:
    v_add_f32 v4, v4, v14
    v_add_f32 v5, v5, v15
    s_waitcnt lgkmcnt(0)
    v_mfma_f32_32x32x16_bf16 v[48:63], v[208:211], v[16:19], v[80:95]
    v_exp_f32 v64, v64
    v_exp_f32 v65, v65
    v_exp_f32 v66, v66
    v_exp_f32 v67, v67
    v_cvt_pk_bf16_f32 v184, v64, v65
    v_mfma_f32_32x32x16_bf16 v[48:63], v[212:215], v[20:23], v[48:63]
    v_exp_f32 v68, v68
    v_exp_f32 v69, v69
    v_cvt_pk_bf16_f32 v185, v66, v67
    v_add_f32 v14, v64, v66
    v_add_f32 v15, v65, v67
    v_mfma_f32_32x32x16_bf16 v[48:63], v[216:219], v[24:27], v[48:63]
    v_exp_f32 v70, v70
    v_exp_f32 v71, v71
    v_cvt_pk_bf16_f32 v186, v68, v69
    v_add_f32 v14, v14, v68
    v_add_f32 v15, v15, v69
    v_exp_f32 v72, v72
    v_mfma_f32_32x32x16_bf16 v[48:63], v[220:223], v[28:31], v[48:63]
    v_exp_f32 v73, v73
    v_cvt_pk_bf16_f32 v187, v70, v71
    v_add_f32 v14, v14, v70
    v_add_f32 v15, v15, v71
    v_exp_f32 v74, v74
    v_mfma_f32_32x32x16_bf16 v[112:127], v[224:227], v[176:179], v[112:127]
    v_exp_f32 v75, v75
    v_cvt_pk_bf16_f32 v188, v72, v73
    v_add_f32 v14, v14, v72
    v_add_f32 v15, v15, v73
    v_exp_f32 v76, v76
    v_mfma_f32_32x32x16_bf16 v[128:143], v[232:235], v[176:179], v[128:143]
    v_exp_f32 v77, v77
    v_cvt_pk_bf16_f32 v189, v74, v75
    v_add_f32 v14, v14, v74
    v_add_f32 v15, v15, v75
    v_exp_f32 v78, v78
    v_exp_f32 v79, v79
    v_mfma_f32_32x32x16_bf16 v[112:127], v[228:231], v[180:183], v[112:127]
    v_cvt_pk_bf16_f32 v190, v76, v77
    v_add_f32 v14, v14, v76
    v_add_f32 v15, v15, v77
    v_cvt_pk_bf16_f32 v191, v78, v79
    v_add_f32 v14, v14, v78
    v_mfma_f32_32x32x16_bf16 v[128:143], v[236:239], v[180:183], v[128:143]
    v_add_f32 v15, v15, v79
    v_add_f32 v13, v14, v15
    v_cmp_lt_f32 vcc, 0x44800000, v13
    s_nop 0
    s_cbranch_vccnz Lrs_attn_kernel_4
Lrs_attn_kernel_4_ret:
    v_add_f32 v6, v6, v14
    v_add_f32 v7, v7, v15
    s_waitcnt vmcnt(8)
    s_barrier
    v_mfma_f32_32x32x16_bf16 v[64:79], v[208:211], v[32:35], v[96:111]
    ds_read_b128 v[192:195], v3 offset:32768
    ds_read_b128 v[196:199], v3 offset:33792
    v_exp_f32 v48, v48
    v_exp_f32 v49, v49
    v_exp_f32 v50, v50
    v_exp_f32 v51, v51
    v_cvt_pk_bf16_f32 v176, v48, v49
    v_mfma_f32_32x32x16_bf16 v[64:79], v[212:215], v[36:39], v[64:79]
    ds_read_b128 v[200:203], v3 offset:34816
    ds_read_b128 v[204:207], v3 offset:35840
    v_exp_f32 v52, v52
    v_exp_f32 v53, v53
    v_cvt_pk_bf16_f32 v177, v50, v51
    v_add_f32 v14, v48, v50
    v_add_f32 v15, v49, v51
    v_mfma_f32_32x32x16_bf16 v[64:79], v[216:219], v[40:43], v[64:79]
    ds_read_b128 v[240:243], v3 offset:36864
    ds_read_b128 v[244:247], v3 offset:37888
    v_exp_f32 v54, v54
    v_exp_f32 v55, v55
    v_cvt_pk_bf16_f32 v178, v52, v53
    v_add_f32 v14, v14, v52
    v_add_f32 v15, v15, v53
    v_exp_f32 v56, v56
    v_mfma_f32_32x32x16_bf16 v[64:79], v[220:223], v[44:47], v[64:79]
    ds_read_b128 v[248:251], v3 offset:38912
    ds_read_b128 v[252:255], v3 offset:39936
    v_exp_f32 v57, v57
    v_cvt_pk_bf16_f32 v179, v54, v55
    v_add_f32 v14, v14, v54
    v_add_f32 v15, v15, v55
    v_exp_f32 v58, v58
    v_mfma_f32_32x32x16_bf16 v[144:159], v[224:227], v[184:187], v[144:159]
    s_mov_b32 m0, s34
    s_nop 0
    buffer_load_dwordx4 v1, s[12:15], s28 offen lds
    buffer_load_dwordx4 v1, s[12:15], s28 offen offset:1024 lds
    v_exp_f32 v59, v59
    v_cvt_pk_bf16_f32 v180, v56, v57
    v_add_f32 v14, v14, v56
    v_add_f32 v15, v15, v57
    v_exp_f32 v60, v60
    v_mfma_f32_32x32x16_bf16 v[160:175], v[232:235], v[184:187], v[160:175]
    buffer_load_dwordx4 v1, s[12:15], s28 offen offset:2048 lds
    buffer_load_dwordx4 v1, s[12:15], s28 offen offset:3072 lds
    s_add_u32 s28, s28, 8192
    v_exp_f32 v61, v61
    v_cvt_pk_bf16_f32 v181, v58, v59
    v_add_f32 v14, v14, v58
    v_add_f32 v15, v15, v59
    v_exp_f32 v62, v62
    v_exp_f32 v63, v63
    v_mfma_f32_32x32x16_bf16 v[144:159], v[228:231], v[188:191], v[144:159]
    v_cvt_pk_bf16_f32 v182, v60, v61
    v_add_f32 v14, v14, v60
    v_add_f32 v15, v15, v61
    v_cvt_pk_bf16_f32 v183, v62, v63
    v_add_f32 v14, v14, v62
    v_mfma_f32_32x32x16_bf16 v[160:175], v[236:239], v[188:191], v[160:175]
    v_add_f32 v15, v15, v63
    v_add_f32 v13, v14, v15
    v_cmp_lt_f32 vcc, 0x44800000, v13
    s_nop 0
    s_cbranch_vccnz Lrs_attn_kernel_5
Lrs_attn_kernel_5_ret:
    v_add_f32 v4, v4, v14
    v_add_f32 v5, v5, v15
    s_waitcnt lgkmcnt(0)
    v_mfma_f32_32x32x16_bf16 v[48:63], v[192:195], v[16:19], v[80:95]
    v_exp_f32 v64, v64
    v_exp_f32 v65, v65
    v_exp_f32 v66, v66
    v_exp_f32 v67, v67
    v_cvt_pk_bf16_f32 v184, v64, v65
    v_mfma_f32_32x32x16_bf16 v[48:63], v[196:199], v[20:23], v[48:63]
    v_exp_f32 v68, v68
    v_exp_f32 v69, v69
    v_cvt_pk_bf16_f32 v185, v66, v67
    v_add_f32 v14, v64, v66
    v_add_f32 v15, v65, v67
    v_mfma_f32_32x32x16_bf16 v[48:63], v[200:203], v[24:27], v[48:63]
    v_exp_f32 v70, v70
    v_exp_f32 v71, v71
    v_cvt_pk_bf16_f32 v186, v68, v69
    v_add_f32 v14, v14, v68
    v_add_f32 v15, v15, v69
    v_exp_f32 v72, v72
    v_mfma_f32_32x32x16_bf16 v[48:63], v[204:207], v[28:31], v[48:63]
    v_exp_f32 v73, v73
    v_cvt_pk_bf16_f32 v187, v70, v71
    v_add_f32 v14, v14, v70
    v_add_f32 v15, v15, v71
    v_exp_f32 v74, v74
    v_mfma_f32_32x32x16_bf16 v[112:127], v[240:243], v[176:179], v[112:127]
    v_exp_f32 v75, v75
    v_cvt_pk_bf16_f32 v188, v72, v73
    v_add_f32 v14, v14, v72
    v_add_f32 v15, v15, v73
    v_exp_f32 v76, v76
    v_mfma_f32_32x32x16_bf16 v[128:143], v[248:251], v[176:179], v[128:143]
    v_exp_f32 v77, v77
    v_cvt_pk_bf16_f32 v189, v74, v75
    v_add_f32 v14, v14, v74
    v_add_f32 v15, v15, v75
    v_exp_f32 v78, v78
    v_exp_f32 v79, v79
    v_mfma_f32_32x32x16_bf16 v[112:127], v[244:247], v[180:183], v[112:127]
    v_cvt_pk_bf16_f32 v190, v76, v77
    v_add_f32 v14, v14, v76
    v_add_f32 v15, v15, v77
    v_cvt_pk_bf16_f32 v191, v78, v79
    v_add_f32 v14, v14, v78
    v_mfma_f32_32x32x16_bf16 v[128:143], v[252:255], v[180:183], v[128:143]
    v_add_f32 v15, v15, v79
    v_add_f32 v13, v14, v15
    v_cmp_lt_f32 vcc, 0x44800000, v13
    s_nop 0
    s_cbranch_vccnz Lrs_attn_kernel_6
Lrs_attn_kernel_6_ret:
    v_add_f32 v6, v6, v14
    v_add_f32 v7, v7, v15
    s_waitcnt vmcnt(8)
    s_barrier
    v_mfma_f32_32x32x16_bf16 v[64:79], v[192:195], v[32:35], v[96:111]
    ds_read_b128 v[208:211], v2 offset:0
    ds_read_b128 v[212:215], v2 offset:1024
    v_exp_f32 v48, v48
    v_exp_f32 v49, v49
    v_exp_f32 v50, v50
    v_exp_f32 v51, v51
    v_cvt_pk_bf16_f32 v176, v48, v49
    v_mfma_f32_32x32x16_bf16 v[64:79], v[196:199], v[36:39], v[64:79]
    ds_read_b128 v[216:219], v2 offset:2048
    ds_read_b128 v[220:223], v2 offset:3072
    v_exp_f32 v52, v52
    v_exp_f32 v53, v53
    v_cvt_pk_bf16_f32 v177, v50, v51
    v_add_f32 v14, v48, v50
    v_add_f32 v15, v49, v51
    v_mfma_f32_32x32x16_bf16 v[64:79], v[200:203], v[40:43], v[64:79]
    ds_read_b128 v[224:227], v2 offset:4096
    ds_read_b128 v[228:231], v2 offset:5120
    v_exp_f32 v54, v54
    v_exp_f32 v55, v55
    v_cvt_pk_bf16_f32 v178, v52, v53
    v_add_f32 v14, v14, v52
    v_add_f32 v15, v15, v53
    v_exp_f32 v56, v56
    v_mfma_f32_32x32x16_bf16 v[64:79], v[204:207], v[44:47], v[64:79]
    ds_read_b128 v[232:235], v2 offset:6144
    ds_read_b128 v[236:239], v2 offset:7168
    v_exp_f32 v57, v57
    v_cvt_pk_bf16_f32 v179, v54, v55
    v_add_f32 v14, v14, v54
    v_add_f32 v15, v15, v55
    v_exp_f32 v58, v58
    v_mfma_f32_32x32x16_bf16 v[144:159], v[240:243], v[184:187], v[144:159]
    s_mov_b32 m0, s35
    s_nop 0
    buffer_load_dwordx4 v1, s[12:15], s28 offen lds
    buffer_load_dwordx4 v1, s[12:15], s28 offen offset:1024 lds
    v_exp_f32 v59, v59
    v_cvt_pk_bf16_f32 v180, v56, v57
    v_add_f32 v14, v14, v56
    v_add_f32 v15, v15, v57
    v_exp_f32 v60, v60
    v_mfma_f32_32x32x16_bf16 v[160:175], v[248:251], v[184:187], v[160:175]
    buffer_load_dwordx4 v1, s[12:15], s28 offen offset:2048 lds
    buffer_load_dwordx4 v1, s[12:15], s28 offen offset:3072 lds
    s_add_u32 s28, s28, 8192
    v_exp_f32 v61, v61
    v_cvt_pk_bf16_f32 v181, v58, v59
    v_add_f32 v14, v14, v58
    v_add_f32 v15, v15, v59
    v_exp_f32 v62, v62
    v_exp_f32 v63, v63
    v_mfma_f32_32x32x16_bf16 v[144:159], v[244:247], v[188:191], v[144:159]
    v_cvt_pk_bf16_f32 v182, v60, v61
    v_add_f32 v14, v14, v60
    v_add_f32 v15, v15, v61
    v_cvt_pk_bf16_f32 v183, v62, v63
    v_add_f32 v14, v14, v62
    v_mfma_f32_32x32x16_bf16 v[160:175], v[252:255], v[188:191], v[160:175]
    v_add_f32 v15, v15, v63
    v_add_f32 v13, v14, v15
    v_cmp_lt_f32 vcc, 0x44800000, v13
    s_nop 0
    s_cbranch_vccnz Lrs_attn_kernel_7
Lrs_attn_kernel_7_ret:
    v_add_f32 v4, v4, v14
    v_add_f32 v5, v5, v15
    s_waitcnt lgkmcnt(0)
    v_mfma_f32_32x32x16_bf16 v[48:63], v[208:211], v[16:19], v[80:95]
    v_exp_f32 v64, v64
    v_exp_f32 v65, v65
    v_exp_f32 v66, v66
    v_exp_f32 v67, v67
    v_cvt_pk_bf16_f32 v184, v64, v65
    v_mfma_f32_32x32x16_bf16 v[48:63], v[212:215], v[20:23], v[48:63]
    v_exp_f32 v68, v68
    v_exp_f32 v69, v69
    v_cvt_pk_bf16_f32 v185, v66, v67
    v_add_f32 v14, v64, v66
    v_add_f32 v15, v65, v67
    v_mfma_f32_32x32x16_bf16 v[48:63], v[216:219], v[24:27], v[48:63]
    v_exp_f32 v70, v70
    v_exp_f32 v71, v71
    v_cvt_pk_bf16_f32 v186, v68, v69
    v_add_f32 v14, v14, v68
    v_add_f32 v15, v15, v69
    v_exp_f32 v72, v72
    v_mfma_f32_32x32x16_bf16 v[48:63], v[220:223], v[28:31], v[48:63]
    v_exp_f32 v73, v73
    v_cvt_pk_bf16_f32 v187, v70, v71
    v_add_f32 v14, v14, v70
    v_add_f32 v15, v15, v71
    v_exp_f32 v74, v74
    v_mfma_f32_32x32x16_bf16 v[112:127], v[224:227], v[176:179], v[112:127]
    v_exp_f32 v75, v75
    v_cvt_pk_bf16_f32 v188, v72, v73
    v_add_f32 v14, v14, v72
    v_add_f32 v15, v15, v73
    v_exp_f32 v76, v76
    v_mfma_f32_32x32x16_bf16 v[128:143], v[232:235], v[176:179], v[128:143]
    v_exp_f32 v77, v77
    v_cvt_pk_bf16_f32 v189, v74, v75
    v_add_f32 v14, v14, v74
    v_add_f32 v15, v15, v75
    v_exp_f32 v78, v78
    v_exp_f32 v79, v79
    v_mfma_f32_32x32x16_bf16 v[112:127], v[228:231], v[180:183], v[112:127]
    v_cvt_pk_bf16_f32 v190, v76, v77
    v_add_f32 v14, v14, v76
    v_add_f32 v15, v15, v77
    v_cvt_pk_bf16_f32 v191, v78, v79
    v_add_f32 v14, v14, v78
    v_mfma_f32_32x32x16_bf16 v[128:143], v[236:239], v[180:183], v[128:143]
    v_add_f32 v15, v15, v79
    v_add_f32 v13, v14, v15
    v_cmp_lt_f32 vcc, 0x44800000, v13
    s_nop 0
    s_cbranch_vccnz Lrs_attn_kernel_8
Lrs_attn_kernel_8_ret:
    v_add_f32 v6, v6, v14
    v_add_f32 v7, v7, v15
    s_sub_u32 s30, s30, 1
    s_cmp_lg_u32 s30, 0
    s_nop 1
    s_cbranch_scc1 L_k2_loop_attn_kernel
    s_waitcnt vmcnt(8)
    s_barrier
    v_mfma_f32_32x32x16_bf16 v[64:79], v[208:211], v[32:35], v[96:111]
    ds_read_b128 v[192:195], v2 offset:32768
    ds_read_b128 v[196:199], v2 offset:33792
    v_exp_f32 v48, v48
    v_exp_f32 v49, v49
    v_exp_f32 v50, v50
    v_exp_f32 v51, v51
    v_cvt_pk_bf16_f32 v176, v48, v49
    v_mfma_f32_32x32x16_bf16 v[64:79], v[212:215], v[36:39], v[64:79]
    ds_read_b128 v[200:203], v2 offset:34816
    ds_read_b128 v[204:207], v2 offset:35840
    v_exp_f32 v52, v52
    v_exp_f32 v53, v53
    v_cvt_pk_bf16_f32 v177, v50, v51
    v_add_f32 v14, v48, v50
    v_add_f32 v15, v49, v51
    v_mfma_f32_32x32x16_bf16 v[64:79], v[216:219], v[40:43], v[64:79]
    ds_read_b128 v[240:243], v2 offset:36864
    ds_read_b128 v[244:247], v2 offset:37888
    v_exp_f32 v54, v54
    v_exp_f32 v55, v55
    v_cvt_pk_bf16_f32 v178, v52, v53
    v_add_f32 v14, v14, v52
    v_add_f32 v15, v15, v53
    v_exp_f32 v56, v56
    v_mfma_f32_32x32x16_bf16 v[64:79], v[220:223], v[44:47], v[64:79]
    ds_read_b128 v[248:251], v2 offset:38912
    ds_read_b128 v[252:255], v2 offset:39936
    v_exp_f32 v57, v57
    v_cvt_pk_bf16_f32 v179, v54, v55
    v_add_f32 v14, v14, v54
    v_add_f32 v15, v15, v55
    v_exp_f32 v58, v58
    v_mfma_f32_32x32x16_bf16 v[144:159], v[224:227], v[184:187], v[144:159]
    s_mov_b32 m0, s32
    s_nop 0
    buffer_load_dwordx4 v1, s[12:15], s28 offen lds
    buffer_load_dwordx4 v1, s[12:15], s28 offen offset:1024 lds
    v_exp_f32 v59, v59
    v_cvt_pk_bf16_f32 v180, v56, v57
    v_add_f32 v14, v14, v56
    v_add_f32 v15, v15, v57
    v_exp_f32 v60, v60
    v_mfma_f32_32x32x16_bf16 v[160:175], v[232:235], v[184:187], v[160:175]
    buffer_load_dwordx4 v1, s[12:15], s28 offen offset:2048 lds
    buffer_load_dwordx4 v1, s[12:15], s28 offen offset:3072 lds
    s_add_u32 s28, s28, 8192
    v_exp_f32 v61, v61
    v_cvt_pk_bf16_f32 v181, v58, v59
    v_add_f32 v14, v14, v58
    v_add_f32 v15, v15, v59
    v_exp_f32 v62, v62
    v_exp_f32 v63, v63
    v_mfma_f32_32x32x16_bf16 v[144:159], v[228:231], v[188:191], v[144:159]
    v_cvt_pk_bf16_f32 v182, v60, v61
    v_add_f32 v14, v14, v60
    v_add_f32 v15, v15, v61
    v_cvt_pk_bf16_f32 v183, v62, v63
    v_add_f32 v14, v14, v62
    v_mfma_f32_32x32x16_bf16 v[160:175], v[236:239], v[188:191], v[160:175]
    v_add_f32 v15, v15, v63
    v_add_f32 v13, v14, v15
    v_cmp_lt_f32 vcc, 0x44800000, v13
    s_nop 0
    s_cbranch_vccnz Lrs_attn_kernel_9
Lrs_attn_kernel_9_ret:
    v_add_f32 v4, v4, v14
    v_add_f32 v5, v5, v15
    s_waitcnt lgkmcnt(0)
    v_mfma_f32_32x32x16_bf16 v[48:63], v[192:195], v[16:19], v[80:95]
    v_exp_f32 v64, v64
    v_exp_f32 v65, v65
    v_exp_f32 v66, v66
    v_exp_f32 v67, v67
    v_cvt_pk_bf16_f32 v184, v64, v65
    v_mfma_f32_32x32x16_bf16 v[48:63], v[196:199], v[20:23], v[48:63]
    v_exp_f32 v68, v68
    v_exp_f32 v69, v69
    v_cvt_pk_bf16_f32 v185, v66, v67
    v_add_f32 v14, v64, v66
    v_add_f32 v15, v65, v67
    v_mfma_f32_32x32x16_bf16 v[48:63], v[200:203], v[24:27], v[48:63]
    v_exp_f32 v70, v70
    v_exp_f32 v71, v71
    v_cvt_pk_bf16_f32 v186, v68, v69
    v_add_f32 v14, v14, v68
    v_add_f32 v15, v15, v69
    v_exp_f32 v72, v72
    v_mfma_f32_32x32x16_bf16 v[48:63], v[204:207], v[28:31], v[48:63]
    v_exp_f32 v73, v73
    v_cvt_pk_bf16_f32 v187, v70, v71
    v_add_f32 v14, v14, v70
    v_add_f32 v15, v15, v71
    v_exp_f32 v74, v74
    v_mfma_f32_32x32x16_bf16 v[112:127], v[240:243], v[176:179], v[112:127]
    v_exp_f32 v75, v75
    v_cvt_pk_bf16_f32 v188, v72, v73
    v_add_f32 v14, v14, v72
    v_add_f32 v15, v15, v73
    v_exp_f32 v76, v76
    v_mfma_f32_32x32x16_bf16 v[128:143], v[248:251], v[176:179], v[128:143]
    v_exp_f32 v77, v77
    v_cvt_pk_bf16_f32 v189, v74, v75
    v_add_f32 v14, v14, v74
    v_add_f32 v15, v15, v75
    v_exp_f32 v78, v78
    v_exp_f32 v79, v79
    v_mfma_f32_32x32x16_bf16 v[112:127], v[244:247], v[180:183], v[112:127]
    v_cvt_pk_bf16_f32 v190, v76, v77
    v_add_f32 v14, v14, v76
    v_add_f32 v15, v15, v77
    v_cvt_pk_bf16_f32 v191, v78, v79
    v_add_f32 v14, v14, v78
    v_mfma_f32_32x32x16_bf16 v[128:143], v[252:255], v[180:183], v[128:143]
    v_add_f32 v15, v15, v79
    v_add_f32 v13, v14, v15
    v_cmp_lt_f32 vcc, 0x44800000, v13
    s_nop 0
    s_cbranch_vccnz Lrs_attn_kernel_10
Lrs_attn_kernel_10_ret:
    v_add_f32 v6, v6, v14
    v_add_f32 v7, v7, v15
    s_waitcnt vmcnt(8)
    s_barrier
    v_mfma_f32_32x32x16_bf16 v[64:79], v[192:195], v[32:35], v[96:111]
    ds_read_b128 v[208:211], v3 offset:0
    ds_read_b128 v[212:215], v3 offset:1024
    v_exp_f32 v48, v48
    v_exp_f32 v49, v49
    v_exp_f32 v50, v50
    v_exp_f32 v51, v51
    v_cvt_pk_bf16_f32 v176, v48, v49
    v_mfma_f32_32x32x16_bf16 v[64:79], v[196:199], v[36:39], v[64:79]
    ds_read_b128 v[216:219], v3 offset:2048
    ds_read_b128 v[220:223], v3 offset:3072
    v_exp_f32 v52, v52
    v_exp_f32 v53, v53
    v_cvt_pk_bf16_f32 v177, v50, v51
    v_add_f32 v14, v48, v50
    v_add_f32 v15, v49, v51
    v_mfma_f32_32x32x16_bf16 v[64:79], v[200:203], v[40:43], v[64:79]
    ds_read_b128 v[224:227], v3 offset:4096
    ds_read_b128 v[228:231], v3 offset:5120
    v_exp_f32 v54, v54
    v_exp_f32 v55, v55
    v_cvt_pk_bf16_f32 v178, v52, v53
    v_add_f32 v14, v14, v52
    v_add_f32 v15, v15, v53
    v_exp_f32 v56, v56
    v_mfma_f32_32x32x16_bf16 v[64:79], v[204:207], v[44:47], v[64:79]
    ds_read_b128 v[232:235], v3 offset:6144
    ds_read_b128 v[236:239], v3 offset:7168
    v_exp_f32 v57, v57
    v_cvt_pk_bf16_f32 v179, v54, v55
    v_add_f32 v14, v14, v54
    v_add_f32 v15, v15, v55
    v_exp_f32 v58, v58
    v_mfma_f32_32x32x16_bf16 v[144:159], v[240:243], v[184:187], v[144:159]
    s_mov_b32 m0, s33
    s_nop 0
    buffer_load_dwordx4 v1, s[12:15], s28 offen lds
    buffer_load_dwordx4 v1, s[12:15], s28 offen offset:1024 lds
    v_exp_f32 v59, v59
    v_cvt_pk_bf16_f32 v180, v56, v57
    v_add_f32 v14, v14, v56
    v_add_f32 v15, v15, v57
    v_exp_f32 v60, v60
    v_mfma_f32_32x32x16_bf16 v[160:175], v[248:251], v[184:187], v[160:175]
    buffer_load_dwordx4 v1, s[12:15], s28 offen offset:2048 lds
    buffer_load_dwordx4 v1, s[12:15], s28 offen offset:3072 lds
    s_add_u32 s28, s28, 8192
    v_exp_f32 v61, v61
    v_cvt_pk_bf16_f32 v181, v58, v59
    v_add_f32 v14, v14, v58
    v_add_f32 v15, v15, v59
    v_exp_f32 v62, v62
    v_exp_f32 v63, v63
    v_mfma_f32_32x32x16_bf16 v[144:159], v[244:247], v[188:191], v[144:159]
    v_cvt_pk_bf16_f32 v182, v60, v61
    v_add_f32 v14, v14, v60
    v_add_f32 v15, v15, v61
    v_cvt_pk_bf16_f32 v183, v62, v63
    v_add_f32 v14, v14, v62
    v_mfma_f32_32x32x16_bf16 v[160:175], v[252:255], v[188:191], v[160:175]
    v_add_f32 v15, v15, v63
    v_add_f32 v13, v14, v15
    v_cmp_lt_f32 vcc, 0x44800000, v13
    s_nop 0
    s_cbranch_vccnz Lrs_attn_kernel_11
Lrs_attn_kernel_11_ret:
    v_add_f32 v4, v4, v14
    v_add_f32 v5, v5, v15
    s_waitcnt lgkmcnt(0)
    v_mfma_f32_32x32x16_bf16 v[48:63], v[208:211], v[16:19], v[80:95]
    v_exp_f32 v64, v64
    v_exp_f32 v65, v65
    v_exp_f32 v66, v66
    v_exp_f32 v67, v67
    v_cvt_pk_bf16_f32 v184, v64, v65
    v_mfma_f32_32x32x16_bf16 v[48:63], v[212:215], v[20:23], v[48:63]
    v_exp_f32 v68, v68
    v_exp_f32 v69, v69
    v_cvt_pk_bf16_f32 v185, v66, v67
    v_add_f32 v14, v64, v66
    v_add_f32 v15, v65, v67
    v_mfma_f32_32x32x16_bf16 v[48:63], v[216:219], v[24:27], v[48:63]
    v_exp_f32 v70, v70
    v_exp_f32 v71, v71
    v_cvt_pk_bf16_f32 v186, v68, v69
    v_add_f32 v14, v14, v68
    v_add_f32 v15, v15, v69
    v_exp_f32 v72, v72
    v_mfma_f32_32x32x16_bf16 v[48:63], v[220:223], v[28:31], v[48:63]
    v_exp_f32 v73, v73
    v_cvt_pk_bf16_f32 v187, v70, v71
    v_add_f32 v14, v14, v70
    v_add_f32 v15, v15, v71
    v_exp_f32 v74, v74
    v_mfma_f32_32x32x16_bf16 v[112:127], v[224:227], v[176:179], v[112:127]
    v_exp_f32 v75, v75
    v_cvt_pk_bf16_f32 v188, v72, v73
    v_add_f32 v14, v14, v72
    v_add_f32 v15, v15, v73
    v_exp_f32 v76, v76
    v_mfma_f32_32x32x16_bf16 v[128:143], v[232:235], v[176:179], v[128:143]
    v_exp_f32 v77, v77
    v_cvt_pk_bf16_f32 v189, v74, v75
    v_add_f32 v14, v14, v74
    v_add_f32 v15, v15, v75
    v_exp_f32 v78, v78
    v_exp_f32 v79, v79
    v_mfma_f32_32x32x16_bf16 v[112:127], v[228:231], v[180:183], v[112:127]
    v_cvt_pk_bf16_f32 v190, v76, v77
    v_add_f32 v14, v14, v76
    v_add_f32 v15, v15, v77
    v_cvt_pk_bf16_f32 v191, v78, v79
    v_add_f32 v14, v14, v78
    v_mfma_f32_32x32x16_bf16 v[128:143], v[236:239], v[180:183], v[128:143]
    v_add_f32 v15, v15, v79
    v_add_f32 v13, v14, v15
    v_cmp_lt_f32 vcc, 0x44800000, v13
    s_nop 0
    s_cbranch_vccnz Lrs_attn_kernel_12
Lrs_attn_kernel_12_ret:
    v_add_f32 v6, v6, v14
    v_add_f32 v7, v7, v15
    s_waitcnt vmcnt(8)
    s_barrier
    v_mfma_f32_32x32x16_bf16 v[64:79], v[208:211], v[32:35], v[96:111]
    ds_read_b128 v[192:195], v3 offset:32768
    ds_read_b128 v[196:199], v3 offset:33792
    v_exp_f32 v48, v48
    v_exp_f32 v49, v49
    v_exp_f32 v50, v50
    v_exp_f32 v51, v51
    v_cvt_pk_bf16_f32 v176, v48, v49
    v_mfma_f32_32x32x16_bf16 v[64:79], v[212:215], v[36:39], v[64:79]
    ds_read_b128 v[200:203], v3 offset:34816
    ds_read_b128 v[204:207], v3 offset:35840
    v_exp_f32 v52, v52
    v_exp_f32 v53, v53
    v_cvt_pk_bf16_f32 v177, v50, v51
    v_add_f32 v14, v48, v50
    v_add_f32 v15, v49, v51
    v_mfma_f32_32x32x16_bf16 v[64:79], v[216:219], v[40:43], v[64:79]
    ds_read_b128 v[240:243], v3 offset:36864
    ds_read_b128 v[244:247], v3 offset:37888
    v_exp_f32 v54, v54
    v_exp_f32 v55, v55
    v_cvt_pk_bf16_f32 v178, v52, v53
    v_add_f32 v14, v14, v52
    v_add_f32 v15, v15, v53
    v_exp_f32 v56, v56
    v_mfma_f32_32x32x16_bf16 v[64:79], v[220:223], v[44:47], v[64:79]
    ds_read_b128 v[248:251], v3 offset:38912
    ds_read_b128 v[252:255], v3 offset:39936
    v_exp_f32 v57, v57
    v_cvt_pk_bf16_f32 v179, v54, v55
    v_add_f32 v14, v14, v54
    v_add_f32 v15, v15, v55
    v_exp_f32 v58, v58
    v_mfma_f32_32x32x16_bf16 v[144:159], v[224:227], v[184:187], v[144:159]
    s_mov_b32 m0, s34
    s_nop 0
    buffer_load_dwordx4 v1, s[12:15], s28 offen lds
    buffer_load_dwordx4 v1, s[12:15], s28 offen offset:1024 lds
    v_exp_f32 v59, v59
    v_cvt_pk_bf16_f32 v180, v56, v57
    v_add_f32 v14, v14, v56
    v_add_f32 v15, v15, v57
    v_exp_f32 v60, v60
    v_mfma_f32_32x32x16_bf16 v[160:175], v[232:235], v[184:187], v[160:175]
    buffer_load_dwordx4 v1, s[12:15], s28 offen offset:2048 lds
    buffer_load_dwordx4 v1, s[12:15], s28 offen offset:3072 lds
    s_add_u32 s28, s28, 8192
    v_exp_f32 v61, v61
    v_cvt_pk_bf16_f32 v181, v58, v59
    v_add_f32 v14, v14, v58
    v_add_f32 v15, v15, v59
    v_exp_f32 v62, v62
    v_exp_f32 v63, v63
    v_mfma_f32_32x32x16_bf16 v[144:159], v[228:231], v[188:191], v[144:159]
    v_cvt_pk_bf16_f32 v182, v60, v61
    v_add_f32 v14, v14, v60
    v_add_f32 v15, v15, v61
    v_cvt_pk_bf16_f32 v183, v62, v63
    v_add_f32 v14, v14, v62
    v_mfma_f32_32x32x16_bf16 v[160:175], v[236:239], v[188:191], v[160:175]
    v_add_f32 v15, v15, v63
    v_add_f32 v13, v14, v15
    v_cmp_lt_f32 vcc, 0x44800000, v13
    s_nop 0
    s_cbranch_vccnz Lrs_attn_kernel_13
Lrs_attn_kernel_13_ret:
    v_add_f32 v4, v4, v14
    v_add_f32 v5, v5, v15
    s_waitcnt lgkmcnt(0)
    v_mfma_f32_32x32x16_bf16 v[48:63], v[192:195], v[16:19], v[80:95]
    v_exp_f32 v64, v64
    v_exp_f32 v65, v65
    v_exp_f32 v66, v66
    v_exp_f32 v67, v67
    v_cvt_pk_bf16_f32 v184, v64, v65
    v_mfma_f32_32x32x16_bf16 v[48:63], v[196:199], v[20:23], v[48:63]
    v_exp_f32 v68, v68
    v_exp_f32 v69, v69
    v_cvt_pk_bf16_f32 v185, v66, v67
    v_add_f32 v14, v64, v66
    v_add_f32 v15, v65, v67
    v_mfma_f32_32x32x16_bf16 v[48:63], v[200:203], v[24:27], v[48:63]
    v_exp_f32 v70, v70
    v_exp_f32 v71, v71
    v_cvt_pk_bf16_f32 v186, v68, v69
    v_add_f32 v14, v14, v68
    v_add_f32 v15, v15, v69
    v_exp_f32 v72, v72
    v_mfma_f32_32x32x16_bf16 v[48:63], v[204:207], v[28:31], v[48:63]
    v_exp_f32 v73, v73
    v_cvt_pk_bf16_f32 v187, v70, v71
    v_add_f32 v14, v14, v70
    v_add_f32 v15, v15, v71
    v_exp_f32 v74, v74
    v_mfma_f32_32x32x16_bf16 v[112:127], v[240:243], v[176:179], v[112:127]
    v_exp_f32 v75, v75
    v_cvt_pk_bf16_f32 v188, v72, v73
    v_add_f32 v14, v14, v72
    v_add_f32 v15, v15, v73
    v_exp_f32 v76, v76
    v_mfma_f32_32x32x16_bf16 v[128:143], v[248:251], v[176:179], v[128:143]
    v_exp_f32 v77, v77
    v_cvt_pk_bf16_f32 v189, v74, v75
    v_add_f32 v14, v14, v74
    v_add_f32 v15, v15, v75
    v_exp_f32 v78, v78
    v_exp_f32 v79, v79
    v_mfma_f32_32x32x16_bf16 v[112:127], v[244:247], v[180:183], v[112:127]
    v_cvt_pk_bf16_f32 v190, v76, v77
    v_add_f32 v14, v14, v76
    v_add_f32 v15, v15, v77
    v_cvt_pk_bf16_f32 v191, v78, v79
    v_add_f32 v14, v14, v78
    v_mfma_f32_32x32x16_bf16 v[128:143], v[252:255], v[180:183], v[128:143]
    v_add_f32 v15, v15, v79
    v_add_f32 v13, v14, v15
    v_cmp_lt_f32 vcc, 0x44800000, v13
    s_nop 0
    s_cbranch_vccnz Lrs_attn_kernel_14
Lrs_attn_kernel_14_ret:
    v_add_f32 v6, v6, v14
    v_add_f32 v7, v7, v15
    s_waitcnt vmcnt(8)
    s_barrier
    v_mfma_f32_32x32x16_bf16 v[64:79], v[192:195], v[32:35], v[96:111]
    ds_read_b128 v[208:211], v2 offset:0
    ds_read_b128 v[212:215], v2 offset:1024
    v_exp_f32 v48, v48
    v_exp_f32 v49, v49
    v_exp_f32 v50, v50
    v_exp_f32 v51, v51
    v_cvt_pk_bf16_f32 v176, v48, v49
    v_mfma_f32_32x32x16_bf16 v[64:79], v[196:199], v[36:39], v[64:79]
    ds_read_b128 v[216:219], v2 offset:2048
    ds_read_b128 v[220:223], v2 offset:3072
    v_exp_f32 v52, v52
    v_exp_f32 v53, v53
    v_cvt_pk_bf16_f32 v177, v50, v51
    v_add_f32 v14, v48, v50
    v_add_f32 v15, v49, v51
    v_mfma_f32_32x32x16_bf16 v[64:79], v[200:203], v[40:43], v[64:79]
    ds_read_b128 v[224:227], v2 offset:4096
    ds_read_b128 v[228:231], v2 offset:5120
    v_exp_f32 v54, v54
    v_exp_f32 v55, v55
    v_cvt_pk_bf16_f32 v178, v52, v53
    v_add_f32 v14, v14, v52
    v_add_f32 v15, v15, v53
    v_exp_f32 v56, v56
    v_mfma_f32_32x32x16_bf16 v[64:79], v[204:207], v[44:47], v[64:79]
    ds_read_b128 v[232:235], v2 offset:6144
    ds_read_b128 v[236:239], v2 offset:7168
    v_exp_f32 v57, v57
    v_cvt_pk_bf16_f32 v179, v54, v55
    v_add_f32 v14, v14, v54
    v_add_f32 v15, v15, v55
    v_exp_f32 v58, v58
    v_mfma_f32_32x32x16_bf16 v[144:159], v[240:243], v[184:187], v[144:159]
    s_mov_b32 m0, s35
    s_nop 0
    buffer_load_dwordx4 v1, s[12:15], s28 offen lds
    buffer_load_dwordx4 v1, s[12:15], s28 offen offset:1024 lds
    v_exp_f32 v59, v59
    v_cvt_pk_bf16_f32 v180, v56, v57
    v_add_f32 v14, v14, v56
    v_add_f32 v15, v15, v57
    v_exp_f32 v60, v60
    v_mfma_f32_32x32x16_bf16 v[160:175], v[248:251], v[184:187], v[160:175]
    buffer_load_dwordx4 v1, s[12:15], s28 offen offset:2048 lds
    buffer_load_dwordx4 v1, s[12:15], s28 offen offset:3072 lds
    s_add_u32 s28, s28, 8192
    v_exp_f32 v61, v61
    v_cvt_pk_bf16_f32 v181, v58, v59
    v_add_f32 v14, v14, v58
    v_add_f32 v15, v15, v59
    v_exp_f32 v62, v62
    v_exp_f32 v63, v63
    v_mfma_f32_32x32x16_bf16 v[144:159], v[244:247], v[188:191], v[144:159]
    v_cvt_pk_bf16_f32 v182, v60, v61
    v_add_f32 v14, v14, v60
    v_add_f32 v15, v15, v61
    v_cvt_pk_bf16_f32 v183, v62, v63
    v_add_f32 v14, v14, v62
    v_mfma_f32_32x32x16_bf16 v[160:175], v[252:255], v[188:191], v[160:175]
    v_add_f32 v15, v15, v63
    v_add_f32 v13, v14, v15
    v_cmp_lt_f32 vcc, 0x44800000, v13
    s_nop 0
    s_cbranch_vccnz Lrs_attn_kernel_15
Lrs_attn_kernel_15_ret:
    v_add_f32 v4, v4, v14
    v_add_f32 v5, v5, v15
    s_cmp_eq_u32 s18, 3
    s_nop 2
    s_cbranch_scc0 Lni_attn_kernel_16
    v_mov_b32 v80, 0xff800000
    v_mov_b32 v81, 0xff800000
    v_mov_b32 v82, 0xff800000
    v_mov_b32 v83, 0xff800000
    v_mov_b32 v84, 0xff800000
    v_mov_b32 v85, 0xff800000
    v_mov_b32 v86, 0xff800000
    v_mov_b32 v87, 0xff800000
    v_mov_b32 v88, 0xff800000
    v_mov_b32 v89, 0xff800000
    v_mov_b32 v90, 0xff800000
    v_mov_b32 v91, 0xff800000
    v_mov_b32 v92, 0xff800000
    v_mov_b32 v93, 0xff800000
    v_mov_b32 v94, 0xff800000
    v_mov_b32 v95, 0xff800000
    s_nop 0
Lni_attn_kernel_16:
    s_waitcnt lgkmcnt(0)
    v_mfma_f32_32x32x16_bf16 v[48:63], v[208:211], v[16:19], v[80:95]
    v_exp_f32 v64, v64
    v_exp_f32 v65, v65
    v_exp_f32 v66, v66
    v_exp_f32 v67, v67
    v_cvt_pk_bf16_f32 v184, v64, v65
    v_mfma_f32_32x32x16_bf16 v[48:63], v[212:215], v[20:23], v[48:63]
    v_exp_f32 v68, v68
    v_exp_f32 v69, v69
    v_cvt_pk_bf16_f32 v185, v66, v67
    v_add_f32 v14, v64, v66
    v_add_f32 v15, v65, v67
    v_mfma_f32_32x32x16_bf16 v[48:63], v[216:219], v[24:27], v[48:63]
    v_exp_f32 v70, v70
    v_exp_f32 v71, v71
    v_cvt_pk_bf16_f32 v186, v68, v69
    v_add_f32 v14, v14, v68
    v_add_f32 v15, v15, v69
    v_exp_f32 v72, v72
    v_mfma_f32_32x32x16_bf16 v[48:63], v[220:223], v[28:31], v[48:63]
    v_exp_f32 v73, v73
    v_cvt_pk_bf16_f32 v187, v70, v71
    v_add_f32 v14, v14, v70
    v_add_f32 v15, v15, v71
    v_exp_f32 v74, v74
    v_mfma_f32_32x32x16_bf16 v[112:127], v[224:227], v[176:179], v[112:127]
    v_exp_f32 v75, v75
    v_cvt_pk_bf16_f32 v188, v72, v73
    v_add_f32 v14, v14, v72
    v_add_f32 v15, v15, v73
    v_exp_f32 v76, v76
    v_mfma_f32_32x32x16_bf16 v[128:143], v[232:235], v[176:179], v[128:143]
    v_exp_f32 v77, v77
    v_cvt_pk_bf16_f32 v189, v74, v75
    v_add_f32 v14, v14, v74
    v_add_f32 v15, v15, v75
    v_exp_f32 v78, v78
    v_exp_f32 v79, v79
    v_mfma_f32_32x32x16_bf16 v[112:127], v[228:231], v[180:183], v[112:127]
    v_cvt_pk_bf16_f32 v190, v76, v77
    v_add_f32 v14, v14, v76
    v_add_f32 v15, v15, v77
    v_cvt_pk_bf16_f32 v191, v78, v79
    v_add_f32 v14, v14, v78
    v_mfma_f32_32x32x16_bf16 v[128:143], v[236:239], v[180:183], v[128:143]
    v_add_f32 v15, v15, v79
    v_add_f32 v13, v14, v15
    v_cmp_lt_f32 vcc, 0x44800000, v13
    s_nop 0
    s_cbranch_vccnz Lrs_attn_kernel_17
Lrs_attn_kernel_17_ret:
    v_add_f32 v6, v6, v14
    v_add_f32 v7, v7, v15
    s_waitcnt vmcnt(8)
    s_barrier
    s_cmp_eq_u32 s18, 3
    s_nop 0
    s_cbranch_scc0 Lni_attn_kernel_18
    v_mov_b32 v96, 0xff800000
    v_mov_b32 v97, 0xff800000
    v_mov_b32 v98, 0xff800000
    v_mov_b32 v99, 0xff800000
    v_mov_b32 v100, 0xff800000
    v_mov_b32 v101, 0xff800000
    v_mov_b32 v102, 0xff800000
    v_mov_b32 v103, 0xff800000
    v_mov_b32 v104, 0xff800000
    v_mov_b32 v105, 0xff800000
    v_mov_b32 v106, 0xff800000
    v_mov_b32 v107, 0xff800000
    v_mov_b32 v108, 0xff800000
    v_mov_b32 v109, 0xff800000
    v_mov_b32 v110, 0xff800000
    v_mov_b32 v111, 0xff800000
    s_nop 0
Lni_attn_kernel_18:
    s_nop 0
    v_mfma_f32_32x32x16_bf16 v[64:79], v[208:211], v[32:35], v[96:111]
    ds_read_b128 v[192:195], v2 offset:32768
    ds_read_b128 v[196:199], v2 offset:33792
    v_exp_f32 v48, v48
    v_exp_f32 v49, v49
    v_exp_f32 v50, v50
    v_exp_f32 v51, v51
    v_cvt_pk_bf16_f32 v176, v48, v49
    v_mfma_f32_32x32x16_bf16 v[64:79], v[212:215], v[36:39], v[64:79]
    ds_read_b128 v[200:203], v2 offset:34816
    ds_read_b128 v[204:207], v2 offset:35840
    v_exp_f32 v52, v52
    v_exp_f32 v53, v53
    v_cvt_pk_bf16_f32 v177, v50, v51
    v_add_f32 v14, v48, v50
    v_add_f32 v15, v49, v51
    v_mfma_f32_32x32x16_bf16 v[64:79], v[216:219], v[40:43], v[64:79]
    ds_read_b128 v[240:243], v2 offset:36864
    ds_read_b128 v[244:247], v2 offset:37888
    v_exp_f32 v54, v54
    v_exp_f32 v55, v55
    v_cvt_pk_bf16_f32 v178, v52, v53
    v_add_f32 v14, v14, v52
    v_add_f32 v15, v15, v53
    v_exp_f32 v56, v56
    v_mfma_f32_32x32x16_bf16 v[64:79], v[220:223], v[44:47], v[64:79]
    ds_read_b128 v[248:251], v2 offset:38912
    ds_read_b128 v[252:255], v2 offset:39936
    v_exp_f32 v57, v57
    v_cvt_pk_bf16_f32 v179, v54, v55
    v_add_f32 v14, v14, v54
    v_add_f32 v15, v15, v55
    v_exp_f32 v58, v58
    v_mfma_f32_32x32x16_bf16 v[144:159], v[224:227], v[184:187], v[144:159]
    v_exp_f32 v59, v59
    v_cvt_pk_bf16_f32 v180, v56, v57
    v_add_f32 v14, v14, v56
    v_add_f32 v15, v15, v57
    v_exp_f32 v60, v60
    v_mfma_f32_32x32x16_bf16 v[160:175], v[232:235], v[184:187], v[160:175]
    v_exp_f32 v61, v61
    v_cvt_pk_bf16_f32 v181, v58, v59
    v_add_f32 v14, v14, v58
    v_add_f32 v15, v15, v59
    v_exp_f32 v62, v62
    v_exp_f32 v63, v63
    v_mfma_f32_32x32x16_bf16 v[144:159], v[228:231], v[188:191], v[144:159]
    v_cvt_pk_bf16_f32 v182, v60, v61
    v_add_f32 v14, v14, v60
    v_add_f32 v15, v15, v61
    v_cvt_pk_bf16_f32 v183, v62, v63
    v_add_f32 v14, v14, v62
    v_mfma_f32_32x32x16_bf16 v[160:175], v[236:239], v[188:191], v[160:175]
    v_add_f32 v15, v15, v63
    v_add_f32 v13, v14, v15
    v_cmp_lt_f32 vcc, 0x44800000, v13
    s_nop 0
    s_cbranch_vccnz Lrs_attn_kernel_19
Lrs_attn_kernel_19_ret:
    v_add_f32 v4, v4, v14
    v_add_f32 v5, v5, v15
    s_waitcnt lgkmcnt(0)
    v_mfma_f32_32x32x16_bf16 v[48:63], v[192:195], v[16:19], v[80:95]
    v_exp_f32 v64, v64
    v_exp_f32 v65, v65
    v_exp_f32 v66, v66
    v_exp_f32 v67, v67
    v_cvt_pk_bf16_f32 v184, v64, v65
    v_mfma_f32_32x32x16_bf16 v[48:63], v[196:199], v[20:23], v[48:63]
    v_exp_f32 v68, v68
    v_exp_f32 v69, v69
    v_cvt_pk_bf16_f32 v185, v66, v67
    v_add_f32 v14, v64, v66
    v_add_f32 v15, v65, v67
    v_mfma_f32_32x32x16_bf16 v[48:63], v[200:203], v[24:27], v[48:63]
    v_exp_f32 v70, v70
    v_exp_f32 v71, v71
    v_cvt_pk_bf16_f32 v186, v68, v69
    v_add_f32 v14, v14, v68
    v_add_f32 v15, v15, v69
    v_exp_f32 v72, v72
    v_mfma_f32_32x32x16_bf16 v[48:63], v[204:207], v[28:31], v[48:63]
    v_exp_f32 v73, v73
    v_cvt_pk_bf16_f32 v187, v70, v71
    v_add_f32 v14, v14, v70
    v_add_f32 v15, v15, v71
    v_exp_f32 v74, v74
    v_mfma_f32_32x32x16_bf16 v[112:127], v[240:243], v[176:179], v[112:127]
    v_exp_f32 v75, v75
    v_cvt_pk_bf16_f32 v188, v72, v73
    v_add_f32 v14, v14, v72
    v_add_f32 v15, v15, v73
    v_exp_f32 v76, v76
    v_mfma_f32_32x32x16_bf16 v[128:143], v[248:251], v[176:179], v[128:143]
    v_exp_f32 v77, v77
    v_cvt_pk_bf16_f32 v189, v74, v75
    v_add_f32 v14, v14, v74
    v_add_f32 v15, v15, v75
    v_exp_f32 v78, v78
    v_exp_f32 v79, v79
    v_mfma_f32_32x32x16_bf16 v[112:127], v[244:247], v[180:183], v[112:127]
    v_cvt_pk_bf16_f32 v190, v76, v77
    v_add_f32 v14, v14, v76
    v_add_f32 v15, v15, v77
    v_cvt_pk_bf16_f32 v191, v78, v79
    v_add_f32 v14, v14, v78
    v_mfma_f32_32x32x16_bf16 v[128:143], v[252:255], v[180:183], v[128:143]
    v_add_f32 v15, v15, v79
    v_add_f32 v13, v14, v15
    v_cmp_lt_f32 vcc, 0x44800000, v13
    s_nop 0
    s_cbranch_vccnz Lrs_attn_kernel_20
Lrs_attn_kernel_20_ret:
    v_add_f32 v6, v6, v14
    v_add_f32 v7, v7, v15
    s_waitcnt vmcnt(4)
    s_barrier
    v_mfma_f32_32x32x16_bf16 v[64:79], v[192:195], v[32:35], v[96:111]
    ds_read_b128 v[208:211], v3 offset:0
    ds_read_b128 v[212:215], v3 offset:1024
    v_exp_f32 v48, v48
    v_exp_f32 v49, v49
    v_exp_f32 v50, v50
    v_exp_f32 v51, v51
    v_cvt_pk_bf16_f32 v176, v48, v49
    v_mfma_f32_32x32x16_bf16 v[64:79], v[196:199], v[36:39], v[64:79]
    ds_read_b128 v[216:219], v3 offset:2048
    ds_read_b128 v[220:223], v3 offset:3072
    v_exp_f32 v52, v52
    v_exp_f32 v53, v53
    v_cvt_pk_bf16_f32 v177, v50, v51
    v_add_f32 v14, v48, v50
    v_add_f32 v15, v49, v51
    v_mfma_f32_32x32x16_bf16 v[64:79], v[200:203], v[40:43], v[64:79]
    ds_read_b128 v[224:227], v3 offset:4096
    ds_read_b128 v[228:231], v3 offset:5120
    v_exp_f32 v54, v54
    v_exp_f32 v55, v55
    v_cvt_pk_bf16_f32 v178, v52, v53
    v_add_f32 v14, v14, v52
    v_add_f32 v15, v15, v53
    v_exp_f32 v56, v56
    v_mfma_f32_32x32x16_bf16 v[64:79], v[204:207], v[44:47], v[64:79]
    ds_read_b128 v[232:235], v3 offset:6144
    ds_read_b128 v[236:239], v3 offset:7168
    v_exp_f32 v57, v57
    v_cvt_pk_bf16_f32 v179, v54, v55
    v_add_f32 v14, v14, v54
    v_add_f32 v15, v15, v55
    v_exp_f32 v58, v58
    v_mfma_f32_32x32x16_bf16 v[144:159], v[240:243], v[184:187], v[144:159]
    v_exp_f32 v59, v59
    v_cvt_pk_bf16_f32 v180, v56, v57
    v_add_f32 v14, v14, v56
    v_add_f32 v15, v15, v57
    v_exp_f32 v60, v60
    v_mfma_f32_32x32x16_bf16 v[160:175], v[248:251], v[184:187], v[160:175]
    v_exp_f32 v61, v61
    v_cvt_pk_bf16_f32 v181, v58, v59
    v_add_f32 v14, v14, v58
    v_add_f32 v15, v15, v59
    v_exp_f32 v62, v62
    v_exp_f32 v63, v63
    v_mfma_f32_32x32x16_bf16 v[144:159], v[244:247], v[188:191], v[144:159]
    v_cvt_pk_bf16_f32 v182, v60, v61
    v_add_f32 v14, v14, v60
    v_add_f32 v15, v15, v61
    v_cvt_pk_bf16_f32 v183, v62, v63
    v_add_f32 v14, v14, v62
    v_mfma_f32_32x32x16_bf16 v[160:175], v[252:255], v[188:191], v[160:175]
    v_add_f32 v15, v15, v63
    v_add_f32 v13, v14, v15
    v_cmp_lt_f32 vcc, 0x44800000, v13
    s_nop 0
    s_cbranch_vccnz Lrs_attn_kernel_21
Lrs_attn_kernel_21_ret:
    v_add_f32 v4, v4, v14
    v_add_f32 v5, v5, v15
    s_waitcnt lgkmcnt(0)
    v_mfma_f32_32x32x16_bf16 v[48:63], v[208:211], v[16:19], v[80:95]
    v_exp_f32 v64, v64
    v_exp_f32 v65, v65
    v_exp_f32 v66, v66
    v_exp_f32 v67, v67
    v_cvt_pk_bf16_f32 v184, v64, v65
    v_mfma_f32_32x32x16_bf16 v[48:63], v[212:215], v[20:23], v[48:63]
    v_exp_f32 v68, v68
    v_exp_f32 v69, v69
    v_cvt_pk_bf16_f32 v185, v66, v67
    v_add_f32 v14, v64, v66
    v_add_f32 v15, v65, v67
    v_mfma_f32_32x32x16_bf16 v[48:63], v[216:219], v[24:27], v[48:63]
    v_exp_f32 v70, v70
    v_exp_f32 v71, v71
    v_cvt_pk_bf16_f32 v186, v68, v69
    v_add_f32 v14, v14, v68
    v_add_f32 v15, v15, v69
    v_exp_f32 v72, v72
    v_mfma_f32_32x32x16_bf16 v[48:63], v[220:223], v[28:31], v[48:63]
    v_exp_f32 v73, v73
    v_cvt_pk_bf16_f32 v187, v70, v71
    v_add_f32 v14, v14, v70
    v_add_f32 v15, v15, v71
    v_exp_f32 v74, v74
    v_mfma_f32_32x32x16_bf16 v[112:127], v[224:227], v[176:179], v[112:127]
    v_exp_f32 v75, v75
    v_cvt_pk_bf16_f32 v188, v72, v73
    v_add_f32 v14, v14, v72
    v_add_f32 v15, v15, v73
    v_exp_f32 v76, v76
    v_mfma_f32_32x32x16_bf16 v[128:143], v[232:235], v[176:179], v[128:143]
    v_exp_f32 v77, v77
    v_cvt_pk_bf16_f32 v189, v74, v75
    v_add_f32 v14, v14, v74
    v_add_f32 v15, v15, v75
    v_exp_f32 v78, v78
    v_exp_f32 v79, v79
    v_mfma_f32_32x32x16_bf16 v[112:127], v[228:231], v[180:183], v[112:127]
    v_cvt_pk_bf16_f32 v190, v76, v77
    v_add_f32 v14, v14, v76
    v_add_f32 v15, v15, v77
    v_cvt_pk_bf16_f32 v191, v78, v79
    v_add_f32 v14, v14, v78
    v_mfma_f32_32x32x16_bf16 v[128:143], v[236:239], v[180:183], v[128:143]
    v_add_f32 v15, v15, v79
    v_add_f32 v13, v14, v15
    v_cmp_lt_f32 vcc, 0x44800000, v13
    s_nop 0
    s_cbranch_vccnz Lrs_attn_kernel_22
Lrs_attn_kernel_22_ret:
    v_add_f32 v6, v6, v14
    v_add_f32 v7, v7, v15
    s_waitcnt vmcnt(0)
    s_barrier
    v_mfma_f32_32x32x16_bf16 v[64:79], v[208:211], v[32:35], v[96:111]
    ds_read_b128 v[240:243], v3 offset:36864
    v_exp_f32 v48, v48
    v_exp_f32 v49, v49
    v_exp_f32 v50, v50
    v_exp_f32 v51, v51
    v_cvt_pk_bf16_f32 v176, v48, v49
    v_mfma_f32_32x32x16_bf16 v[64:79], v[212:215], v[36:39], v[64:79]
    ds_read_b128 v[244:247], v3 offset:37888
    v_exp_f32 v52, v52
    v_exp_f32 v53, v53
    v_cvt_pk_bf16_f32 v177, v50, v51
    v_add_f32 v14, v48, v50
    v_add_f32 v15, v49, v51
    v_mfma_f32_32x32x16_bf16 v[64:79], v[216:219], v[40:43], v[64:79]
    ds_read_b128 v[248:251], v3 offset:38912
    v_exp_f32 v54, v54
    v_exp_f32 v55, v55
    v_cvt_pk_bf16_f32 v178, v52, v53
    v_add_f32 v14, v14, v52
    v_add_f32 v15, v15, v53
    v_exp_f32 v56, v56
    v_mfma_f32_32x32x16_bf16 v[64:79], v[220:223], v[44:47], v[64:79]
    ds_read_b128 v[252:255], v3 offset:39936
    v_exp_f32 v57, v57
    v_cvt_pk_bf16_f32 v179, v54, v55
    v_add_f32 v14, v14, v54
    v_add_f32 v15, v15, v55
    v_exp_f32 v58, v58
    v_mfma_f32_32x32x16_bf16 v[144:159], v[224:227], v[184:187], v[144:159]
    v_exp_f32 v59, v59
    v_cvt_pk_bf16_f32 v180, v56, v57
    v_add_f32 v14, v14, v56
    v_add_f32 v15, v15, v57
    v_exp_f32 v60, v60
    v_mfma_f32_32x32x16_bf16 v[160:175], v[232:235], v[184:187], v[160:175]
    v_exp_f32 v61, v61
    v_cvt_pk_bf16_f32 v181, v58, v59
    v_add_f32 v14, v14, v58
    v_add_f32 v15, v15, v59
    v_exp_f32 v62, v62
    v_exp_f32 v63, v63
    v_mfma_f32_32x32x16_bf16 v[144:159], v[228:231], v[188:191], v[144:159]
    v_cvt_pk_bf16_f32 v182, v60, v61
    v_add_f32 v14, v14, v60
    v_add_f32 v15, v15, v61
    v_cvt_pk_bf16_f32 v183, v62, v63
    v_add_f32 v14, v14, v62
    v_mfma_f32_32x32x16_bf16 v[160:175], v[236:239], v[188:191], v[160:175]
    v_add_f32 v15, v15, v63
    v_add_f32 v13, v14, v15
    v_cmp_lt_f32 vcc, 0x44800000, v13
    s_nop 0
    s_cbranch_vccnz Lrs_attn_kernel_23
Lrs_attn_kernel_23_ret:
    v_add_f32 v4, v4, v14
    v_add_f32 v5, v5, v15
    s_waitcnt lgkmcnt(0)
    v_mfma_f32_32x32x16_bf16 v[112:127], v[240:243], v[176:179], v[112:127]
    v_exp_f32 v64, v64
    v_exp_f32 v65, v65
    v_exp_f32 v66, v66
    v_exp_f32 v67, v67
    v_cvt_pk_bf16_f32 v184, v64, v65
    v_exp_f32 v68, v68
    v_exp_f32 v69, v69
    v_cvt_pk_bf16_f32 v185, v66, v67
    v_add_f32 v14, v64, v66
    v_add_f32 v15, v65, v67
    v_mfma_f32_32x32x16_bf16 v[128:143], v[248:251], v[176:179], v[128:143]
    v_exp_f32 v70, v70
    v_exp_f32 v71, v71
    v_cvt_pk_bf16_f32 v186, v68, v69
    v_add_f32 v14, v14, v68
    v_add_f32 v15, v15, v69
    v_exp_f32 v72, v72
    v_exp_f32 v73, v73
    v_cvt_pk_bf16_f32 v187, v70, v71
    v_add_f32 v14, v14, v70
    v_add_f32 v15, v15, v71
    v_exp_f32 v74, v74
    v_mfma_f32_32x32x16_bf16 v[112:127], v[244:247], v[180:183], v[112:127]
    v_exp_f32 v75, v75
    v_cvt_pk_bf16_f32 v188, v72, v73
    v_add_f32 v14, v14, v72
    v_add_f32 v15, v15, v73
    v_exp_f32 v76, v76
    v_exp_f32 v77, v77
    v_cvt_pk_bf16_f32 v189, v74, v75
    v_add_f32 v14, v14, v74
    v_add_f32 v15, v15, v75
    v_exp_f32 v78, v78
    v_exp_f32 v79, v79
    v_mfma_f32_32x32x16_bf16 v[128:143], v[252:255], v[180:183], v[128:143]
    v_cvt_pk_bf16_f32 v190, v76, v77
    v_add_f32 v14, v14, v76
    v_add_f32 v15, v15, v77
    v_cvt_pk_bf16_f32 v191, v78, v79
    v_add_f32 v14, v14, v78
    v_add_f32 v15, v15, v79
    v_add_f32 v13, v14, v15
    v_cmp_lt_f32 vcc, 0x44800000, v13
    s_nop 0
    s_cbranch_vccnz Lrs_attn_kernel_24
Lrs_attn_kernel_24_ret:
    v_add_f32 v6, v6, v14
    v_add_f32 v7, v7, v15
    v_mfma_f32_32x32x16_bf16 v[144:159], v[240:243], v[184:187], v[144:159]
    v_mfma_f32_32x32x16_bf16 v[160:175], v[248:251], v[184:187], v[160:175]
    v_mfma_f32_32x32x16_bf16 v[144:159], v[244:247], v[188:191], v[144:159]
    v_mfma_f32_32x32x16_bf16 v[160:175], v[252:255], v[188:191], v[160:175]
    v_add_f32 v4, v4, v5
    v_mov_b32 v10, v4
    v_mov_b32 v11, v4
    s_nop 1
    v_permlane32_swap_b32 v10, v11
    v_add_f32 v4, v10, v11
    v_add_f32 v6, v6, v7
    v_mov_b32 v10, v6
    v_mov_b32 v11, v6
    s_nop 1
    v_permlane32_swap_b32 v10, v11
    v_add_f32 v6, v10, v11
    s_barrier
    s_lshl_b32 s31, s16, 14
    v_add_u32 v2, s31, v1
    s_lshl_b32 s31, s16, 10
    s_add_u32 s31, s31, 0x20000
    v_lshrrev_b32 v3, 1, v1
    v_add_u32 v3, s31, v3
    ds_write_b128 v2, v[112:115] offset:0
    ds_write_b128 v2, v[116:119] offset:1024
    ds_write_b128 v2, v[120:123] offset:2048
    ds_write_b128 v2, v[124:127] offset:3072
    ds_write_b128 v2, v[128:131] offset:4096
    ds_write_b128 v2, v[132:135] offset:5120
    ds_write_b128 v2, v[136:139] offset:6144
    ds_write_b128 v2, v[140:143] offset:7168
    ds_write_b128 v2, v[144:147] offset:8192
    ds_write_b128 v2, v[148:151] offset:9216
    ds_write_b128 v2, v[152:155] offset:10240
    ds_write_b128 v2, v[156:159] offset:11264
    ds_write_b128 v2, v[160:163] offset:12288
    ds_write_b128 v2, v[164:167] offset:13312
    ds_write_b128 v2, v[168:171] offset:14336
    ds_write_b128 v2, v[172:175] offset:15360
    v_mov_b32 v10, v8
    v_mov_b32 v11, v4
    ds_write_b64 v3, v[10:11] offset:0
    v_mov_b32 v10, v9
    v_mov_b32 v11, v6
    ds_write_b64 v3, v[10:11] offset:512
    s_waitcnt lgkmcnt(0)
    s_barrier
    s_lshl_b32 s31, s17, 14
    s_lshl_b32 s36, s18, 12
    s_add_u32 s31, s31, s36
    v_add_u32 v2, s31, v1
    v_add_u32 v192, 0x10000, v2
    s_lshl_b32 s31, s17, 10
    s_lshr_b32 s36, s18, 1
    s_lshl_b32 s36, s36, 9
    s_add_u32 s31, s31, s36
    s_add_u32 s31, s31, 0x20000
    v_lshrrev_b32 v3, 1, v1
    v_add_u32 v3, s31, v3
    ds_read_b64 v[16:17], v3 offset:0
    ds_read_b64 v[18:19], v3 offset:2048
    ds_read_b64 v[20:21], v3 offset:4096
    ds_read_b64 v[22:23], v3 offset:6144
    ds_read_b128 v[48:51], v2 offset:0
    ds_read_b128 v[52:55], v2 offset:1024
    ds_read_b128 v[56:59], v2 offset:2048
    ds_read_b128 v[60:63], v2 offset:3072
    ds_read_b128 v[64:67], v2 offset:32768
    ds_read_b128 v[68:71], v2 offset:33792
    ds_read_b128 v[72:75], v2 offset:34816
    ds_read_b128 v[76:79], v2 offset:35840
    ds_read_b128 v[80:83], v192 offset:0
    ds_read_b128 v[84:87], v192 offset:1024
    ds_read_b128 v[88:91], v192 offset:2048
    ds_read_b128 v[92:95], v192 offset:3072
    ds_read_b128 v[96:99], v192 offset:32768
    ds_read_b128 v[100:103], v192 offset:33792
    ds_read_b128 v[104:107], v192 offset:34816
    ds_read_b128 v[108:111], v192 offset:35840
    s_waitcnt lgkmcnt(0)
    v_max_f32 v24, v16, v18
    v_max3_f32 v24, v24, v20, v22
    v_sub_f32 v25, v16, v24
    v_sub_f32 v26, v18, v24
    v_sub_f32 v27, v20, v24
    v_sub_f32 v28, v22, v24
    v_exp_f32 v25, v25
    v_exp_f32 v26, v26
    v_exp_f32 v27, v27
    v_exp_f32 v28, v28
    s_nop 0
    v_mul_f32 v29, v25, v17
    v_fmac_f32 v29, v26, v19
    v_fmac_f32 v29, v27, v21
    v_fmac_f32 v29, v28, v23
    v_rcp_f32 v29, v29
    s_nop 0
    v_mul_f32 v25, v25, v29
    v_mul_f32 v26, v26, v29
    v_mul_f32 v27, v27, v29
    v_mul_f32 v28, v28, v29
    v_mul_f32 v48, v48, v25
    v_mul_f32 v49, v49, v25
    v_mul_f32 v50, v50, v25
    v_mul_f32 v51, v51, v25
    v_mul_f32 v52, v52, v25
    v_mul_f32 v53, v53, v25
    v_mul_f32 v54, v54, v25
    v_mul_f32 v55, v55, v25
    v_mul_f32 v56, v56, v25
    v_mul_f32 v57, v57, v25
    v_mul_f32 v58, v58, v25
    v_mul_f32 v59, v59, v25
    v_mul_f32 v60, v60, v25
    v_mul_f32 v61, v61, v25
    v_mul_f32 v62, v62, v25
    v_mul_f32 v63, v63, v25
    v_fmac_f32 v48, v64, v26
    v_fmac_f32 v49, v65, v26
    v_fmac_f32 v50, v66, v26
    v_fmac_f32 v51, v67, v26
    v_fmac_f32 v52, v68, v26
    v_fmac_f32 v53, v69, v26
    v_fmac_f32 v54, v70, v26
    v_fmac_f32 v55, v71, v26
    v_fmac_f32 v56, v72, v26
    v_fmac_f32 v57, v73, v26
    v_fmac_f32 v58, v74, v26
    v_fmac_f32 v59, v75, v26
    v_fmac_f32 v60, v76, v26
    v_fmac_f32 v61, v77, v26
    v_fmac_f32 v62, v78, v26
    v_fmac_f32 v63, v79, v26
    v_fmac_f32 v48, v80, v27
    v_fmac_f32 v49, v81, v27
    v_fmac_f32 v50, v82, v27
    v_fmac_f32 v51, v83, v27
    v_fmac_f32 v52, v84, v27
    v_fmac_f32 v53, v85, v27
    v_fmac_f32 v54, v86, v27
    v_fmac_f32 v55, v87, v27
    v_fmac_f32 v56, v88, v27
    v_fmac_f32 v57, v89, v27
    v_fmac_f32 v58, v90, v27
    v_fmac_f32 v59, v91, v27
    v_fmac_f32 v60, v92, v27
    v_fmac_f32 v61, v93, v27
    v_fmac_f32 v62, v94, v27
    v_fmac_f32 v63, v95, v27
    v_fmac_f32 v48, v96, v28
    v_fmac_f32 v49, v97, v28
    v_fmac_f32 v50, v98, v28
    v_fmac_f32 v51, v99, v28
    v_fmac_f32 v52, v100, v28
    v_fmac_f32 v53, v101, v28
    v_fmac_f32 v54, v102, v28
    v_fmac_f32 v55, v103, v28
    v_fmac_f32 v56, v104, v28
    v_fmac_f32 v57, v105, v28
    v_fmac_f32 v58, v106, v28
    v_fmac_f32 v59, v107, v28
    v_fmac_f32 v60, v108, v28
    v_fmac_f32 v61, v109, v28
    v_fmac_f32 v62, v110, v28
    v_fmac_f32 v63, v111, v28
    v_cvt_pk_bf16_f32 v32, v48, v49
    v_cvt_pk_bf16_f32 v33, v50, v51
    v_cvt_pk_bf16_f32 v34, v52, v53
    v_cvt_pk_bf16_f32 v35, v54, v55
    v_cvt_pk_bf16_f32 v36, v56, v57
    v_cvt_pk_bf16_f32 v37, v58, v59
    v_cvt_pk_bf16_f32 v38, v60, v61
    v_cvt_pk_bf16_f32 v39, v62, v63
    s_lshr_b32 s36, s18, 1
    s_add_u32 s36, s36, s21
    s_cmp_gt_u32 s36, 124
    s_cbranch_scc1 L_k2_end_attn_kernel
    s_lshr_b32 s37, s19, 2
    s_mul_i32 s37, s37, 125
    s_add_u32 s36, s36, s37
    s_lshl_b32 s36, s36, 14
    s_and_b32 s37, s19, 3
    s_lshl_b32 s37, s37, 12
    s_add_u32 s36, s36, s37
    s_and_b32 s37, s18, 1
    s_lshl_b32 s37, s37, 11
    s_add_u32 s36, s36, s37
    s_add_u32 s36, s36, 25165824
    buffer_store_dwordx4 v[32:35], v1, s[12:15], s36 offen
    buffer_store_dwordx4 v[36:39], v1, s[12:15], s36 offen offset:1024
    s_nop 0
    s_branch L_k2_end_attn_kernel
Lrs_attn_kernel_1:
    s_nop 12
    v_mfma_f32_32x32x16_bf16 v[48:63], v[208:211], v[16:19], v[80:95]
    v_mfma_f32_32x32x16_bf16 v[48:63], v[212:215], v[20:23], v[48:63]
    v_mfma_f32_32x32x16_bf16 v[48:63], v[216:219], v[24:27], v[48:63]
    v_mfma_f32_32x32x16_bf16 v[48:63], v[220:223], v[28:31], v[48:63]
    s_nop 12
    v_max3_f32 v10, v48, v49, v50
    v_max3_f32 v10, v10, v51, v52
    v_max3_f32 v10, v10, v53, v54
    v_max3_f32 v10, v10, v55, v56
    v_max3_f32 v10, v10, v57, v58
    v_max3_f32 v10, v10, v59, v60
    v_max3_f32 v10, v10, v61, v62
    v_max_f32 v10, v10, v63
    v_mov_b32 v11, v10
    v_mov_b32 v12, v10
    s_nop 1
    v_permlane32_swap_b32 v11, v12
    v_max_f32 v11, v11, v12
    v_max_f32 v11, 0, v11
    v_add_f32 v8, v8, v11
    v_sub_f32 v48, v48, v11
    v_sub_f32 v49, v49, v11
    v_sub_f32 v50, v50, v11
    v_sub_f32 v51, v51, v11
    v_sub_f32 v52, v52, v11
    v_sub_f32 v53, v53, v11
    v_sub_f32 v54, v54, v11
    v_sub_f32 v55, v55, v11
    v_sub_f32 v56, v56, v11
    v_sub_f32 v57, v57, v11
    v_sub_f32 v58, v58, v11
    v_sub_f32 v59, v59, v11
    v_sub_f32 v60, v60, v11
    v_sub_f32 v61, v61, v11
    v_sub_f32 v62, v62, v11
    v_sub_f32 v63, v63, v11
    v_sub_f32 v80, v80, v11
    v_sub_f32 v81, v81, v11
    v_sub_f32 v82, v82, v11
    v_sub_f32 v83, v83, v11
    v_sub_f32 v84, v84, v11
    v_sub_f32 v85, v85, v11
    v_sub_f32 v86, v86, v11
    v_sub_f32 v87, v87, v11
    v_sub_f32 v88, v88, v11
    v_sub_f32 v89, v89, v11
    v_sub_f32 v90, v90, v11
    v_sub_f32 v91, v91, v11
    v_sub_f32 v92, v92, v11
    v_sub_f32 v93, v93, v11
    v_sub_f32 v94, v94, v11
    v_sub_f32 v95, v95, v11
    v_sub_f32 v12, 0, v11
    v_exp_f32 v12, v12
    s_nop 0
    v_mul_f32 v4, v4, v12
    v_mul_f32 v5, v5, v12
    v_mul_f32 v112, v112, v12
    v_mul_f32 v113, v113, v12
    v_mul_f32 v114, v114, v12
    v_mul_f32 v115, v115, v12
    v_mul_f32 v116, v116, v12
    v_mul_f32 v117, v117, v12
    v_mul_f32 v118, v118, v12
    v_mul_f32 v119, v119, v12
    v_mul_f32 v120, v120, v12
    v_mul_f32 v121, v121, v12
    v_mul_f32 v122, v122, v12
    v_mul_f32 v123, v123, v12
    v_mul_f32 v124, v124, v12
    v_mul_f32 v125, v125, v12
    v_mul_f32 v126, v126, v12
    v_mul_f32 v127, v127, v12
    v_mul_f32 v128, v128, v12
    v_mul_f32 v129, v129, v12
    v_mul_f32 v130, v130, v12
    v_mul_f32 v131, v131, v12
    v_mul_f32 v132, v132, v12
    v_mul_f32 v133, v133, v12
    v_mul_f32 v134, v134, v12
    v_mul_f32 v135, v135, v12
    v_mul_f32 v136, v136, v12
    v_mul_f32 v137, v137, v12
    v_mul_f32 v138, v138, v12
    v_mul_f32 v139, v139, v12
    v_mul_f32 v140, v140, v12
    v_mul_f32 v141, v141, v12
    v_mul_f32 v142, v142, v12
    v_mul_f32 v143, v143, v12
    v_exp_f32 v48, v48
    v_exp_f32 v49, v49
    v_exp_f32 v50, v50
    v_exp_f32 v51, v51
    v_cvt_pk_bf16_f32 v176, v48, v49
    v_exp_f32 v52, v52
    v_exp_f32 v53, v53
    v_cvt_pk_bf16_f32 v177, v50, v51
    v_add_f32 v14, v48, v50
    v_add_f32 v15, v49, v51
    v_exp_f32 v54, v54
    v_exp_f32 v55, v55
    v_cvt_pk_bf16_f32 v178, v52, v53
    v_add_f32 v14, v14, v52
    v_add_f32 v15, v15, v53
    v_exp_f32 v56, v56
    v_exp_f32 v57, v57
    v_cvt_pk_bf16_f32 v179, v54, v55
    v_add_f32 v14, v14, v54
    v_add_f32 v15, v15, v55
    v_exp_f32 v58, v58
    v_exp_f32 v59, v59
    v_cvt_pk_bf16_f32 v180, v56, v57
    v_add_f32 v14, v14, v56
    v_add_f32 v15, v15, v57
    v_exp_f32 v60, v60
    v_exp_f32 v61, v61
    v_cvt_pk_bf16_f32 v181, v58, v59
    v_add_f32 v14, v14, v58
    v_add_f32 v15, v15, v59
    v_exp_f32 v62, v62
    v_exp_f32 v63, v63
    v_cvt_pk_bf16_f32 v182, v60, v61
    v_add_f32 v14, v14, v60
    v_add_f32 v15, v15, v61
    v_cvt_pk_bf16_f32 v183, v62, v63
    v_add_f32 v14, v14, v62
    v_add_f32 v15, v15, v63
    s_nop 4
    s_branch Lrs_attn_kernel_1_ret
Lrs_attn_kernel_2:
    s_nop 12
    v_mfma_f32_32x32x16_bf16 v[64:79], v[208:211], v[32:35], v[96:111]
    v_mfma_f32_32x32x16_bf16 v[64:79], v[212:215], v[36:39], v[64:79]
    v_mfma_f32_32x32x16_bf16 v[64:79], v[216:219], v[40:43], v[64:79]
    v_mfma_f32_32x32x16_bf16 v[64:79], v[220:223], v[44:47], v[64:79]
    s_nop 12
    v_max3_f32 v10, v64, v65, v66
    v_max3_f32 v10, v10, v67, v68
    v_max3_f32 v10, v10, v69, v70
    v_max3_f32 v10, v10, v71, v72
    v_max3_f32 v10, v10, v73, v74
    v_max3_f32 v10, v10, v75, v76
    v_max3_f32 v10, v10, v77, v78
    v_max_f32 v10, v10, v79
    v_mov_b32 v11, v10
    v_mov_b32 v12, v10
    s_nop 1
    v_permlane32_swap_b32 v11, v12
    v_max_f32 v11, v11, v12
    v_max_f32 v11, 0, v11
    v_add_f32 v9, v9, v11
    v_sub_f32 v64, v64, v11
    v_sub_f32 v65, v65, v11
    v_sub_f32 v66, v66, v11
    v_sub_f32 v67, v67, v11
    v_sub_f32 v68, v68, v11
    v_sub_f32 v69, v69, v11
    v_sub_f32 v70, v70, v11
    v_sub_f32 v71, v71, v11
    v_sub_f32 v72, v72, v11
    v_sub_f32 v73, v73, v11
    v_sub_f32 v74, v74, v11
    v_sub_f32 v75, v75, v11
    v_sub_f32 v76, v76, v11
    v_sub_f32 v77, v77, v11
    v_sub_f32 v78, v78, v11
    v_sub_f32 v79, v79, v11
    v_sub_f32 v96, v96, v11
    v_sub_f32 v97, v97, v11
    v_sub_f32 v98, v98, v11
    v_sub_f32 v99, v99, v11
    v_sub_f32 v100, v100, v11
    v_sub_f32 v101, v101, v11
    v_sub_f32 v102, v102, v11
    v_sub_f32 v103, v103, v11
    v_sub_f32 v104, v104, v11
    v_sub_f32 v105, v105, v11
    v_sub_f32 v106, v106, v11
    v_sub_f32 v107, v107, v11
    v_sub_f32 v108, v108, v11
    v_sub_f32 v109, v109, v11
    v_sub_f32 v110, v110, v11
    v_sub_f32 v111, v111, v11
    v_sub_f32 v12, 0, v11
    v_exp_f32 v12, v12
    s_nop 0
    v_mul_f32 v6, v6, v12
    v_mul_f32 v7, v7, v12
    v_mul_f32 v144, v144, v12
    v_mul_f32 v145, v145, v12
    v_mul_f32 v146, v146, v12
    v_mul_f32 v147, v147, v12
    v_mul_f32 v148, v148, v12
    v_mul_f32 v149, v149, v12
    v_mul_f32 v150, v150, v12
    v_mul_f32 v151, v151, v12
    v_mul_f32 v152, v152, v12
    v_mul_f32 v153, v153, v12
    v_mul_f32 v154, v154, v12
    v_mul_f32 v155, v155, v12
    v_mul_f32 v156, v156, v12
    v_mul_f32 v157, v157, v12
    v_mul_f32 v158, v158, v12
    v_mul_f32 v159, v159, v12
    v_mul_f32 v160, v160, v12
    v_mul_f32 v161, v161, v12
    v_mul_f32 v162, v162, v12
    v_mul_f32 v163, v163, v12
    v_mul_f32 v164, v164, v12
    v_mul_f32 v165, v165, v12
    v_mul_f32 v166, v166, v12
    v_mul_f32 v167, v167, v12
    v_mul_f32 v168, v168, v12
    v_mul_f32 v169, v169, v12
    v_mul_f32 v170, v170, v12
    v_mul_f32 v171, v171, v12
    v_mul_f32 v172, v172, v12
    v_mul_f32 v173, v173, v12
    v_mul_f32 v174, v174, v12
    v_mul_f32 v175, v175, v12
    v_exp_f32 v64, v64
    v_exp_f32 v65, v65
    v_exp_f32 v66, v66
    v_exp_f32 v67, v67
    v_cvt_pk_bf16_f32 v184, v64, v65
    v_exp_f32 v68, v68
    v_exp_f32 v69, v69
    v_cvt_pk_bf16_f32 v185, v66, v67
    v_add_f32 v14, v64, v66
    v_add_f32 v15, v65, v67
    v_exp_f32 v70, v70
    v_exp_f32 v71, v71
    v_cvt_pk_bf16_f32 v186, v68, v69
    v_add_f32 v14, v14, v68
    v_add_f32 v15, v15, v69
    v_exp_f32 v72, v72
    v_exp_f32 v73, v73
    v_cvt_pk_bf16_f32 v187, v70, v71
    v_add_f32 v14, v14, v70
    v_add_f32 v15, v15, v71
    v_exp_f32 v74, v74
    v_exp_f32 v75, v75
    v_cvt_pk_bf16_f32 v188, v72, v73
    v_add_f32 v14, v14, v72
    v_add_f32 v15, v15, v73
    v_exp_f32 v76, v76
    v_exp_f32 v77, v77
    v_cvt_pk_bf16_f32 v189, v74, v75
    v_add_f32 v14, v14, v74
    v_add_f32 v15, v15, v75
    v_exp_f32 v78, v78
    v_exp_f32 v79, v79
    v_cvt_pk_bf16_f32 v190, v76, v77
    v_add_f32 v14, v14, v76
    v_add_f32 v15, v15, v77
    v_cvt_pk_bf16_f32 v191, v78, v79
    v_add_f32 v14, v14, v78
    v_add_f32 v15, v15, v79
    s_nop 4
    s_branch Lrs_attn_kernel_2_ret
Lrs_attn_kernel_3:
    s_nop 12
    v_mfma_f32_32x32x16_bf16 v[48:63], v[192:195], v[16:19], v[80:95]
    v_mfma_f32_32x32x16_bf16 v[48:63], v[196:199], v[20:23], v[48:63]
    v_mfma_f32_32x32x16_bf16 v[48:63], v[200:203], v[24:27], v[48:63]
    v_mfma_f32_32x32x16_bf16 v[48:63], v[204:207], v[28:31], v[48:63]
    s_nop 12
    v_max3_f32 v10, v48, v49, v50
    v_max3_f32 v10, v10, v51, v52
    v_max3_f32 v10, v10, v53, v54
    v_max3_f32 v10, v10, v55, v56
    v_max3_f32 v10, v10, v57, v58
    v_max3_f32 v10, v10, v59, v60
    v_max3_f32 v10, v10, v61, v62
    v_max_f32 v10, v10, v63
    v_mov_b32 v11, v10
    v_mov_b32 v12, v10
    s_nop 1
    v_permlane32_swap_b32 v11, v12
    v_max_f32 v11, v11, v12
    v_max_f32 v11, 0, v11
    v_add_f32 v8, v8, v11
    v_sub_f32 v48, v48, v11
    v_sub_f32 v49, v49, v11
    v_sub_f32 v50, v50, v11
    v_sub_f32 v51, v51, v11
    v_sub_f32 v52, v52, v11
    v_sub_f32 v53, v53, v11
    v_sub_f32 v54, v54, v11
    v_sub_f32 v55, v55, v11
    v_sub_f32 v56, v56, v11
    v_sub_f32 v57, v57, v11
    v_sub_f32 v58, v58, v11
    v_sub_f32 v59, v59, v11
    v_sub_f32 v60, v60, v11
    v_sub_f32 v61, v61, v11
    v_sub_f32 v62, v62, v11
    v_sub_f32 v63, v63, v11
    v_sub_f32 v80, v80, v11
    v_sub_f32 v81, v81, v11
    v_sub_f32 v82, v82, v11
    v_sub_f32 v83, v83, v11
    v_sub_f32 v84, v84, v11
    v_sub_f32 v85, v85, v11
    v_sub_f32 v86, v86, v11
    v_sub_f32 v87, v87, v11
    v_sub_f32 v88, v88, v11
    v_sub_f32 v89, v89, v11
    v_sub_f32 v90, v90, v11
    v_sub_f32 v91, v91, v11
    v_sub_f32 v92, v92, v11
    v_sub_f32 v93, v93, v11
    v_sub_f32 v94, v94, v11
    v_sub_f32 v95, v95, v11
    v_sub_f32 v12, 0, v11
    v_exp_f32 v12, v12
    s_nop 0
    v_mul_f32 v4, v4, v12
    v_mul_f32 v5, v5, v12
    v_mul_f32 v112, v112, v12
    v_mul_f32 v113, v113, v12
    v_mul_f32 v114, v114, v12
    v_mul_f32 v115, v115, v12
    v_mul_f32 v116, v116, v12
    v_mul_f32 v117, v117, v12
    v_mul_f32 v118, v118, v12
    v_mul_f32 v119, v119, v12
    v_mul_f32 v120, v120, v12
    v_mul_f32 v121, v121, v12
    v_mul_f32 v122, v122, v12
    v_mul_f32 v123, v123, v12
    v_mul_f32 v124, v124, v12
    v_mul_f32 v125, v125, v12
    v_mul_f32 v126, v126, v12
    v_mul_f32 v127, v127, v12
    v_mul_f32 v128, v128, v12
    v_mul_f32 v129, v129, v12
    v_mul_f32 v130, v130, v12
    v_mul_f32 v131, v131, v12
    v_mul_f32 v132, v132, v12
    v_mul_f32 v133, v133, v12
    v_mul_f32 v134, v134, v12
    v_mul_f32 v135, v135, v12
    v_mul_f32 v136, v136, v12
    v_mul_f32 v137, v137, v12
    v_mul_f32 v138, v138, v12
    v_mul_f32 v139, v139, v12
    v_mul_f32 v140, v140, v12
    v_mul_f32 v141, v141, v12
    v_mul_f32 v142, v142, v12
    v_mul_f32 v143, v143, v12
    v_exp_f32 v48, v48
    v_exp_f32 v49, v49
    v_exp_f32 v50, v50
    v_exp_f32 v51, v51
    v_cvt_pk_bf16_f32 v176, v48, v49
    v_exp_f32 v52, v52
    v_exp_f32 v53, v53
    v_cvt_pk_bf16_f32 v177, v50, v51
    v_add_f32 v14, v48, v50
    v_add_f32 v15, v49, v51
    v_exp_f32 v54, v54
    v_exp_f32 v55, v55
    v_cvt_pk_bf16_f32 v178, v52, v53
    v_add_f32 v14, v14, v52
    v_add_f32 v15, v15, v53
    v_exp_f32 v56, v56
    v_exp_f32 v57, v57
    v_cvt_pk_bf16_f32 v179, v54, v55
    v_add_f32 v14, v14, v54
    v_add_f32 v15, v15, v55
    v_exp_f32 v58, v58
    v_exp_f32 v59, v59
    v_cvt_pk_bf16_f32 v180, v56, v57
    v_add_f32 v14, v14, v56
    v_add_f32 v15, v15, v57
    v_exp_f32 v60, v60
    v_exp_f32 v61, v61
    v_cvt_pk_bf16_f32 v181, v58, v59
    v_add_f32 v14, v14, v58
    v_add_f32 v15, v15, v59
    v_exp_f32 v62, v62
    v_exp_f32 v63, v63
    v_cvt_pk_bf16_f32 v182, v60, v61
    v_add_f32 v14, v14, v60
    v_add_f32 v15, v15, v61
    v_cvt_pk_bf16_f32 v183, v62, v63
    v_add_f32 v14, v14, v62
    v_add_f32 v15, v15, v63
    s_nop 4
    s_branch Lrs_attn_kernel_3_ret
Lrs_attn_kernel_4:
    s_nop 12
    v_mfma_f32_32x32x16_bf16 v[64:79], v[192:195], v[32:35], v[96:111]
    v_mfma_f32_32x32x16_bf16 v[64:79], v[196:199], v[36:39], v[64:79]
    v_mfma_f32_32x32x16_bf16 v[64:79], v[200:203], v[40:43], v[64:79]
    v_mfma_f32_32x32x16_bf16 v[64:79], v[204:207], v[44:47], v[64:79]
    s_nop 12
    v_max3_f32 v10, v64, v65, v66
    v_max3_f32 v10, v10, v67, v68
    v_max3_f32 v10, v10, v69, v70
    v_max3_f32 v10, v10, v71, v72
    v_max3_f32 v10, v10, v73, v74
    v_max3_f32 v10, v10, v75, v76
    v_max3_f32 v10, v10, v77, v78
    v_max_f32 v10, v10, v79
    v_mov_b32 v11, v10
    v_mov_b32 v12, v10
    s_nop 1
    v_permlane32_swap_b32 v11, v12
    v_max_f32 v11, v11, v12
    v_max_f32 v11, 0, v11
    v_add_f32 v9, v9, v11
    v_sub_f32 v64, v64, v11
    v_sub_f32 v65, v65, v11
    v_sub_f32 v66, v66, v11
    v_sub_f32 v67, v67, v11
    v_sub_f32 v68, v68, v11
    v_sub_f32 v69, v69, v11
    v_sub_f32 v70, v70, v11
    v_sub_f32 v71, v71, v11
    v_sub_f32 v72, v72, v11
    v_sub_f32 v73, v73, v11
    v_sub_f32 v74, v74, v11
    v_sub_f32 v75, v75, v11
    v_sub_f32 v76, v76, v11
    v_sub_f32 v77, v77, v11
    v_sub_f32 v78, v78, v11
    v_sub_f32 v79, v79, v11
    v_sub_f32 v96, v96, v11
    v_sub_f32 v97, v97, v11
    v_sub_f32 v98, v98, v11
    v_sub_f32 v99, v99, v11
    v_sub_f32 v100, v100, v11
    v_sub_f32 v101, v101, v11
    v_sub_f32 v102, v102, v11
    v_sub_f32 v103, v103, v11
    v_sub_f32 v104, v104, v11
    v_sub_f32 v105, v105, v11
    v_sub_f32 v106, v106, v11
    v_sub_f32 v107, v107, v11
    v_sub_f32 v108, v108, v11
    v_sub_f32 v109, v109, v11
    v_sub_f32 v110, v110, v11
    v_sub_f32 v111, v111, v11
    v_sub_f32 v12, 0, v11
    v_exp_f32 v12, v12
    s_nop 0
    v_mul_f32 v6, v6, v12
    v_mul_f32 v7, v7, v12
    v_mul_f32 v144, v144, v12
    v_mul_f32 v145, v145, v12
    v_mul_f32 v146, v146, v12
    v_mul_f32 v147, v147, v12
    v_mul_f32 v148, v148, v12
    v_mul_f32 v149, v149, v12
    v_mul_f32 v150, v150, v12
    v_mul_f32 v151, v151, v12
    v_mul_f32 v152, v152, v12
    v_mul_f32 v153, v153, v12
    v_mul_f32 v154, v154, v12
    v_mul_f32 v155, v155, v12
    v_mul_f32 v156, v156, v12
    v_mul_f32 v157, v157, v12
    v_mul_f32 v158, v158, v12
    v_mul_f32 v159, v159, v12
    v_mul_f32 v160, v160, v12
    v_mul_f32 v161, v161, v12
    v_mul_f32 v162, v162, v12
    v_mul_f32 v163, v163, v12
    v_mul_f32 v164, v164, v12
    v_mul_f32 v165, v165, v12
    v_mul_f32 v166, v166, v12
    v_mul_f32 v167, v167, v12
    v_mul_f32 v168, v168, v12
    v_mul_f32 v169, v169, v12
    v_mul_f32 v170, v170, v12
    v_mul_f32 v171, v171, v12
    v_mul_f32 v172, v172, v12
    v_mul_f32 v173, v173, v12
    v_mul_f32 v174, v174, v12
    v_mul_f32 v175, v175, v12
    v_exp_f32 v64, v64
    v_exp_f32 v65, v65
    v_exp_f32 v66, v66
    v_exp_f32 v67, v67
    v_cvt_pk_bf16_f32 v184, v64, v65
    v_exp_f32 v68, v68
    v_exp_f32 v69, v69
    v_cvt_pk_bf16_f32 v185, v66, v67
    v_add_f32 v14, v64, v66
    v_add_f32 v15, v65, v67
    v_exp_f32 v70, v70
    v_exp_f32 v71, v71
    v_cvt_pk_bf16_f32 v186, v68, v69
    v_add_f32 v14, v14, v68
    v_add_f32 v15, v15, v69
    v_exp_f32 v72, v72
    v_exp_f32 v73, v73
    v_cvt_pk_bf16_f32 v187, v70, v71
    v_add_f32 v14, v14, v70
    v_add_f32 v15, v15, v71
    v_exp_f32 v74, v74
    v_exp_f32 v75, v75
    v_cvt_pk_bf16_f32 v188, v72, v73
    v_add_f32 v14, v14, v72
    v_add_f32 v15, v15, v73
    v_exp_f32 v76, v76
    v_exp_f32 v77, v77
    v_cvt_pk_bf16_f32 v189, v74, v75
    v_add_f32 v14, v14, v74
    v_add_f32 v15, v15, v75
    v_exp_f32 v78, v78
    v_exp_f32 v79, v79
    v_cvt_pk_bf16_f32 v190, v76, v77
    v_add_f32 v14, v14, v76
    v_add_f32 v15, v15, v77
    v_cvt_pk_bf16_f32 v191, v78, v79
    v_add_f32 v14, v14, v78
    v_add_f32 v15, v15, v79
    s_nop 4
    s_branch Lrs_attn_kernel_4_ret
Lrs_attn_kernel_5:
    s_nop 12
    v_mfma_f32_32x32x16_bf16 v[48:63], v[208:211], v[16:19], v[80:95]
    v_mfma_f32_32x32x16_bf16 v[48:63], v[212:215], v[20:23], v[48:63]
    v_mfma_f32_32x32x16_bf16 v[48:63], v[216:219], v[24:27], v[48:63]
    v_mfma_f32_32x32x16_bf16 v[48:63], v[220:223], v[28:31], v[48:63]
    s_nop 12
    v_max3_f32 v10, v48, v49, v50
    v_max3_f32 v10, v10, v51, v52
    v_max3_f32 v10, v10, v53, v54
    v_max3_f32 v10, v10, v55, v56
    v_max3_f32 v10, v10, v57, v58
    v_max3_f32 v10, v10, v59, v60
    v_max3_f32 v10, v10, v61, v62
    v_max_f32 v10, v10, v63
    v_mov_b32 v11, v10
    v_mov_b32 v12, v10
    s_nop 1
    v_permlane32_swap_b32 v11, v12
    v_max_f32 v11, v11, v12
    v_max_f32 v11, 0, v11
    v_add_f32 v8, v8, v11
    v_sub_f32 v48, v48, v11
    v_sub_f32 v49, v49, v11
    v_sub_f32 v50, v50, v11
    v_sub_f32 v51, v51, v11
    v_sub_f32 v52, v52, v11
    v_sub_f32 v53, v53, v11
    v_sub_f32 v54, v54, v11
    v_sub_f32 v55, v55, v11
    v_sub_f32 v56, v56, v11
    v_sub_f32 v57, v57, v11
    v_sub_f32 v58, v58, v11
    v_sub_f32 v59, v59, v11
    v_sub_f32 v60, v60, v11
    v_sub_f32 v61, v61, v11
    v_sub_f32 v62, v62, v11
    v_sub_f32 v63, v63, v11
    v_sub_f32 v80, v80, v11
    v_sub_f32 v81, v81, v11
    v_sub_f32 v82, v82, v11
    v_sub_f32 v83, v83, v11
    v_sub_f32 v84, v84, v11
    v_sub_f32 v85, v85, v11
    v_sub_f32 v86, v86, v11
    v_sub_f32 v87, v87, v11
    v_sub_f32 v88, v88, v11
    v_sub_f32 v89, v89, v11
    v_sub_f32 v90, v90, v11
    v_sub_f32 v91, v91, v11
    v_sub_f32 v92, v92, v11
    v_sub_f32 v93, v93, v11
    v_sub_f32 v94, v94, v11
    v_sub_f32 v95, v95, v11
    v_sub_f32 v12, 0, v11
    v_exp_f32 v12, v12
    s_nop 0
    v_mul_f32 v4, v4, v12
    v_mul_f32 v5, v5, v12
    v_mul_f32 v112, v112, v12
    v_mul_f32 v113, v113, v12
    v_mul_f32 v114, v114, v12
    v_mul_f32 v115, v115, v12
    v_mul_f32 v116, v116, v12
    v_mul_f32 v117, v117, v12
    v_mul_f32 v118, v118, v12
    v_mul_f32 v119, v119, v12
    v_mul_f32 v120, v120, v12
    v_mul_f32 v121, v121, v12
    v_mul_f32 v122, v122, v12
    v_mul_f32 v123, v123, v12
    v_mul_f32 v124, v124, v12
    v_mul_f32 v125, v125, v12
    v_mul_f32 v126, v126, v12
    v_mul_f32 v127, v127, v12
    v_mul_f32 v128, v128, v12
    v_mul_f32 v129, v129, v12
    v_mul_f32 v130, v130, v12
    v_mul_f32 v131, v131, v12
    v_mul_f32 v132, v132, v12
    v_mul_f32 v133, v133, v12
    v_mul_f32 v134, v134, v12
    v_mul_f32 v135, v135, v12
    v_mul_f32 v136, v136, v12
    v_mul_f32 v137, v137, v12
    v_mul_f32 v138, v138, v12
    v_mul_f32 v139, v139, v12
    v_mul_f32 v140, v140, v12
    v_mul_f32 v141, v141, v12
    v_mul_f32 v142, v142, v12
    v_mul_f32 v143, v143, v12
    v_exp_f32 v48, v48
    v_exp_f32 v49, v49
    v_exp_f32 v50, v50
    v_exp_f32 v51, v51
    v_cvt_pk_bf16_f32 v176, v48, v49
    v_exp_f32 v52, v52
    v_exp_f32 v53, v53
    v_cvt_pk_bf16_f32 v177, v50, v51
    v_add_f32 v14, v48, v50
    v_add_f32 v15, v49, v51
    v_exp_f32 v54, v54
    v_exp_f32 v55, v55
    v_cvt_pk_bf16_f32 v178, v52, v53
    v_add_f32 v14, v14, v52
    v_add_f32 v15, v15, v53
    v_exp_f32 v56, v56
    v_exp_f32 v57, v57
    v_cvt_pk_bf16_f32 v179, v54, v55
    v_add_f32 v14, v14, v54
    v_add_f32 v15, v15, v55
    v_exp_f32 v58, v58
    v_exp_f32 v59, v59
    v_cvt_pk_bf16_f32 v180, v56, v57
    v_add_f32 v14, v14, v56
    v_add_f32 v15, v15, v57
    v_exp_f32 v60, v60
    v_exp_f32 v61, v61
    v_cvt_pk_bf16_f32 v181, v58, v59
    v_add_f32 v14, v14, v58
    v_add_f32 v15, v15, v59
    v_exp_f32 v62, v62
    v_exp_f32 v63, v63
    v_cvt_pk_bf16_f32 v182, v60, v61
    v_add_f32 v14, v14, v60
    v_add_f32 v15, v15, v61
    v_cvt_pk_bf16_f32 v183, v62, v63
    v_add_f32 v14, v14, v62
    v_add_f32 v15, v15, v63
    s_nop 4
    s_branch Lrs_attn_kernel_5_ret
Lrs_attn_kernel_6:
    s_nop 12
    v_mfma_f32_32x32x16_bf16 v[64:79], v[208:211], v[32:35], v[96:111]
    v_mfma_f32_32x32x16_bf16 v[64:79], v[212:215], v[36:39], v[64:79]
    v_mfma_f32_32x32x16_bf16 v[64:79], v[216:219], v[40:43], v[64:79]
    v_mfma_f32_32x32x16_bf16 v[64:79], v[220:223], v[44:47], v[64:79]
    s_nop 12
    v_max3_f32 v10, v64, v65, v66
    v_max3_f32 v10, v10, v67, v68
    v_max3_f32 v10, v10, v69, v70
    v_max3_f32 v10, v10, v71, v72
    v_max3_f32 v10, v10, v73, v74
    v_max3_f32 v10, v10, v75, v76
    v_max3_f32 v10, v10, v77, v78
    v_max_f32 v10, v10, v79
    v_mov_b32 v11, v10
    v_mov_b32 v12, v10
    s_nop 1
    v_permlane32_swap_b32 v11, v12
    v_max_f32 v11, v11, v12
    v_max_f32 v11, 0, v11
    v_add_f32 v9, v9, v11
    v_sub_f32 v64, v64, v11
    v_sub_f32 v65, v65, v11
    v_sub_f32 v66, v66, v11
    v_sub_f32 v67, v67, v11
    v_sub_f32 v68, v68, v11
    v_sub_f32 v69, v69, v11
    v_sub_f32 v70, v70, v11
    v_sub_f32 v71, v71, v11
    v_sub_f32 v72, v72, v11
    v_sub_f32 v73, v73, v11
    v_sub_f32 v74, v74, v11
    v_sub_f32 v75, v75, v11
    v_sub_f32 v76, v76, v11
    v_sub_f32 v77, v77, v11
    v_sub_f32 v78, v78, v11
    v_sub_f32 v79, v79, v11
    v_sub_f32 v96, v96, v11
    v_sub_f32 v97, v97, v11
    v_sub_f32 v98, v98, v11
    v_sub_f32 v99, v99, v11
    v_sub_f32 v100, v100, v11
    v_sub_f32 v101, v101, v11
    v_sub_f32 v102, v102, v11
    v_sub_f32 v103, v103, v11
    v_sub_f32 v104, v104, v11
    v_sub_f32 v105, v105, v11
    v_sub_f32 v106, v106, v11
    v_sub_f32 v107, v107, v11
    v_sub_f32 v108, v108, v11
    v_sub_f32 v109, v109, v11
    v_sub_f32 v110, v110, v11
    v_sub_f32 v111, v111, v11
    v_sub_f32 v12, 0, v11
    v_exp_f32 v12, v12
    s_nop 0
    v_mul_f32 v6, v6, v12
    v_mul_f32 v7, v7, v12
    v_mul_f32 v144, v144, v12
    v_mul_f32 v145, v145, v12
    v_mul_f32 v146, v146, v12
    v_mul_f32 v147, v147, v12
    v_mul_f32 v148, v148, v12
    v_mul_f32 v149, v149, v12
    v_mul_f32 v150, v150, v12
    v_mul_f32 v151, v151, v12
    v_mul_f32 v152, v152, v12
    v_mul_f32 v153, v153, v12
    v_mul_f32 v154, v154, v12
    v_mul_f32 v155, v155, v12
    v_mul_f32 v156, v156, v12
    v_mul_f32 v157, v157, v12
    v_mul_f32 v158, v158, v12
    v_mul_f32 v159, v159, v12
    v_mul_f32 v160, v160, v12
    v_mul_f32 v161, v161, v12
    v_mul_f32 v162, v162, v12
    v_mul_f32 v163, v163, v12
    v_mul_f32 v164, v164, v12
    v_mul_f32 v165, v165, v12
    v_mul_f32 v166, v166, v12
    v_mul_f32 v167, v167, v12
    v_mul_f32 v168, v168, v12
    v_mul_f32 v169, v169, v12
    v_mul_f32 v170, v170, v12
    v_mul_f32 v171, v171, v12
    v_mul_f32 v172, v172, v12
    v_mul_f32 v173, v173, v12
    v_mul_f32 v174, v174, v12
    v_mul_f32 v175, v175, v12
    v_exp_f32 v64, v64
    v_exp_f32 v65, v65
    v_exp_f32 v66, v66
    v_exp_f32 v67, v67
    v_cvt_pk_bf16_f32 v184, v64, v65
    v_exp_f32 v68, v68
    v_exp_f32 v69, v69
    v_cvt_pk_bf16_f32 v185, v66, v67
    v_add_f32 v14, v64, v66
    v_add_f32 v15, v65, v67
    v_exp_f32 v70, v70
    v_exp_f32 v71, v71
    v_cvt_pk_bf16_f32 v186, v68, v69
    v_add_f32 v14, v14, v68
    v_add_f32 v15, v15, v69
    v_exp_f32 v72, v72
    v_exp_f32 v73, v73
    v_cvt_pk_bf16_f32 v187, v70, v71
    v_add_f32 v14, v14, v70
    v_add_f32 v15, v15, v71
    v_exp_f32 v74, v74
    v_exp_f32 v75, v75
    v_cvt_pk_bf16_f32 v188, v72, v73
    v_add_f32 v14, v14, v72
    v_add_f32 v15, v15, v73
    v_exp_f32 v76, v76
    v_exp_f32 v77, v77
    v_cvt_pk_bf16_f32 v189, v74, v75
    v_add_f32 v14, v14, v74
    v_add_f32 v15, v15, v75
    v_exp_f32 v78, v78
    v_exp_f32 v79, v79
    v_cvt_pk_bf16_f32 v190, v76, v77
    v_add_f32 v14, v14, v76
    v_add_f32 v15, v15, v77
    v_cvt_pk_bf16_f32 v191, v78, v79
    v_add_f32 v14, v14, v78
    v_add_f32 v15, v15, v79
    s_nop 4
    s_branch Lrs_attn_kernel_6_ret
Lrs_attn_kernel_7:
    s_nop 12
    v_mfma_f32_32x32x16_bf16 v[48:63], v[192:195], v[16:19], v[80:95]
    v_mfma_f32_32x32x16_bf16 v[48:63], v[196:199], v[20:23], v[48:63]
    v_mfma_f32_32x32x16_bf16 v[48:63], v[200:203], v[24:27], v[48:63]
    v_mfma_f32_32x32x16_bf16 v[48:63], v[204:207], v[28:31], v[48:63]
    s_nop 12
    v_max3_f32 v10, v48, v49, v50
    v_max3_f32 v10, v10, v51, v52
    v_max3_f32 v10, v10, v53, v54
    v_max3_f32 v10, v10, v55, v56
    v_max3_f32 v10, v10, v57, v58
    v_max3_f32 v10, v10, v59, v60
    v_max3_f32 v10, v10, v61, v62
    v_max_f32 v10, v10, v63
    v_mov_b32 v11, v10
    v_mov_b32 v12, v10
    s_nop 1
    v_permlane32_swap_b32 v11, v12
    v_max_f32 v11, v11, v12
    v_max_f32 v11, 0, v11
    v_add_f32 v8, v8, v11
    v_sub_f32 v48, v48, v11
    v_sub_f32 v49, v49, v11
    v_sub_f32 v50, v50, v11
    v_sub_f32 v51, v51, v11
    v_sub_f32 v52, v52, v11
    v_sub_f32 v53, v53, v11
    v_sub_f32 v54, v54, v11
    v_sub_f32 v55, v55, v11
    v_sub_f32 v56, v56, v11
    v_sub_f32 v57, v57, v11
    v_sub_f32 v58, v58, v11
    v_sub_f32 v59, v59, v11
    v_sub_f32 v60, v60, v11
    v_sub_f32 v61, v61, v11
    v_sub_f32 v62, v62, v11
    v_sub_f32 v63, v63, v11
    v_sub_f32 v80, v80, v11
    v_sub_f32 v81, v81, v11
    v_sub_f32 v82, v82, v11
    v_sub_f32 v83, v83, v11
    v_sub_f32 v84, v84, v11
    v_sub_f32 v85, v85, v11
    v_sub_f32 v86, v86, v11
    v_sub_f32 v87, v87, v11
    v_sub_f32 v88, v88, v11
    v_sub_f32 v89, v89, v11
    v_sub_f32 v90, v90, v11
    v_sub_f32 v91, v91, v11
    v_sub_f32 v92, v92, v11
    v_sub_f32 v93, v93, v11
    v_sub_f32 v94, v94, v11
    v_sub_f32 v95, v95, v11
    v_sub_f32 v12, 0, v11
    v_exp_f32 v12, v12
    s_nop 0
    v_mul_f32 v4, v4, v12
    v_mul_f32 v5, v5, v12
    v_mul_f32 v112, v112, v12
    v_mul_f32 v113, v113, v12
    v_mul_f32 v114, v114, v12
    v_mul_f32 v115, v115, v12
    v_mul_f32 v116, v116, v12
    v_mul_f32 v117, v117, v12
    v_mul_f32 v118, v118, v12
    v_mul_f32 v119, v119, v12
    v_mul_f32 v120, v120, v12
    v_mul_f32 v121, v121, v12
    v_mul_f32 v122, v122, v12
    v_mul_f32 v123, v123, v12
    v_mul_f32 v124, v124, v12
    v_mul_f32 v125, v125, v12
    v_mul_f32 v126, v126, v12
    v_mul_f32 v127, v127, v12
    v_mul_f32 v128, v128, v12
    v_mul_f32 v129, v129, v12
    v_mul_f32 v130, v130, v12
    v_mul_f32 v131, v131, v12
    v_mul_f32 v132, v132, v12
    v_mul_f32 v133, v133, v12
    v_mul_f32 v134, v134, v12
    v_mul_f32 v135, v135, v12
    v_mul_f32 v136, v136, v12
    v_mul_f32 v137, v137, v12
    v_mul_f32 v138, v138, v12
    v_mul_f32 v139, v139, v12
    v_mul_f32 v140, v140, v12
    v_mul_f32 v141, v141, v12
    v_mul_f32 v142, v142, v12
    v_mul_f32 v143, v143, v12
    v_exp_f32 v48, v48
    v_exp_f32 v49, v49
    v_exp_f32 v50, v50
    v_exp_f32 v51, v51
    v_cvt_pk_bf16_f32 v176, v48, v49
    v_exp_f32 v52, v52
    v_exp_f32 v53, v53
    v_cvt_pk_bf16_f32 v177, v50, v51
    v_add_f32 v14, v48, v50
    v_add_f32 v15, v49, v51
    v_exp_f32 v54, v54
    v_exp_f32 v55, v55
    v_cvt_pk_bf16_f32 v178, v52, v53
    v_add_f32 v14, v14, v52
    v_add_f32 v15, v15, v53
    v_exp_f32 v56, v56
    v_exp_f32 v57, v57
    v_cvt_pk_bf16_f32 v179, v54, v55
    v_add_f32 v14, v14, v54
    v_add_f32 v15, v15, v55
    v_exp_f32 v58, v58
    v_exp_f32 v59, v59
    v_cvt_pk_bf16_f32 v180, v56, v57
    v_add_f32 v14, v14, v56
    v_add_f32 v15, v15, v57
    v_exp_f32 v60, v60
    v_exp_f32 v61, v61
    v_cvt_pk_bf16_f32 v181, v58, v59
    v_add_f32 v14, v14, v58
    v_add_f32 v15, v15, v59
    v_exp_f32 v62, v62
    v_exp_f32 v63, v63
    v_cvt_pk_bf16_f32 v182, v60, v61
    v_add_f32 v14, v14, v60
    v_add_f32 v15, v15, v61
    v_cvt_pk_bf16_f32 v183, v62, v63
    v_add_f32 v14, v14, v62
    v_add_f32 v15, v15, v63
    s_nop 4
    s_branch Lrs_attn_kernel_7_ret
Lrs_attn_kernel_8:
    s_nop 12
    v_mfma_f32_32x32x16_bf16 v[64:79], v[192:195], v[32:35], v[96:111]
    v_mfma_f32_32x32x16_bf16 v[64:79], v[196:199], v[36:39], v[64:79]
    v_mfma_f32_32x32x16_bf16 v[64:79], v[200:203], v[40:43], v[64:79]
    v_mfma_f32_32x32x16_bf16 v[64:79], v[204:207], v[44:47], v[64:79]
    s_nop 12
    v_max3_f32 v10, v64, v65, v66
    v_max3_f32 v10, v10, v67, v68
    v_max3_f32 v10, v10, v69, v70
    v_max3_f32 v10, v10, v71, v72
    v_max3_f32 v10, v10, v73, v74
    v_max3_f32 v10, v10, v75, v76
    v_max3_f32 v10, v10, v77, v78
    v_max_f32 v10, v10, v79
    v_mov_b32 v11, v10
    v_mov_b32 v12, v10
    s_nop 1
    v_permlane32_swap_b32 v11, v12
    v_max_f32 v11, v11, v12
    v_max_f32 v11, 0, v11
    v_add_f32 v9, v9, v11
    v_sub_f32 v64, v64, v11
    v_sub_f32 v65, v65, v11
    v_sub_f32 v66, v66, v11
    v_sub_f32 v67, v67, v11
    v_sub_f32 v68, v68, v11
    v_sub_f32 v69, v69, v11
    v_sub_f32 v70, v70, v11
    v_sub_f32 v71, v71, v11
    v_sub_f32 v72, v72, v11
    v_sub_f32 v73, v73, v11
    v_sub_f32 v74, v74, v11
    v_sub_f32 v75, v75, v11
    v_sub_f32 v76, v76, v11
    v_sub_f32 v77, v77, v11
    v_sub_f32 v78, v78, v11
    v_sub_f32 v79, v79, v11
    v_sub_f32 v96, v96, v11
    v_sub_f32 v97, v97, v11
    v_sub_f32 v98, v98, v11
    v_sub_f32 v99, v99, v11
    v_sub_f32 v100, v100, v11
    v_sub_f32 v101, v101, v11
    v_sub_f32 v102, v102, v11
    v_sub_f32 v103, v103, v11
    v_sub_f32 v104, v104, v11
    v_sub_f32 v105, v105, v11
    v_sub_f32 v106, v106, v11
    v_sub_f32 v107, v107, v11
    v_sub_f32 v108, v108, v11
    v_sub_f32 v109, v109, v11
    v_sub_f32 v110, v110, v11
    v_sub_f32 v111, v111, v11
    v_sub_f32 v12, 0, v11
    v_exp_f32 v12, v12
    s_nop 0
    v_mul_f32 v6, v6, v12
    v_mul_f32 v7, v7, v12
    v_mul_f32 v144, v144, v12
    v_mul_f32 v145, v145, v12
    v_mul_f32 v146, v146, v12
    v_mul_f32 v147, v147, v12
    v_mul_f32 v148, v148, v12
    v_mul_f32 v149, v149, v12
    v_mul_f32 v150, v150, v12
    v_mul_f32 v151, v151, v12
    v_mul_f32 v152, v152, v12
    v_mul_f32 v153, v153, v12
    v_mul_f32 v154, v154, v12
    v_mul_f32 v155, v155, v12
    v_mul_f32 v156, v156, v12
    v_mul_f32 v157, v157, v12
    v_mul_f32 v158, v158, v12
    v_mul_f32 v159, v159, v12
    v_mul_f32 v160, v160, v12
    v_mul_f32 v161, v161, v12
    v_mul_f32 v162, v162, v12
    v_mul_f32 v163, v163, v12
    v_mul_f32 v164, v164, v12
    v_mul_f32 v165, v165, v12
    v_mul_f32 v166, v166, v12
    v_mul_f32 v167, v167, v12
    v_mul_f32 v168, v168, v12
    v_mul_f32 v169, v169, v12
    v_mul_f32 v170, v170, v12
    v_mul_f32 v171, v171, v12
    v_mul_f32 v172, v172, v12
    v_mul_f32 v173, v173, v12
    v_mul_f32 v174, v174, v12
    v_mul_f32 v175, v175, v12
    v_exp_f32 v64, v64
    v_exp_f32 v65, v65
    v_exp_f32 v66, v66
    v_exp_f32 v67, v67
    v_cvt_pk_bf16_f32 v184, v64, v65
    v_exp_f32 v68, v68
    v_exp_f32 v69, v69
    v_cvt_pk_bf16_f32 v185, v66, v67
    v_add_f32 v14, v64, v66
    v_add_f32 v15, v65, v67
    v_exp_f32 v70, v70
    v_exp_f32 v71, v71
    v_cvt_pk_bf16_f32 v186, v68, v69
    v_add_f32 v14, v14, v68
    v_add_f32 v15, v15, v69
    v_exp_f32 v72, v72
    v_exp_f32 v73, v73
    v_cvt_pk_bf16_f32 v187, v70, v71
    v_add_f32 v14, v14, v70
    v_add_f32 v15, v15, v71
    v_exp_f32 v74, v74
    v_exp_f32 v75, v75
    v_cvt_pk_bf16_f32 v188, v72, v73
    v_add_f32 v14, v14, v72
    v_add_f32 v15, v15, v73
    v_exp_f32 v76, v76
    v_exp_f32 v77, v77
    v_cvt_pk_bf16_f32 v189, v74, v75
    v_add_f32 v14, v14, v74
    v_add_f32 v15, v15, v75
    v_exp_f32 v78, v78
    v_exp_f32 v79, v79
    v_cvt_pk_bf16_f32 v190, v76, v77
    v_add_f32 v14, v14, v76
    v_add_f32 v15, v15, v77
    v_cvt_pk_bf16_f32 v191, v78, v79
    v_add_f32 v14, v14, v78
    v_add_f32 v15, v15, v79
    s_nop 4
    s_branch Lrs_attn_kernel_8_ret
Lrs_attn_kernel_9:
    s_nop 12
    v_mfma_f32_32x32x16_bf16 v[48:63], v[208:211], v[16:19], v[80:95]
    v_mfma_f32_32x32x16_bf16 v[48:63], v[212:215], v[20:23], v[48:63]
    v_mfma_f32_32x32x16_bf16 v[48:63], v[216:219], v[24:27], v[48:63]
    v_mfma_f32_32x32x16_bf16 v[48:63], v[220:223], v[28:31], v[48:63]
    s_nop 12
    v_max3_f32 v10, v48, v49, v50
    v_max3_f32 v10, v10, v51, v52
    v_max3_f32 v10, v10, v53, v54
    v_max3_f32 v10, v10, v55, v56
    v_max3_f32 v10, v10, v57, v58
    v_max3_f32 v10, v10, v59, v60
    v_max3_f32 v10, v10, v61, v62
    v_max_f32 v10, v10, v63
    v_mov_b32 v11, v10
    v_mov_b32 v12, v10
    s_nop 1
    v_permlane32_swap_b32 v11, v12
    v_max_f32 v11, v11, v12
    v_max_f32 v11, 0, v11
    v_add_f32 v8, v8, v11
    v_sub_f32 v48, v48, v11
    v_sub_f32 v49, v49, v11
    v_sub_f32 v50, v50, v11
    v_sub_f32 v51, v51, v11
    v_sub_f32 v52, v52, v11
    v_sub_f32 v53, v53, v11
    v_sub_f32 v54, v54, v11
    v_sub_f32 v55, v55, v11
    v_sub_f32 v56, v56, v11
    v_sub_f32 v57, v57, v11
    v_sub_f32 v58, v58, v11
    v_sub_f32 v59, v59, v11
    v_sub_f32 v60, v60, v11
    v_sub_f32 v61, v61, v11
    v_sub_f32 v62, v62, v11
    v_sub_f32 v63, v63, v11
    v_sub_f32 v80, v80, v11
    v_sub_f32 v81, v81, v11
    v_sub_f32 v82, v82, v11
    v_sub_f32 v83, v83, v11
    v_sub_f32 v84, v84, v11
    v_sub_f32 v85, v85, v11
    v_sub_f32 v86, v86, v11
    v_sub_f32 v87, v87, v11
    v_sub_f32 v88, v88, v11
    v_sub_f32 v89, v89, v11
    v_sub_f32 v90, v90, v11
    v_sub_f32 v91, v91, v11
    v_sub_f32 v92, v92, v11
    v_sub_f32 v93, v93, v11
    v_sub_f32 v94, v94, v11
    v_sub_f32 v95, v95, v11
    v_sub_f32 v12, 0, v11
    v_exp_f32 v12, v12
    s_nop 0
    v_mul_f32 v4, v4, v12
    v_mul_f32 v5, v5, v12
    v_mul_f32 v112, v112, v12
    v_mul_f32 v113, v113, v12
    v_mul_f32 v114, v114, v12
    v_mul_f32 v115, v115, v12
    v_mul_f32 v116, v116, v12
    v_mul_f32 v117, v117, v12
    v_mul_f32 v118, v118, v12
    v_mul_f32 v119, v119, v12
    v_mul_f32 v120, v120, v12
    v_mul_f32 v121, v121, v12
    v_mul_f32 v122, v122, v12
    v_mul_f32 v123, v123, v12
    v_mul_f32 v124, v124, v12
    v_mul_f32 v125, v125, v12
    v_mul_f32 v126, v126, v12
    v_mul_f32 v127, v127, v12
    v_mul_f32 v128, v128, v12
    v_mul_f32 v129, v129, v12
    v_mul_f32 v130, v130, v12
    v_mul_f32 v131, v131, v12
    v_mul_f32 v132, v132, v12
    v_mul_f32 v133, v133, v12
    v_mul_f32 v134, v134, v12
    v_mul_f32 v135, v135, v12
    v_mul_f32 v136, v136, v12
    v_mul_f32 v137, v137, v12
    v_mul_f32 v138, v138, v12
    v_mul_f32 v139, v139, v12
    v_mul_f32 v140, v140, v12
    v_mul_f32 v141, v141, v12
    v_mul_f32 v142, v142, v12
    v_mul_f32 v143, v143, v12
    v_exp_f32 v48, v48
    v_exp_f32 v49, v49
    v_exp_f32 v50, v50
    v_exp_f32 v51, v51
    v_cvt_pk_bf16_f32 v176, v48, v49
    v_exp_f32 v52, v52
    v_exp_f32 v53, v53
    v_cvt_pk_bf16_f32 v177, v50, v51
    v_add_f32 v14, v48, v50
    v_add_f32 v15, v49, v51
    v_exp_f32 v54, v54
    v_exp_f32 v55, v55
    v_cvt_pk_bf16_f32 v178, v52, v53
    v_add_f32 v14, v14, v52
    v_add_f32 v15, v15, v53
    v_exp_f32 v56, v56
    v_exp_f32 v57, v57
    v_cvt_pk_bf16_f32 v179, v54, v55
    v_add_f32 v14, v14, v54
    v_add_f32 v15, v15, v55
    v_exp_f32 v58, v58
    v_exp_f32 v59, v59
    v_cvt_pk_bf16_f32 v180, v56, v57
    v_add_f32 v14, v14, v56
    v_add_f32 v15, v15, v57
    v_exp_f32 v60, v60
    v_exp_f32 v61, v61
    v_cvt_pk_bf16_f32 v181, v58, v59
    v_add_f32 v14, v14, v58
    v_add_f32 v15, v15, v59
    v_exp_f32 v62, v62
    v_exp_f32 v63, v63
    v_cvt_pk_bf16_f32 v182, v60, v61
    v_add_f32 v14, v14, v60
    v_add_f32 v15, v15, v61
    v_cvt_pk_bf16_f32 v183, v62, v63
    v_add_f32 v14, v14, v62
    v_add_f32 v15, v15, v63
    s_nop 4
    s_branch Lrs_attn_kernel_9_ret
Lrs_attn_kernel_10:
    s_nop 12
    v_mfma_f32_32x32x16_bf16 v[64:79], v[208:211], v[32:35], v[96:111]
    v_mfma_f32_32x32x16_bf16 v[64:79], v[212:215], v[36:39], v[64:79]
    v_mfma_f32_32x32x16_bf16 v[64:79], v[216:219], v[40:43], v[64:79]
    v_mfma_f32_32x32x16_bf16 v[64:79], v[220:223], v[44:47], v[64:79]
    s_nop 12
    v_max3_f32 v10, v64, v65, v66
    v_max3_f32 v10, v10, v67, v68
    v_max3_f32 v10, v10, v69, v70
    v_max3_f32 v10, v10, v71, v72
    v_max3_f32 v10, v10, v73, v74
    v_max3_f32 v10, v10, v75, v76
    v_max3_f32 v10, v10, v77, v78
    v_max_f32 v10, v10, v79
    v_mov_b32 v11, v10
    v_mov_b32 v12, v10
    s_nop 1
    v_permlane32_swap_b32 v11, v12
    v_max_f32 v11, v11, v12
    v_max_f32 v11, 0, v11
    v_add_f32 v9, v9, v11
    v_sub_f32 v64, v64, v11
    v_sub_f32 v65, v65, v11
    v_sub_f32 v66, v66, v11
    v_sub_f32 v67, v67, v11
    v_sub_f32 v68, v68, v11
    v_sub_f32 v69, v69, v11
    v_sub_f32 v70, v70, v11
    v_sub_f32 v71, v71, v11
    v_sub_f32 v72, v72, v11
    v_sub_f32 v73, v73, v11
    v_sub_f32 v74, v74, v11
    v_sub_f32 v75, v75, v11
    v_sub_f32 v76, v76, v11
    v_sub_f32 v77, v77, v11
    v_sub_f32 v78, v78, v11
    v_sub_f32 v79, v79, v11
    v_sub_f32 v96, v96, v11
    v_sub_f32 v97, v97, v11
    v_sub_f32 v98, v98, v11
    v_sub_f32 v99, v99, v11
    v_sub_f32 v100, v100, v11
    v_sub_f32 v101, v101, v11
    v_sub_f32 v102, v102, v11
    v_sub_f32 v103, v103, v11
    v_sub_f32 v104, v104, v11
    v_sub_f32 v105, v105, v11
    v_sub_f32 v106, v106, v11
    v_sub_f32 v107, v107, v11
    v_sub_f32 v108, v108, v11
    v_sub_f32 v109, v109, v11
    v_sub_f32 v110, v110, v11
    v_sub_f32 v111, v111, v11
    v_sub_f32 v12, 0, v11
    v_exp_f32 v12, v12
    s_nop 0
    v_mul_f32 v6, v6, v12
    v_mul_f32 v7, v7, v12
    v_mul_f32 v144, v144, v12
    v_mul_f32 v145, v145, v12
    v_mul_f32 v146, v146, v12
    v_mul_f32 v147, v147, v12
    v_mul_f32 v148, v148, v12
    v_mul_f32 v149, v149, v12
    v_mul_f32 v150, v150, v12
    v_mul_f32 v151, v151, v12
    v_mul_f32 v152, v152, v12
    v_mul_f32 v153, v153, v12
    v_mul_f32 v154, v154, v12
    v_mul_f32 v155, v155, v12
    v_mul_f32 v156, v156, v12
    v_mul_f32 v157, v157, v12
    v_mul_f32 v158, v158, v12
    v_mul_f32 v159, v159, v12
    v_mul_f32 v160, v160, v12
    v_mul_f32 v161, v161, v12
    v_mul_f32 v162, v162, v12
    v_mul_f32 v163, v163, v12
    v_mul_f32 v164, v164, v12
    v_mul_f32 v165, v165, v12
    v_mul_f32 v166, v166, v12
    v_mul_f32 v167, v167, v12
    v_mul_f32 v168, v168, v12
    v_mul_f32 v169, v169, v12
    v_mul_f32 v170, v170, v12
    v_mul_f32 v171, v171, v12
    v_mul_f32 v172, v172, v12
    v_mul_f32 v173, v173, v12
    v_mul_f32 v174, v174, v12
    v_mul_f32 v175, v175, v12
    v_exp_f32 v64, v64
    v_exp_f32 v65, v65
    v_exp_f32 v66, v66
    v_exp_f32 v67, v67
    v_cvt_pk_bf16_f32 v184, v64, v65
    v_exp_f32 v68, v68
    v_exp_f32 v69, v69
    v_cvt_pk_bf16_f32 v185, v66, v67
    v_add_f32 v14, v64, v66
    v_add_f32 v15, v65, v67
    v_exp_f32 v70, v70
    v_exp_f32 v71, v71
    v_cvt_pk_bf16_f32 v186, v68, v69
    v_add_f32 v14, v14, v68
    v_add_f32 v15, v15, v69
    v_exp_f32 v72, v72
    v_exp_f32 v73, v73
    v_cvt_pk_bf16_f32 v187, v70, v71
    v_add_f32 v14, v14, v70
    v_add_f32 v15, v15, v71
    v_exp_f32 v74, v74
    v_exp_f32 v75, v75
    v_cvt_pk_bf16_f32 v188, v72, v73
    v_add_f32 v14, v14, v72
    v_add_f32 v15, v15, v73
    v_exp_f32 v76, v76
    v_exp_f32 v77, v77
    v_cvt_pk_bf16_f32 v189, v74, v75
    v_add_f32 v14, v14, v74
    v_add_f32 v15, v15, v75
    v_exp_f32 v78, v78
    v_exp_f32 v79, v79
    v_cvt_pk_bf16_f32 v190, v76, v77
    v_add_f32 v14, v14, v76
    v_add_f32 v15, v15, v77
    v_cvt_pk_bf16_f32 v191, v78, v79
    v_add_f32 v14, v14, v78
    v_add_f32 v15, v15, v79
    s_nop 4
    s_branch Lrs_attn_kernel_10_ret
Lrs_attn_kernel_11:
    s_nop 12
    v_mfma_f32_32x32x16_bf16 v[48:63], v[192:195], v[16:19], v[80:95]
    v_mfma_f32_32x32x16_bf16 v[48:63], v[196:199], v[20:23], v[48:63]
    v_mfma_f32_32x32x16_bf16 v[48:63], v[200:203], v[24:27], v[48:63]
    v_mfma_f32_32x32x16_bf16 v[48:63], v[204:207], v[28:31], v[48:63]
    s_nop 12
    v_max3_f32 v10, v48, v49, v50
    v_max3_f32 v10, v10, v51, v52
    v_max3_f32 v10, v10, v53, v54
    v_max3_f32 v10, v10, v55, v56
    v_max3_f32 v10, v10, v57, v58
    v_max3_f32 v10, v10, v59, v60
    v_max3_f32 v10, v10, v61, v62
    v_max_f32 v10, v10, v63
    v_mov_b32 v11, v10
    v_mov_b32 v12, v10
    s_nop 1
    v_permlane32_swap_b32 v11, v12
    v_max_f32 v11, v11, v12
    v_max_f32 v11, 0, v11
    v_add_f32 v8, v8, v11
    v_sub_f32 v48, v48, v11
    v_sub_f32 v49, v49, v11
    v_sub_f32 v50, v50, v11
    v_sub_f32 v51, v51, v11
    v_sub_f32 v52, v52, v11
    v_sub_f32 v53, v53, v11
    v_sub_f32 v54, v54, v11
    v_sub_f32 v55, v55, v11
    v_sub_f32 v56, v56, v11
    v_sub_f32 v57, v57, v11
    v_sub_f32 v58, v58, v11
    v_sub_f32 v59, v59, v11
    v_sub_f32 v60, v60, v11
    v_sub_f32 v61, v61, v11
    v_sub_f32 v62, v62, v11
    v_sub_f32 v63, v63, v11
    v_sub_f32 v80, v80, v11
    v_sub_f32 v81, v81, v11
    v_sub_f32 v82, v82, v11
    v_sub_f32 v83, v83, v11
    v_sub_f32 v84, v84, v11
    v_sub_f32 v85, v85, v11
    v_sub_f32 v86, v86, v11
    v_sub_f32 v87, v87, v11
    v_sub_f32 v88, v88, v11
    v_sub_f32 v89, v89, v11
    v_sub_f32 v90, v90, v11
    v_sub_f32 v91, v91, v11
    v_sub_f32 v92, v92, v11
    v_sub_f32 v93, v93, v11
    v_sub_f32 v94, v94, v11
    v_sub_f32 v95, v95, v11
    v_sub_f32 v12, 0, v11
    v_exp_f32 v12, v12
    s_nop 0
    v_mul_f32 v4, v4, v12
    v_mul_f32 v5, v5, v12
    v_mul_f32 v112, v112, v12
    v_mul_f32 v113, v113, v12
    v_mul_f32 v114, v114, v12
    v_mul_f32 v115, v115, v12
    v_mul_f32 v116, v116, v12
    v_mul_f32 v117, v117, v12
    v_mul_f32 v118, v118, v12
    v_mul_f32 v119, v119, v12
    v_mul_f32 v120, v120, v12
    v_mul_f32 v121, v121, v12
    v_mul_f32 v122, v122, v12
    v_mul_f32 v123, v123, v12
    v_mul_f32 v124, v124, v12
    v_mul_f32 v125, v125, v12
    v_mul_f32 v126, v126, v12
    v_mul_f32 v127, v127, v12
    v_mul_f32 v128, v128, v12
    v_mul_f32 v129, v129, v12
    v_mul_f32 v130, v130, v12
    v_mul_f32 v131, v131, v12
    v_mul_f32 v132, v132, v12
    v_mul_f32 v133, v133, v12
    v_mul_f32 v134, v134, v12
    v_mul_f32 v135, v135, v12
    v_mul_f32 v136, v136, v12
    v_mul_f32 v137, v137, v12
    v_mul_f32 v138, v138, v12
    v_mul_f32 v139, v139, v12
    v_mul_f32 v140, v140, v12
    v_mul_f32 v141, v141, v12
    v_mul_f32 v142, v142, v12
    v_mul_f32 v143, v143, v12
    v_exp_f32 v48, v48
    v_exp_f32 v49, v49
    v_exp_f32 v50, v50
    v_exp_f32 v51, v51
    v_cvt_pk_bf16_f32 v176, v48, v49
    v_exp_f32 v52, v52
    v_exp_f32 v53, v53
    v_cvt_pk_bf16_f32 v177, v50, v51
    v_add_f32 v14, v48, v50
    v_add_f32 v15, v49, v51
    v_exp_f32 v54, v54
    v_exp_f32 v55, v55
    v_cvt_pk_bf16_f32 v178, v52, v53
    v_add_f32 v14, v14, v52
    v_add_f32 v15, v15, v53
    v_exp_f32 v56, v56
    v_exp_f32 v57, v57
    v_cvt_pk_bf16_f32 v179, v54, v55
    v_add_f32 v14, v14, v54
    v_add_f32 v15, v15, v55
    v_exp_f32 v58, v58
    v_exp_f32 v59, v59
    v_cvt_pk_bf16_f32 v180, v56, v57
    v_add_f32 v14, v14, v56
    v_add_f32 v15, v15, v57
    v_exp_f32 v60, v60
    v_exp_f32 v61, v61
    v_cvt_pk_bf16_f32 v181, v58, v59
    v_add_f32 v14, v14, v58
    v_add_f32 v15, v15, v59
    v_exp_f32 v62, v62
    v_exp_f32 v63, v63
    v_cvt_pk_bf16_f32 v182, v60, v61
    v_add_f32 v14, v14, v60
    v_add_f32 v15, v15, v61
    v_cvt_pk_bf16_f32 v183, v62, v63
    v_add_f32 v14, v14, v62
    v_add_f32 v15, v15, v63
    s_nop 4
    s_branch Lrs_attn_kernel_11_ret
Lrs_attn_kernel_12:
    s_nop 12
    v_mfma_f32_32x32x16_bf16 v[64:79], v[192:195], v[32:35], v[96:111]
    v_mfma_f32_32x32x16_bf16 v[64:79], v[196:199], v[36:39], v[64:79]
    v_mfma_f32_32x32x16_bf16 v[64:79], v[200:203], v[40:43], v[64:79]
    v_mfma_f32_32x32x16_bf16 v[64:79], v[204:207], v[44:47], v[64:79]
    s_nop 12
    v_max3_f32 v10, v64, v65, v66
    v_max3_f32 v10, v10, v67, v68
    v_max3_f32 v10, v10, v69, v70
    v_max3_f32 v10, v10, v71, v72
    v_max3_f32 v10, v10, v73, v74
    v_max3_f32 v10, v10, v75, v76
    v_max3_f32 v10, v10, v77, v78
    v_max_f32 v10, v10, v79
    v_mov_b32 v11, v10
    v_mov_b32 v12, v10
    s_nop 1
    v_permlane32_swap_b32 v11, v12
    v_max_f32 v11, v11, v12
    v_max_f32 v11, 0, v11
    v_add_f32 v9, v9, v11
    v_sub_f32 v64, v64, v11
    v_sub_f32 v65, v65, v11
    v_sub_f32 v66, v66, v11
    v_sub_f32 v67, v67, v11
    v_sub_f32 v68, v68, v11
    v_sub_f32 v69, v69, v11
    v_sub_f32 v70, v70, v11
    v_sub_f32 v71, v71, v11
    v_sub_f32 v72, v72, v11
    v_sub_f32 v73, v73, v11
    v_sub_f32 v74, v74, v11
    v_sub_f32 v75, v75, v11
    v_sub_f32 v76, v76, v11
    v_sub_f32 v77, v77, v11
    v_sub_f32 v78, v78, v11
    v_sub_f32 v79, v79, v11
    v_sub_f32 v96, v96, v11
    v_sub_f32 v97, v97, v11
    v_sub_f32 v98, v98, v11
    v_sub_f32 v99, v99, v11
    v_sub_f32 v100, v100, v11
    v_sub_f32 v101, v101, v11
    v_sub_f32 v102, v102, v11
    v_sub_f32 v103, v103, v11
    v_sub_f32 v104, v104, v11
    v_sub_f32 v105, v105, v11
    v_sub_f32 v106, v106, v11
    v_sub_f32 v107, v107, v11
    v_sub_f32 v108, v108, v11
    v_sub_f32 v109, v109, v11
    v_sub_f32 v110, v110, v11
    v_sub_f32 v111, v111, v11
    v_sub_f32 v12, 0, v11
    v_exp_f32 v12, v12
    s_nop 0
    v_mul_f32 v6, v6, v12
    v_mul_f32 v7, v7, v12
    v_mul_f32 v144, v144, v12
    v_mul_f32 v145, v145, v12
    v_mul_f32 v146, v146, v12
    v_mul_f32 v147, v147, v12
    v_mul_f32 v148, v148, v12
    v_mul_f32 v149, v149, v12
    v_mul_f32 v150, v150, v12
    v_mul_f32 v151, v151, v12
    v_mul_f32 v152, v152, v12
    v_mul_f32 v153, v153, v12
    v_mul_f32 v154, v154, v12
    v_mul_f32 v155, v155, v12
    v_mul_f32 v156, v156, v12
    v_mul_f32 v157, v157, v12
    v_mul_f32 v158, v158, v12
    v_mul_f32 v159, v159, v12
    v_mul_f32 v160, v160, v12
    v_mul_f32 v161, v161, v12
    v_mul_f32 v162, v162, v12
    v_mul_f32 v163, v163, v12
    v_mul_f32 v164, v164, v12
    v_mul_f32 v165, v165, v12
    v_mul_f32 v166, v166, v12
    v_mul_f32 v167, v167, v12
    v_mul_f32 v168, v168, v12
    v_mul_f32 v169, v169, v12
    v_mul_f32 v170, v170, v12
    v_mul_f32 v171, v171, v12
    v_mul_f32 v172, v172, v12
    v_mul_f32 v173, v173, v12
    v_mul_f32 v174, v174, v12
    v_mul_f32 v175, v175, v12
    v_exp_f32 v64, v64
    v_exp_f32 v65, v65
    v_exp_f32 v66, v66
    v_exp_f32 v67, v67
    v_cvt_pk_bf16_f32 v184, v64, v65
    v_exp_f32 v68, v68
    v_exp_f32 v69, v69
    v_cvt_pk_bf16_f32 v185, v66, v67
    v_add_f32 v14, v64, v66
    v_add_f32 v15, v65, v67
    v_exp_f32 v70, v70
    v_exp_f32 v71, v71
    v_cvt_pk_bf16_f32 v186, v68, v69
    v_add_f32 v14, v14, v68
    v_add_f32 v15, v15, v69
    v_exp_f32 v72, v72
    v_exp_f32 v73, v73
    v_cvt_pk_bf16_f32 v187, v70, v71
    v_add_f32 v14, v14, v70
    v_add_f32 v15, v15, v71
    v_exp_f32 v74, v74
    v_exp_f32 v75, v75
    v_cvt_pk_bf16_f32 v188, v72, v73
    v_add_f32 v14, v14, v72
    v_add_f32 v15, v15, v73
    v_exp_f32 v76, v76
    v_exp_f32 v77, v77
    v_cvt_pk_bf16_f32 v189, v74, v75
    v_add_f32 v14, v14, v74
    v_add_f32 v15, v15, v75
    v_exp_f32 v78, v78
    v_exp_f32 v79, v79
    v_cvt_pk_bf16_f32 v190, v76, v77
    v_add_f32 v14, v14, v76
    v_add_f32 v15, v15, v77
    v_cvt_pk_bf16_f32 v191, v78, v79
    v_add_f32 v14, v14, v78
    v_add_f32 v15, v15, v79
    s_nop 4
    s_branch Lrs_attn_kernel_12_ret
Lrs_attn_kernel_13:
    s_nop 12
    v_mfma_f32_32x32x16_bf16 v[48:63], v[208:211], v[16:19], v[80:95]
    v_mfma_f32_32x32x16_bf16 v[48:63], v[212:215], v[20:23], v[48:63]
    v_mfma_f32_32x32x16_bf16 v[48:63], v[216:219], v[24:27], v[48:63]
    v_mfma_f32_32x32x16_bf16 v[48:63], v[220:223], v[28:31], v[48:63]
    s_nop 12
    v_max3_f32 v10, v48, v49, v50
    v_max3_f32 v10, v10, v51, v52
    v_max3_f32 v10, v10, v53, v54
    v_max3_f32 v10, v10, v55, v56
    v_max3_f32 v10, v10, v57, v58
    v_max3_f32 v10, v10, v59, v60
    v_max3_f32 v10, v10, v61, v62
    v_max_f32 v10, v10, v63
    v_mov_b32 v11, v10
    v_mov_b32 v12, v10
    s_nop 1
    v_permlane32_swap_b32 v11, v12
    v_max_f32 v11, v11, v12
    v_max_f32 v11, 0, v11
    v_add_f32 v8, v8, v11
    v_sub_f32 v48, v48, v11
    v_sub_f32 v49, v49, v11
    v_sub_f32 v50, v50, v11
    v_sub_f32 v51, v51, v11
    v_sub_f32 v52, v52, v11
    v_sub_f32 v53, v53, v11
    v_sub_f32 v54, v54, v11
    v_sub_f32 v55, v55, v11
    v_sub_f32 v56, v56, v11
    v_sub_f32 v57, v57, v11
    v_sub_f32 v58, v58, v11
    v_sub_f32 v59, v59, v11
    v_sub_f32 v60, v60, v11
    v_sub_f32 v61, v61, v11
    v_sub_f32 v62, v62, v11
    v_sub_f32 v63, v63, v11
    v_sub_f32 v80, v80, v11
    v_sub_f32 v81, v81, v11
    v_sub_f32 v82, v82, v11
    v_sub_f32 v83, v83, v11
    v_sub_f32 v84, v84, v11
    v_sub_f32 v85, v85, v11
    v_sub_f32 v86, v86, v11
    v_sub_f32 v87, v87, v11
    v_sub_f32 v88, v88, v11
    v_sub_f32 v89, v89, v11
    v_sub_f32 v90, v90, v11
    v_sub_f32 v91, v91, v11
    v_sub_f32 v92, v92, v11
    v_sub_f32 v93, v93, v11
    v_sub_f32 v94, v94, v11
    v_sub_f32 v95, v95, v11
    v_sub_f32 v12, 0, v11
    v_exp_f32 v12, v12
    s_nop 0
    v_mul_f32 v4, v4, v12
    v_mul_f32 v5, v5, v12
    v_mul_f32 v112, v112, v12
    v_mul_f32 v113, v113, v12
    v_mul_f32 v114, v114, v12
    v_mul_f32 v115, v115, v12
    v_mul_f32 v116, v116, v12
    v_mul_f32 v117, v117, v12
    v_mul_f32 v118, v118, v12
    v_mul_f32 v119, v119, v12
    v_mul_f32 v120, v120, v12
    v_mul_f32 v121, v121, v12
    v_mul_f32 v122, v122, v12
    v_mul_f32 v123, v123, v12
    v_mul_f32 v124, v124, v12
    v_mul_f32 v125, v125, v12
    v_mul_f32 v126, v126, v12
    v_mul_f32 v127, v127, v12
    v_mul_f32 v128, v128, v12
    v_mul_f32 v129, v129, v12
    v_mul_f32 v130, v130, v12
    v_mul_f32 v131, v131, v12
    v_mul_f32 v132, v132, v12
    v_mul_f32 v133, v133, v12
    v_mul_f32 v134, v134, v12
    v_mul_f32 v135, v135, v12
    v_mul_f32 v136, v136, v12
    v_mul_f32 v137, v137, v12
    v_mul_f32 v138, v138, v12
    v_mul_f32 v139, v139, v12
    v_mul_f32 v140, v140, v12
    v_mul_f32 v141, v141, v12
    v_mul_f32 v142, v142, v12
    v_mul_f32 v143, v143, v12
    v_exp_f32 v48, v48
    v_exp_f32 v49, v49
    v_exp_f32 v50, v50
    v_exp_f32 v51, v51
    v_cvt_pk_bf16_f32 v176, v48, v49
    v_exp_f32 v52, v52
    v_exp_f32 v53, v53
    v_cvt_pk_bf16_f32 v177, v50, v51
    v_add_f32 v14, v48, v50
    v_add_f32 v15, v49, v51
    v_exp_f32 v54, v54
    v_exp_f32 v55, v55
    v_cvt_pk_bf16_f32 v178, v52, v53
    v_add_f32 v14, v14, v52
    v_add_f32 v15, v15, v53
    v_exp_f32 v56, v56
    v_exp_f32 v57, v57
    v_cvt_pk_bf16_f32 v179, v54, v55
    v_add_f32 v14, v14, v54
    v_add_f32 v15, v15, v55
    v_exp_f32 v58, v58
    v_exp_f32 v59, v59
    v_cvt_pk_bf16_f32 v180, v56, v57
    v_add_f32 v14, v14, v56
    v_add_f32 v15, v15, v57
    v_exp_f32 v60, v60
    v_exp_f32 v61, v61
    v_cvt_pk_bf16_f32 v181, v58, v59
    v_add_f32 v14, v14, v58
    v_add_f32 v15, v15, v59
    v_exp_f32 v62, v62
    v_exp_f32 v63, v63
    v_cvt_pk_bf16_f32 v182, v60, v61
    v_add_f32 v14, v14, v60
    v_add_f32 v15, v15, v61
    v_cvt_pk_bf16_f32 v183, v62, v63
    v_add_f32 v14, v14, v62
    v_add_f32 v15, v15, v63
    s_nop 4
    s_branch Lrs_attn_kernel_13_ret
Lrs_attn_kernel_14:
    s_nop 12
    v_mfma_f32_32x32x16_bf16 v[64:79], v[208:211], v[32:35], v[96:111]
    v_mfma_f32_32x32x16_bf16 v[64:79], v[212:215], v[36:39], v[64:79]
    v_mfma_f32_32x32x16_bf16 v[64:79], v[216:219], v[40:43], v[64:79]
    v_mfma_f32_32x32x16_bf16 v[64:79], v[220:223], v[44:47], v[64:79]
    s_nop 12
    v_max3_f32 v10, v64, v65, v66
    v_max3_f32 v10, v10, v67, v68
    v_max3_f32 v10, v10, v69, v70
    v_max3_f32 v10, v10, v71, v72
    v_max3_f32 v10, v10, v73, v74
    v_max3_f32 v10, v10, v75, v76
    v_max3_f32 v10, v10, v77, v78
    v_max_f32 v10, v10, v79
    v_mov_b32 v11, v10
    v_mov_b32 v12, v10
    s_nop 1
    v_permlane32_swap_b32 v11, v12
    v_max_f32 v11, v11, v12
    v_max_f32 v11, 0, v11
    v_add_f32 v9, v9, v11
    v_sub_f32 v64, v64, v11
    v_sub_f32 v65, v65, v11
    v_sub_f32 v66, v66, v11
    v_sub_f32 v67, v67, v11
    v_sub_f32 v68, v68, v11
    v_sub_f32 v69, v69, v11
    v_sub_f32 v70, v70, v11
    v_sub_f32 v71, v71, v11
    v_sub_f32 v72, v72, v11
    v_sub_f32 v73, v73, v11
    v_sub_f32 v74, v74, v11
    v_sub_f32 v75, v75, v11
    v_sub_f32 v76, v76, v11
    v_sub_f32 v77, v77, v11
    v_sub_f32 v78, v78, v11
    v_sub_f32 v79, v79, v11
    v_sub_f32 v96, v96, v11
    v_sub_f32 v97, v97, v11
    v_sub_f32 v98, v98, v11
    v_sub_f32 v99, v99, v11
    v_sub_f32 v100, v100, v11
    v_sub_f32 v101, v101, v11
    v_sub_f32 v102, v102, v11
    v_sub_f32 v103, v103, v11
    v_sub_f32 v104, v104, v11
    v_sub_f32 v105, v105, v11
    v_sub_f32 v106, v106, v11
    v_sub_f32 v107, v107, v11
    v_sub_f32 v108, v108, v11
    v_sub_f32 v109, v109, v11
    v_sub_f32 v110, v110, v11
    v_sub_f32 v111, v111, v11
    v_sub_f32 v12, 0, v11
    v_exp_f32 v12, v12
    s_nop 0
    v_mul_f32 v6, v6, v12
    v_mul_f32 v7, v7, v12
    v_mul_f32 v144, v144, v12
    v_mul_f32 v145, v145, v12
    v_mul_f32 v146, v146, v12
    v_mul_f32 v147, v147, v12
    v_mul_f32 v148, v148, v12
    v_mul_f32 v149, v149, v12
    v_mul_f32 v150, v150, v12
    v_mul_f32 v151, v151, v12
    v_mul_f32 v152, v152, v12
    v_mul_f32 v153, v153, v12
    v_mul_f32 v154, v154, v12
    v_mul_f32 v155, v155, v12
    v_mul_f32 v156, v156, v12
    v_mul_f32 v157, v157, v12
    v_mul_f32 v158, v158, v12
    v_mul_f32 v159, v159, v12
    v_mul_f32 v160, v160, v12
    v_mul_f32 v161, v161, v12
    v_mul_f32 v162, v162, v12
    v_mul_f32 v163, v163, v12
    v_mul_f32 v164, v164, v12
    v_mul_f32 v165, v165, v12
    v_mul_f32 v166, v166, v12
    v_mul_f32 v167, v167, v12
    v_mul_f32 v168, v168, v12
    v_mul_f32 v169, v169, v12
    v_mul_f32 v170, v170, v12
    v_mul_f32 v171, v171, v12
    v_mul_f32 v172, v172, v12
    v_mul_f32 v173, v173, v12
    v_mul_f32 v174, v174, v12
    v_mul_f32 v175, v175, v12
    v_exp_f32 v64, v64
    v_exp_f32 v65, v65
    v_exp_f32 v66, v66
    v_exp_f32 v67, v67
    v_cvt_pk_bf16_f32 v184, v64, v65
    v_exp_f32 v68, v68
    v_exp_f32 v69, v69
    v_cvt_pk_bf16_f32 v185, v66, v67
    v_add_f32 v14, v64, v66
    v_add_f32 v15, v65, v67
    v_exp_f32 v70, v70
    v_exp_f32 v71, v71
    v_cvt_pk_bf16_f32 v186, v68, v69
    v_add_f32 v14, v14, v68
    v_add_f32 v15, v15, v69
    v_exp_f32 v72, v72
    v_exp_f32 v73, v73
    v_cvt_pk_bf16_f32 v187, v70, v71
    v_add_f32 v14, v14, v70
    v_add_f32 v15, v15, v71
    v_exp_f32 v74, v74
    v_exp_f32 v75, v75
    v_cvt_pk_bf16_f32 v188, v72, v73
    v_add_f32 v14, v14, v72
    v_add_f32 v15, v15, v73
    v_exp_f32 v76, v76
    v_exp_f32 v77, v77
    v_cvt_pk_bf16_f32 v189, v74, v75
    v_add_f32 v14, v14, v74
    v_add_f32 v15, v15, v75
    v_exp_f32 v78, v78
    v_exp_f32 v79, v79
    v_cvt_pk_bf16_f32 v190, v76, v77
    v_add_f32 v14, v14, v76
    v_add_f32 v15, v15, v77
    v_cvt_pk_bf16_f32 v191, v78, v79
    v_add_f32 v14, v14, v78
    v_add_f32 v15, v15, v79
    s_nop 4
    s_branch Lrs_attn_kernel_14_ret
Lrs_attn_kernel_15:
    s_nop 12
    v_mfma_f32_32x32x16_bf16 v[48:63], v[192:195], v[16:19], v[80:95]
    v_mfma_f32_32x32x16_bf16 v[48:63], v[196:199], v[20:23], v[48:63]
    v_mfma_f32_32x32x16_bf16 v[48:63], v[200:203], v[24:27], v[48:63]
    v_mfma_f32_32x32x16_bf16 v[48:63], v[204:207], v[28:31], v[48:63]
    s_nop 12
    v_max3_f32 v10, v48, v49, v50
    v_max3_f32 v10, v10, v51, v52
    v_max3_f32 v10, v10, v53, v54
    v_max3_f32 v10, v10, v55, v56
    v_max3_f32 v10, v10, v57, v58
    v_max3_f32 v10, v10, v59, v60
    v_max3_f32 v10, v10, v61, v62
    v_max_f32 v10, v10, v63
    v_mov_b32 v11, v10
    v_mov_b32 v12, v10
    s_nop 1
    v_permlane32_swap_b32 v11, v12
    v_max_f32 v11, v11, v12
    v_max_f32 v11, 0, v11
    v_add_f32 v8, v8, v11
    v_sub_f32 v48, v48, v11
    v_sub_f32 v49, v49, v11
    v_sub_f32 v50, v50, v11
    v_sub_f32 v51, v51, v11
    v_sub_f32 v52, v52, v11
    v_sub_f32 v53, v53, v11
    v_sub_f32 v54, v54, v11
    v_sub_f32 v55, v55, v11
    v_sub_f32 v56, v56, v11
    v_sub_f32 v57, v57, v11
    v_sub_f32 v58, v58, v11
    v_sub_f32 v59, v59, v11
    v_sub_f32 v60, v60, v11
    v_sub_f32 v61, v61, v11
    v_sub_f32 v62, v62, v11
    v_sub_f32 v63, v63, v11
    v_sub_f32 v80, v80, v11
    v_sub_f32 v81, v81, v11
    v_sub_f32 v82, v82, v11
    v_sub_f32 v83, v83, v11
    v_sub_f32 v84, v84, v11
    v_sub_f32 v85, v85, v11
    v_sub_f32 v86, v86, v11
    v_sub_f32 v87, v87, v11
    v_sub_f32 v88, v88, v11
    v_sub_f32 v89, v89, v11
    v_sub_f32 v90, v90, v11
    v_sub_f32 v91, v91, v11
    v_sub_f32 v92, v92, v11
    v_sub_f32 v93, v93, v11
    v_sub_f32 v94, v94, v11
    v_sub_f32 v95, v95, v11
    v_sub_f32 v12, 0, v11
    v_exp_f32 v12, v12
    s_nop 0
    v_mul_f32 v4, v4, v12
    v_mul_f32 v5, v5, v12
    v_mul_f32 v112, v112, v12
    v_mul_f32 v113, v113, v12
    v_mul_f32 v114, v114, v12
    v_mul_f32 v115, v115, v12
    v_mul_f32 v116, v116, v12
    v_mul_f32 v117, v117, v12
    v_mul_f32 v118, v118, v12
    v_mul_f32 v119, v119, v12
    v_mul_f32 v120, v120, v12
    v_mul_f32 v121, v121, v12
    v_mul_f32 v122, v122, v12
    v_mul_f32 v123, v123, v12
    v_mul_f32 v124, v124, v12
    v_mul_f32 v125, v125, v12
    v_mul_f32 v126, v126, v12
    v_mul_f32 v127, v127, v12
    v_mul_f32 v128, v128, v12
    v_mul_f32 v129, v129, v12
    v_mul_f32 v130, v130, v12
    v_mul_f32 v131, v131, v12
    v_mul_f32 v132, v132, v12
    v_mul_f32 v133, v133, v12
    v_mul_f32 v134, v134, v12
    v_mul_f32 v135, v135, v12
    v_mul_f32 v136, v136, v12
    v_mul_f32 v137, v137, v12
    v_mul_f32 v138, v138, v12
    v_mul_f32 v139, v139, v12
    v_mul_f32 v140, v140, v12
    v_mul_f32 v141, v141, v12
    v_mul_f32 v142, v142, v12
    v_mul_f32 v143, v143, v12
    v_exp_f32 v48, v48
    v_exp_f32 v49, v49
    v_exp_f32 v50, v50
    v_exp_f32 v51, v51
    v_cvt_pk_bf16_f32 v176, v48, v49
    v_exp_f32 v52, v52
    v_exp_f32 v53, v53
    v_cvt_pk_bf16_f32 v177, v50, v51
    v_add_f32 v14, v48, v50
    v_add_f32 v15, v49, v51
    v_exp_f32 v54, v54
    v_exp_f32 v55, v55
    v_cvt_pk_bf16_f32 v178, v52, v53
    v_add_f32 v14, v14, v52
    v_add_f32 v15, v15, v53
    v_exp_f32 v56, v56
    v_exp_f32 v57, v57
    v_cvt_pk_bf16_f32 v179, v54, v55
    v_add_f32 v14, v14, v54
    v_add_f32 v15, v15, v55
    v_exp_f32 v58, v58
    v_exp_f32 v59, v59
    v_cvt_pk_bf16_f32 v180, v56, v57
    v_add_f32 v14, v14, v56
    v_add_f32 v15, v15, v57
    v_exp_f32 v60, v60
    v_exp_f32 v61, v61
    v_cvt_pk_bf16_f32 v181, v58, v59
    v_add_f32 v14, v14, v58
    v_add_f32 v15, v15, v59
    v_exp_f32 v62, v62
    v_exp_f32 v63, v63
    v_cvt_pk_bf16_f32 v182, v60, v61
    v_add_f32 v14, v14, v60
    v_add_f32 v15, v15, v61
    v_cvt_pk_bf16_f32 v183, v62, v63
    v_add_f32 v14, v14, v62
    v_add_f32 v15, v15, v63
    s_nop 4
    s_branch Lrs_attn_kernel_15_ret
Lrs_attn_kernel_17:
    s_nop 12
    v_mfma_f32_32x32x16_bf16 v[64:79], v[192:195], v[32:35], v[96:111]
    v_mfma_f32_32x32x16_bf16 v[64:79], v[196:199], v[36:39], v[64:79]
    v_mfma_f32_32x32x16_bf16 v[64:79], v[200:203], v[40:43], v[64:79]
    v_mfma_f32_32x32x16_bf16 v[64:79], v[204:207], v[44:47], v[64:79]
    s_nop 12
    v_max3_f32 v10, v64, v65, v66
    v_max3_f32 v10, v10, v67, v68
    v_max3_f32 v10, v10, v69, v70
    v_max3_f32 v10, v10, v71, v72
    v_max3_f32 v10, v10, v73, v74
    v_max3_f32 v10, v10, v75, v76
    v_max3_f32 v10, v10, v77, v78
    v_max_f32 v10, v10, v79
    v_mov_b32 v11, v10
    v_mov_b32 v12, v10
    s_nop 1
    v_permlane32_swap_b32 v11, v12
    v_max_f32 v11, v11, v12
    v_max_f32 v11, 0, v11
    v_add_f32 v9, v9, v11
    v_sub_f32 v64, v64, v11
    v_sub_f32 v65, v65, v11
    v_sub_f32 v66, v66, v11
    v_sub_f32 v67, v67, v11
    v_sub_f32 v68, v68, v11
    v_sub_f32 v69, v69, v11
    v_sub_f32 v70, v70, v11
    v_sub_f32 v71, v71, v11
    v_sub_f32 v72, v72, v11
    v_sub_f32 v73, v73, v11
    v_sub_f32 v74, v74, v11
    v_sub_f32 v75, v75, v11
    v_sub_f32 v76, v76, v11
    v_sub_f32 v77, v77, v11
    v_sub_f32 v78, v78, v11
    v_sub_f32 v79, v79, v11
    v_sub_f32 v96, v96, v11
    v_sub_f32 v97, v97, v11
    v_sub_f32 v98, v98, v11
    v_sub_f32 v99, v99, v11
    v_sub_f32 v100, v100, v11
    v_sub_f32 v101, v101, v11
    v_sub_f32 v102, v102, v11
    v_sub_f32 v103, v103, v11
    v_sub_f32 v104, v104, v11
    v_sub_f32 v105, v105, v11
    v_sub_f32 v106, v106, v11
    v_sub_f32 v107, v107, v11
    v_sub_f32 v108, v108, v11
    v_sub_f32 v109, v109, v11
    v_sub_f32 v110, v110, v11
    v_sub_f32 v111, v111, v11
    v_sub_f32 v12, 0, v11
    v_exp_f32 v12, v12
    s_nop 0
    v_mul_f32 v6, v6, v12
    v_mul_f32 v7, v7, v12
    v_mul_f32 v144, v144, v12
    v_mul_f32 v145, v145, v12
    v_mul_f32 v146, v146, v12
    v_mul_f32 v147, v147, v12
    v_mul_f32 v148, v148, v12
    v_mul_f32 v149, v149, v12
    v_mul_f32 v150, v150, v12
    v_mul_f32 v151, v151, v12
    v_mul_f32 v152, v152, v12
    v_mul_f32 v153, v153, v12
    v_mul_f32 v154, v154, v12
    v_mul_f32 v155, v155, v12
    v_mul_f32 v156, v156, v12
    v_mul_f32 v157, v157, v12
    v_mul_f32 v158, v158, v12
    v_mul_f32 v159, v159, v12
    v_mul_f32 v160, v160, v12
    v_mul_f32 v161, v161, v12
    v_mul_f32 v162, v162, v12
    v_mul_f32 v163, v163, v12
    v_mul_f32 v164, v164, v12
    v_mul_f32 v165, v165, v12
    v_mul_f32 v166, v166, v12
    v_mul_f32 v167, v167, v12
    v_mul_f32 v168, v168, v12
    v_mul_f32 v169, v169, v12
    v_mul_f32 v170, v170, v12
    v_mul_f32 v171, v171, v12
    v_mul_f32 v172, v172, v12
    v_mul_f32 v173, v173, v12
    v_mul_f32 v174, v174, v12
    v_mul_f32 v175, v175, v12
    v_exp_f32 v64, v64
    v_exp_f32 v65, v65
    v_exp_f32 v66, v66
    v_exp_f32 v67, v67
    v_cvt_pk_bf16_f32 v184, v64, v65
    v_exp_f32 v68, v68
    v_exp_f32 v69, v69
    v_cvt_pk_bf16_f32 v185, v66, v67
    v_add_f32 v14, v64, v66
    v_add_f32 v15, v65, v67
    v_exp_f32 v70, v70
    v_exp_f32 v71, v71
    v_cvt_pk_bf16_f32 v186, v68, v69
    v_add_f32 v14, v14, v68
    v_add_f32 v15, v15, v69
    v_exp_f32 v72, v72
    v_exp_f32 v73, v73
    v_cvt_pk_bf16_f32 v187, v70, v71
    v_add_f32 v14, v14, v70
    v_add_f32 v15, v15, v71
    v_exp_f32 v74, v74
    v_exp_f32 v75, v75
    v_cvt_pk_bf16_f32 v188, v72, v73
    v_add_f32 v14, v14, v72
    v_add_f32 v15, v15, v73
    v_exp_f32 v76, v76
    v_exp_f32 v77, v77
    v_cvt_pk_bf16_f32 v189, v74, v75
    v_add_f32 v14, v14, v74
    v_add_f32 v15, v15, v75
    v_exp_f32 v78, v78
    v_exp_f32 v79, v79
    v_cvt_pk_bf16_f32 v190, v76, v77
    v_add_f32 v14, v14, v76
    v_add_f32 v15, v15, v77
    v_cvt_pk_bf16_f32 v191, v78, v79
    v_add_f32 v14, v14, v78
    v_add_f32 v15, v15, v79
    s_nop 4
    s_branch Lrs_attn_kernel_17_ret
Lrs_attn_kernel_19:
    s_nop 12
    v_mfma_f32_32x32x16_bf16 v[48:63], v[208:211], v[16:19], v[80:95]
    v_mfma_f32_32x32x16_bf16 v[48:63], v[212:215], v[20:23], v[48:63]
    v_mfma_f32_32x32x16_bf16 v[48:63], v[216:219], v[24:27], v[48:63]
    v_mfma_f32_32x32x16_bf16 v[48:63], v[220:223], v[28:31], v[48:63]
    s_nop 12
    v_max3_f32 v10, v48, v49, v50
    v_max3_f32 v10, v10, v51, v52
    v_max3_f32 v10, v10, v53, v54
    v_max3_f32 v10, v10, v55, v56
    v_max3_f32 v10, v10, v57, v58
    v_max3_f32 v10, v10, v59, v60
    v_max3_f32 v10, v10, v61, v62
    v_max_f32 v10, v10, v63
    v_mov_b32 v11, v10
    v_mov_b32 v12, v10
    s_nop 1
    v_permlane32_swap_b32 v11, v12
    v_max_f32 v11, v11, v12
    v_max_f32 v11, 0, v11
    v_add_f32 v8, v8, v11
    v_sub_f32 v48, v48, v11
    v_sub_f32 v49, v49, v11
    v_sub_f32 v50, v50, v11
    v_sub_f32 v51, v51, v11
    v_sub_f32 v52, v52, v11
    v_sub_f32 v53, v53, v11
    v_sub_f32 v54, v54, v11
    v_sub_f32 v55, v55, v11
    v_sub_f32 v56, v56, v11
    v_sub_f32 v57, v57, v11
    v_sub_f32 v58, v58, v11
    v_sub_f32 v59, v59, v11
    v_sub_f32 v60, v60, v11
    v_sub_f32 v61, v61, v11
    v_sub_f32 v62, v62, v11
    v_sub_f32 v63, v63, v11
    v_sub_f32 v80, v80, v11
    v_sub_f32 v81, v81, v11
    v_sub_f32 v82, v82, v11
    v_sub_f32 v83, v83, v11
    v_sub_f32 v84, v84, v11
    v_sub_f32 v85, v85, v11
    v_sub_f32 v86, v86, v11
    v_sub_f32 v87, v87, v11
    v_sub_f32 v88, v88, v11
    v_sub_f32 v89, v89, v11
    v_sub_f32 v90, v90, v11
    v_sub_f32 v91, v91, v11
    v_sub_f32 v92, v92, v11
    v_sub_f32 v93, v93, v11
    v_sub_f32 v94, v94, v11
    v_sub_f32 v95, v95, v11
    v_sub_f32 v12, 0, v11
    v_exp_f32 v12, v12
    s_nop 0
    v_mul_f32 v4, v4, v12
    v_mul_f32 v5, v5, v12
    v_mul_f32 v112, v112, v12
    v_mul_f32 v113, v113, v12
    v_mul_f32 v114, v114, v12
    v_mul_f32 v115, v115, v12
    v_mul_f32 v116, v116, v12
    v_mul_f32 v117, v117, v12
    v_mul_f32 v118, v118, v12
    v_mul_f32 v119, v119, v12
    v_mul_f32 v120, v120, v12
    v_mul_f32 v121, v121, v12
    v_mul_f32 v122, v122, v12
    v_mul_f32 v123, v123, v12
    v_mul_f32 v124, v124, v12
    v_mul_f32 v125, v125, v12
    v_mul_f32 v126, v126, v12
    v_mul_f32 v127, v127, v12
    v_mul_f32 v128, v128, v12
    v_mul_f32 v129, v129, v12
    v_mul_f32 v130, v130, v12
    v_mul_f32 v131, v131, v12
    v_mul_f32 v132, v132, v12
    v_mul_f32 v133, v133, v12
    v_mul_f32 v134, v134, v12
    v_mul_f32 v135, v135, v12
    v_mul_f32 v136, v136, v12
    v_mul_f32 v137, v137, v12
    v_mul_f32 v138, v138, v12
    v_mul_f32 v139, v139, v12
    v_mul_f32 v140, v140, v12
    v_mul_f32 v141, v141, v12
    v_mul_f32 v142, v142, v12
    v_mul_f32 v143, v143, v12
    v_exp_f32 v48, v48
    v_exp_f32 v49, v49
    v_exp_f32 v50, v50
    v_exp_f32 v51, v51
    v_cvt_pk_bf16_f32 v176, v48, v49
    v_exp_f32 v52, v52
    v_exp_f32 v53, v53
    v_cvt_pk_bf16_f32 v177, v50, v51
    v_add_f32 v14, v48, v50
    v_add_f32 v15, v49, v51
    v_exp_f32 v54, v54
    v_exp_f32 v55, v55
    v_cvt_pk_bf16_f32 v178, v52, v53
    v_add_f32 v14, v14, v52
    v_add_f32 v15, v15, v53
    v_exp_f32 v56, v56
    v_exp_f32 v57, v57
    v_cvt_pk_bf16_f32 v179, v54, v55
    v_add_f32 v14, v14, v54
    v_add_f32 v15, v15, v55
    v_exp_f32 v58, v58
    v_exp_f32 v59, v59
    v_cvt_pk_bf16_f32 v180, v56, v57
    v_add_f32 v14, v14, v56
    v_add_f32 v15, v15, v57
    v_exp_f32 v60, v60
    v_exp_f32 v61, v61
    v_cvt_pk_bf16_f32 v181, v58, v59
    v_add_f32 v14, v14, v58
    v_add_f32 v15, v15, v59
    v_exp_f32 v62, v62
    v_exp_f32 v63, v63
    v_cvt_pk_bf16_f32 v182, v60, v61
    v_add_f32 v14, v14, v60
    v_add_f32 v15, v15, v61
    v_cvt_pk_bf16_f32 v183, v62, v63
    v_add_f32 v14, v14, v62
    v_add_f32 v15, v15, v63
    s_nop 4
    s_branch Lrs_attn_kernel_19_ret
Lrs_attn_kernel_20:
    s_nop 12
    v_mfma_f32_32x32x16_bf16 v[64:79], v[208:211], v[32:35], v[96:111]
    v_mfma_f32_32x32x16_bf16 v[64:79], v[212:215], v[36:39], v[64:79]
    v_mfma_f32_32x32x16_bf16 v[64:79], v[216:219], v[40:43], v[64:79]
    v_mfma_f32_32x32x16_bf16 v[64:79], v[220:223], v[44:47], v[64:79]
    s_nop 12
    v_max3_f32 v10, v64, v65, v66
    v_max3_f32 v10, v10, v67, v68
    v_max3_f32 v10, v10, v69, v70
    v_max3_f32 v10, v10, v71, v72
    v_max3_f32 v10, v10, v73, v74
    v_max3_f32 v10, v10, v75, v76
    v_max3_f32 v10, v10, v77, v78
    v_max_f32 v10, v10, v79
    v_mov_b32 v11, v10
    v_mov_b32 v12, v10
    s_nop 1
    v_permlane32_swap_b32 v11, v12
    v_max_f32 v11, v11, v12
    v_max_f32 v11, 0, v11
    v_add_f32 v9, v9, v11
    v_sub_f32 v64, v64, v11
    v_sub_f32 v65, v65, v11
    v_sub_f32 v66, v66, v11
    v_sub_f32 v67, v67, v11
    v_sub_f32 v68, v68, v11
    v_sub_f32 v69, v69, v11
    v_sub_f32 v70, v70, v11
    v_sub_f32 v71, v71, v11
    v_sub_f32 v72, v72, v11
    v_sub_f32 v73, v73, v11
    v_sub_f32 v74, v74, v11
    v_sub_f32 v75, v75, v11
    v_sub_f32 v76, v76, v11
    v_sub_f32 v77, v77, v11
    v_sub_f32 v78, v78, v11
    v_sub_f32 v79, v79, v11
    v_sub_f32 v96, v96, v11
    v_sub_f32 v97, v97, v11
    v_sub_f32 v98, v98, v11
    v_sub_f32 v99, v99, v11
    v_sub_f32 v100, v100, v11
    v_sub_f32 v101, v101, v11
    v_sub_f32 v102, v102, v11
    v_sub_f32 v103, v103, v11
    v_sub_f32 v104, v104, v11
    v_sub_f32 v105, v105, v11
    v_sub_f32 v106, v106, v11
    v_sub_f32 v107, v107, v11
    v_sub_f32 v108, v108, v11
    v_sub_f32 v109, v109, v11
    v_sub_f32 v110, v110, v11
    v_sub_f32 v111, v111, v11
    v_sub_f32 v12, 0, v11
    v_exp_f32 v12, v12
    s_nop 0
    v_mul_f32 v6, v6, v12
    v_mul_f32 v7, v7, v12
    v_mul_f32 v144, v144, v12
    v_mul_f32 v145, v145, v12
    v_mul_f32 v146, v146, v12
    v_mul_f32 v147, v147, v12
    v_mul_f32 v148, v148, v12
    v_mul_f32 v149, v149, v12
    v_mul_f32 v150, v150, v12
    v_mul_f32 v151, v151, v12
    v_mul_f32 v152, v152, v12
    v_mul_f32 v153, v153, v12
    v_mul_f32 v154, v154, v12
    v_mul_f32 v155, v155, v12
    v_mul_f32 v156, v156, v12
    v_mul_f32 v157, v157, v12
    v_mul_f32 v158, v158, v12
    v_mul_f32 v159, v159, v12
    v_mul_f32 v160, v160, v12
    v_mul_f32 v161, v161, v12
    v_mul_f32 v162, v162, v12
    v_mul_f32 v163, v163, v12
    v_mul_f32 v164, v164, v12
    v_mul_f32 v165, v165, v12
    v_mul_f32 v166, v166, v12
    v_mul_f32 v167, v167, v12
    v_mul_f32 v168, v168, v12
    v_mul_f32 v169, v169, v12
    v_mul_f32 v170, v170, v12
    v_mul_f32 v171, v171, v12
    v_mul_f32 v172, v172, v12
    v_mul_f32 v173, v173, v12
    v_mul_f32 v174, v174, v12
    v_mul_f32 v175, v175, v12
    v_exp_f32 v64, v64
    v_exp_f32 v65, v65
    v_exp_f32 v66, v66
    v_exp_f32 v67, v67
    v_cvt_pk_bf16_f32 v184, v64, v65
    v_exp_f32 v68, v68
    v_exp_f32 v69, v69
    v_cvt_pk_bf16_f32 v185, v66, v67
    v_add_f32 v14, v64, v66
    v_add_f32 v15, v65, v67
    v_exp_f32 v70, v70
    v_exp_f32 v71, v71
    v_cvt_pk_bf16_f32 v186, v68, v69
    v_add_f32 v14, v14, v68
    v_add_f32 v15, v15, v69
    v_exp_f32 v72, v72
    v_exp_f32 v73, v73
    v_cvt_pk_bf16_f32 v187, v70, v71
    v_add_f32 v14, v14, v70
    v_add_f32 v15, v15, v71
    v_exp_f32 v74, v74
    v_exp_f32 v75, v75
    v_cvt_pk_bf16_f32 v188, v72, v73
    v_add_f32 v14, v14, v72
    v_add_f32 v15, v15, v73
    v_exp_f32 v76, v76
    v_exp_f32 v77, v77
    v_cvt_pk_bf16_f32 v189, v74, v75
    v_add_f32 v14, v14, v74
    v_add_f32 v15, v15, v75
    v_exp_f32 v78, v78
    v_exp_f32 v79, v79
    v_cvt_pk_bf16_f32 v190, v76, v77
    v_add_f32 v14, v14, v76
    v_add_f32 v15, v15, v77
    v_cvt_pk_bf16_f32 v191, v78, v79
    v_add_f32 v14, v14, v78
    v_add_f32 v15, v15, v79
    s_nop 4
    s_branch Lrs_attn_kernel_20_ret
Lrs_attn_kernel_21:
    s_nop 12
    v_mfma_f32_32x32x16_bf16 v[48:63], v[192:195], v[16:19], v[80:95]
    v_mfma_f32_32x32x16_bf16 v[48:63], v[196:199], v[20:23], v[48:63]
    v_mfma_f32_32x32x16_bf16 v[48:63], v[200:203], v[24:27], v[48:63]
    v_mfma_f32_32x32x16_bf16 v[48:63], v[204:207], v[28:31], v[48:63]
    s_nop 12
    v_max3_f32 v10, v48, v49, v50
    v_max3_f32 v10, v10, v51, v52
    v_max3_f32 v10, v10, v53, v54
    v_max3_f32 v10, v10, v55, v56
    v_max3_f32 v10, v10, v57, v58
    v_max3_f32 v10, v10, v59, v60
    v_max3_f32 v10, v10, v61, v62
    v_max_f32 v10, v10, v63
    v_mov_b32 v11, v10
    v_mov_b32 v12, v10
    s_nop 1
    v_permlane32_swap_b32 v11, v12
    v_max_f32 v11, v11, v12
    v_max_f32 v11, 0, v11
    v_add_f32 v8, v8, v11
    v_sub_f32 v48, v48, v11
    v_sub_f32 v49, v49, v11
    v_sub_f32 v50, v50, v11
    v_sub_f32 v51, v51, v11
    v_sub_f32 v52, v52, v11
    v_sub_f32 v53, v53, v11
    v_sub_f32 v54, v54, v11
    v_sub_f32 v55, v55, v11
    v_sub_f32 v56, v56, v11
    v_sub_f32 v57, v57, v11
    v_sub_f32 v58, v58, v11
    v_sub_f32 v59, v59, v11
    v_sub_f32 v60, v60, v11
    v_sub_f32 v61, v61, v11
    v_sub_f32 v62, v62, v11
    v_sub_f32 v63, v63, v11
    v_sub_f32 v80, v80, v11
    v_sub_f32 v81, v81, v11
    v_sub_f32 v82, v82, v11
    v_sub_f32 v83, v83, v11
    v_sub_f32 v84, v84, v11
    v_sub_f32 v85, v85, v11
    v_sub_f32 v86, v86, v11
    v_sub_f32 v87, v87, v11
    v_sub_f32 v88, v88, v11
    v_sub_f32 v89, v89, v11
    v_sub_f32 v90, v90, v11
    v_sub_f32 v91, v91, v11
    v_sub_f32 v92, v92, v11
    v_sub_f32 v93, v93, v11
    v_sub_f32 v94, v94, v11
    v_sub_f32 v95, v95, v11
    v_sub_f32 v12, 0, v11
    v_exp_f32 v12, v12
    s_nop 0
    v_mul_f32 v4, v4, v12
    v_mul_f32 v5, v5, v12
    v_mul_f32 v112, v112, v12
    v_mul_f32 v113, v113, v12
    v_mul_f32 v114, v114, v12
    v_mul_f32 v115, v115, v12
    v_mul_f32 v116, v116, v12
    v_mul_f32 v117, v117, v12
    v_mul_f32 v118, v118, v12
    v_mul_f32 v119, v119, v12
    v_mul_f32 v120, v120, v12
    v_mul_f32 v121, v121, v12
    v_mul_f32 v122, v122, v12
    v_mul_f32 v123, v123, v12
    v_mul_f32 v124, v124, v12
    v_mul_f32 v125, v125, v12
    v_mul_f32 v126, v126, v12
    v_mul_f32 v127, v127, v12
    v_mul_f32 v128, v128, v12
    v_mul_f32 v129, v129, v12
    v_mul_f32 v130, v130, v12
    v_mul_f32 v131, v131, v12
    v_mul_f32 v132, v132, v12
    v_mul_f32 v133, v133, v12
    v_mul_f32 v134, v134, v12
    v_mul_f32 v135, v135, v12
    v_mul_f32 v136, v136, v12
    v_mul_f32 v137, v137, v12
    v_mul_f32 v138, v138, v12
    v_mul_f32 v139, v139, v12
    v_mul_f32 v140, v140, v12
    v_mul_f32 v141, v141, v12
    v_mul_f32 v142, v142, v12
    v_mul_f32 v143, v143, v12
    v_exp_f32 v48, v48
    v_exp_f32 v49, v49
    v_exp_f32 v50, v50
    v_exp_f32 v51, v51
    v_cvt_pk_bf16_f32 v176, v48, v49
    v_exp_f32 v52, v52
    v_exp_f32 v53, v53
    v_cvt_pk_bf16_f32 v177, v50, v51
    v_add_f32 v14, v48, v50
    v_add_f32 v15, v49, v51
    v_exp_f32 v54, v54
    v_exp_f32 v55, v55
    v_cvt_pk_bf16_f32 v178, v52, v53
    v_add_f32 v14, v14, v52
    v_add_f32 v15, v15, v53
    v_exp_f32 v56, v56
    v_exp_f32 v57, v57
    v_cvt_pk_bf16_f32 v179, v54, v55
    v_add_f32 v14, v14, v54
    v_add_f32 v15, v15, v55
    v_exp_f32 v58, v58
    v_exp_f32 v59, v59
    v_cvt_pk_bf16_f32 v180, v56, v57
    v_add_f32 v14, v14, v56
    v_add_f32 v15, v15, v57
    v_exp_f32 v60, v60
    v_exp_f32 v61, v61
    v_cvt_pk_bf16_f32 v181, v58, v59
    v_add_f32 v14, v14, v58
    v_add_f32 v15, v15, v59
    v_exp_f32 v62, v62
    v_exp_f32 v63, v63
    v_cvt_pk_bf16_f32 v182, v60, v61
    v_add_f32 v14, v14, v60
    v_add_f32 v15, v15, v61
    v_cvt_pk_bf16_f32 v183, v62, v63
    v_add_f32 v14, v14, v62
    v_add_f32 v15, v15, v63
    s_nop 4
    s_branch Lrs_attn_kernel_21_ret
Lrs_attn_kernel_22:
    s_nop 12
    v_mfma_f32_32x32x16_bf16 v[64:79], v[192:195], v[32:35], v[96:111]
    v_mfma_f32_32x32x16_bf16 v[64:79], v[196:199], v[36:39], v[64:79]
    v_mfma_f32_32x32x16_bf16 v[64:79], v[200:203], v[40:43], v[64:79]
    v_mfma_f32_32x32x16_bf16 v[64:79], v[204:207], v[44:47], v[64:79]
    s_nop 12
    v_max3_f32 v10, v64, v65, v66
    v_max3_f32 v10, v10, v67, v68
    v_max3_f32 v10, v10, v69, v70
    v_max3_f32 v10, v10, v71, v72
    v_max3_f32 v10, v10, v73, v74
    v_max3_f32 v10, v10, v75, v76
    v_max3_f32 v10, v10, v77, v78
    v_max_f32 v10, v10, v79
    v_mov_b32 v11, v10
    v_mov_b32 v12, v10
    s_nop 1
    v_permlane32_swap_b32 v11, v12
    v_max_f32 v11, v11, v12
    v_max_f32 v11, 0, v11
    v_add_f32 v9, v9, v11
    v_sub_f32 v64, v64, v11
    v_sub_f32 v65, v65, v11
    v_sub_f32 v66, v66, v11
    v_sub_f32 v67, v67, v11
    v_sub_f32 v68, v68, v11
    v_sub_f32 v69, v69, v11
    v_sub_f32 v70, v70, v11
    v_sub_f32 v71, v71, v11
    v_sub_f32 v72, v72, v11
    v_sub_f32 v73, v73, v11
    v_sub_f32 v74, v74, v11
    v_sub_f32 v75, v75, v11
    v_sub_f32 v76, v76, v11
    v_sub_f32 v77, v77, v11
    v_sub_f32 v78, v78, v11
    v_sub_f32 v79, v79, v11
    v_sub_f32 v96, v96, v11
    v_sub_f32 v97, v97, v11
    v_sub_f32 v98, v98, v11
    v_sub_f32 v99, v99, v11
    v_sub_f32 v100, v100, v11
    v_sub_f32 v101, v101, v11
    v_sub_f32 v102, v102, v11
    v_sub_f32 v103, v103, v11
    v_sub_f32 v104, v104, v11
    v_sub_f32 v105, v105, v11
    v_sub_f32 v106, v106, v11
    v_sub_f32 v107, v107, v11
    v_sub_f32 v108, v108, v11
    v_sub_f32 v109, v109, v11
    v_sub_f32 v110, v110, v11
    v_sub_f32 v111, v111, v11
    v_sub_f32 v12, 0, v11
    v_exp_f32 v12, v12
    s_nop 0
    v_mul_f32 v6, v6, v12
    v_mul_f32 v7, v7, v12
    v_mul_f32 v144, v144, v12
    v_mul_f32 v145, v145, v12
    v_mul_f32 v146, v146, v12
    v_mul_f32 v147, v147, v12
    v_mul_f32 v148, v148, v12
    v_mul_f32 v149, v149, v12
    v_mul_f32 v150, v150, v12
    v_mul_f32 v151, v151, v12
    v_mul_f32 v152, v152, v12
    v_mul_f32 v153, v153, v12
    v_mul_f32 v154, v154, v12
    v_mul_f32 v155, v155, v12
    v_mul_f32 v156, v156, v12
    v_mul_f32 v157, v157, v12
    v_mul_f32 v158, v158, v12
    v_mul_f32 v159, v159, v12
    v_mul_f32 v160, v160, v12
    v_mul_f32 v161, v161, v12
    v_mul_f32 v162, v162, v12
    v_mul_f32 v163, v163, v12
    v_mul_f32 v164, v164, v12
    v_mul_f32 v165, v165, v12
    v_mul_f32 v166, v166, v12
    v_mul_f32 v167, v167, v12
    v_mul_f32 v168, v168, v12
    v_mul_f32 v169, v169, v12
    v_mul_f32 v170, v170, v12
    v_mul_f32 v171, v171, v12
    v_mul_f32 v172, v172, v12
    v_mul_f32 v173, v173, v12
    v_mul_f32 v174, v174, v12
    v_mul_f32 v175, v175, v12
    v_exp_f32 v64, v64
    v_exp_f32 v65, v65
    v_exp_f32 v66, v66
    v_exp_f32 v67, v67
    v_cvt_pk_bf16_f32 v184, v64, v65
    v_exp_f32 v68, v68
    v_exp_f32 v69, v69
    v_cvt_pk_bf16_f32 v185, v66, v67
    v_add_f32 v14, v64, v66
    v_add_f32 v15, v65, v67
    v_exp_f32 v70, v70
    v_exp_f32 v71, v71
    v_cvt_pk_bf16_f32 v186, v68, v69
    v_add_f32 v14, v14, v68
    v_add_f32 v15, v15, v69
    v_exp_f32 v72, v72
    v_exp_f32 v73, v73
    v_cvt_pk_bf16_f32 v187, v70, v71
    v_add_f32 v14, v14, v70
    v_add_f32 v15, v15, v71
    v_exp_f32 v74, v74
    v_exp_f32 v75, v75
    v_cvt_pk_bf16_f32 v188, v72, v73
    v_add_f32 v14, v14, v72
    v_add_f32 v15, v15, v73
    v_exp_f32 v76, v76
    v_exp_f32 v77, v77
    v_cvt_pk_bf16_f32 v189, v74, v75
    v_add_f32 v14, v14, v74
    v_add_f32 v15, v15, v75
    v_exp_f32 v78, v78
    v_exp_f32 v79, v79
    v_cvt_pk_bf16_f32 v190, v76, v77
    v_add_f32 v14, v14, v76
    v_add_f32 v15, v15, v77
    v_cvt_pk_bf16_f32 v191, v78, v79
    v_add_f32 v14, v14, v78
    v_add_f32 v15, v15, v79
    s_nop 4
    s_branch Lrs_attn_kernel_22_ret
Lrs_attn_kernel_23:
    s_nop 12
    v_mfma_f32_32x32x16_bf16 v[48:63], v[208:211], v[16:19], v[80:95]
    v_mfma_f32_32x32x16_bf16 v[48:63], v[212:215], v[20:23], v[48:63]
    v_mfma_f32_32x32x16_bf16 v[48:63], v[216:219], v[24:27], v[48:63]
    v_mfma_f32_32x32x16_bf16 v[48:63], v[220:223], v[28:31], v[48:63]
    s_nop 12
    v_max3_f32 v10, v48, v49, v50
    v_max3_f32 v10, v10, v51, v52
    v_max3_f32 v10, v10, v53, v54
    v_max3_f32 v10, v10, v55, v56
    v_max3_f32 v10, v10, v57, v58
    v_max3_f32 v10, v10, v59, v60
    v_max3_f32 v10, v10, v61, v62
    v_max_f32 v10, v10, v63
    v_mov_b32 v11, v10
    v_mov_b32 v12, v10
    s_nop 1
    v_permlane32_swap_b32 v11, v12
    v_max_f32 v11, v11, v12
    v_max_f32 v11, 0, v11
    v_add_f32 v8, v8, v11
    v_sub_f32 v48, v48, v11
    v_sub_f32 v49, v49, v11
    v_sub_f32 v50, v50, v11
    v_sub_f32 v51, v51, v11
    v_sub_f32 v52, v52, v11
    v_sub_f32 v53, v53, v11
    v_sub_f32 v54, v54, v11
    v_sub_f32 v55, v55, v11
    v_sub_f32 v56, v56, v11
    v_sub_f32 v57, v57, v11
    v_sub_f32 v58, v58, v11
    v_sub_f32 v59, v59, v11
    v_sub_f32 v60, v60, v11
    v_sub_f32 v61, v61, v11
    v_sub_f32 v62, v62, v11
    v_sub_f32 v63, v63, v11
    v_sub_f32 v80, v80, v11
    v_sub_f32 v81, v81, v11
    v_sub_f32 v82, v82, v11
    v_sub_f32 v83, v83, v11
    v_sub_f32 v84, v84, v11
    v_sub_f32 v85, v85, v11
    v_sub_f32 v86, v86, v11
    v_sub_f32 v87, v87, v11
    v_sub_f32 v88, v88, v11
    v_sub_f32 v89, v89, v11
    v_sub_f32 v90, v90, v11
    v_sub_f32 v91, v91, v11
    v_sub_f32 v92, v92, v11
    v_sub_f32 v93, v93, v11
    v_sub_f32 v94, v94, v11
    v_sub_f32 v95, v95, v11
    v_sub_f32 v12, 0, v11
    v_exp_f32 v12, v12
    s_nop 0
    v_mul_f32 v4, v4, v12
    v_mul_f32 v5, v5, v12
    v_mul_f32 v112, v112, v12
    v_mul_f32 v113, v113, v12
    v_mul_f32 v114, v114, v12
    v_mul_f32 v115, v115, v12
    v_mul_f32 v116, v116, v12
    v_mul_f32 v117, v117, v12
    v_mul_f32 v118, v118, v12
    v_mul_f32 v119, v119, v12
    v_mul_f32 v120, v120, v12
    v_mul_f32 v121, v121, v12
    v_mul_f32 v122, v122, v12
    v_mul_f32 v123, v123, v12
    v_mul_f32 v124, v124, v12
    v_mul_f32 v125, v125, v12
    v_mul_f32 v126, v126, v12
    v_mul_f32 v127, v127, v12
    v_mul_f32 v128, v128, v12
    v_mul_f32 v129, v129, v12
    v_mul_f32 v130, v130, v12
    v_mul_f32 v131, v131, v12
    v_mul_f32 v132, v132, v12
    v_mul_f32 v133, v133, v12
    v_mul_f32 v134, v134, v12
    v_mul_f32 v135, v135, v12
    v_mul_f32 v136, v136, v12
    v_mul_f32 v137, v137, v12
    v_mul_f32 v138, v138, v12
    v_mul_f32 v139, v139, v12
    v_mul_f32 v140, v140, v12
    v_mul_f32 v141, v141, v12
    v_mul_f32 v142, v142, v12
    v_mul_f32 v143, v143, v12
    v_exp_f32 v48, v48
    v_exp_f32 v49, v49
    v_exp_f32 v50, v50
    v_exp_f32 v51, v51
    v_cvt_pk_bf16_f32 v176, v48, v49
    v_exp_f32 v52, v52
    v_exp_f32 v53, v53
    v_cvt_pk_bf16_f32 v177, v50, v51
    v_add_f32 v14, v48, v50
    v_add_f32 v15, v49, v51
    v_exp_f32 v54, v54
    v_exp_f32 v55, v55
    v_cvt_pk_bf16_f32 v178, v52, v53
    v_add_f32 v14, v14, v52
    v_add_f32 v15, v15, v53
    v_exp_f32 v56, v56
    v_exp_f32 v57, v57
    v_cvt_pk_bf16_f32 v179, v54, v55
    v_add_f32 v14, v14, v54
    v_add_f32 v15, v15, v55
    v_exp_f32 v58, v58
    v_exp_f32 v59, v59
    v_cvt_pk_bf16_f32 v180, v56, v57
    v_add_f32 v14, v14, v56
    v_add_f32 v15, v15, v57
    v_exp_f32 v60, v60
    v_exp_f32 v61, v61
    v_cvt_pk_bf16_f32 v181, v58, v59
    v_add_f32 v14, v14, v58
    v_add_f32 v15, v15, v59
    v_exp_f32 v62, v62
    v_exp_f32 v63, v63
    v_cvt_pk_bf16_f32 v182, v60, v61
    v_add_f32 v14, v14, v60
    v_add_f32 v15, v15, v61
    v_cvt_pk_bf16_f32 v183, v62, v63
    v_add_f32 v14, v14, v62
    v_add_f32 v15, v15, v63
    s_nop 4
    s_branch Lrs_attn_kernel_23_ret
Lrs_attn_kernel_24:
    s_nop 12
    v_mfma_f32_32x32x16_bf16 v[64:79], v[208:211], v[32:35], v[96:111]
    v_mfma_f32_32x32x16_bf16 v[64:79], v[212:215], v[36:39], v[64:79]
    v_mfma_f32_32x32x16_bf16 v[64:79], v[216:219], v[40:43], v[64:79]
    v_mfma_f32_32x32x16_bf16 v[64:79], v[220:223], v[44:47], v[64:79]
    s_nop 12
    v_max3_f32 v10, v64, v65, v66
    v_max3_f32 v10, v10, v67, v68
    v_max3_f32 v10, v10, v69, v70
    v_max3_f32 v10, v10, v71, v72
    v_max3_f32 v10, v10, v73, v74
    v_max3_f32 v10, v10, v75, v76
    v_max3_f32 v10, v10, v77, v78
    v_max_f32 v10, v10, v79
    v_mov_b32 v11, v10
    v_mov_b32 v12, v10
    s_nop 1
    v_permlane32_swap_b32 v11, v12
    v_max_f32 v11, v11, v12
    v_max_f32 v11, 0, v11
    v_add_f32 v9, v9, v11
    v_sub_f32 v64, v64, v11
    v_sub_f32 v65, v65, v11
    v_sub_f32 v66, v66, v11
    v_sub_f32 v67, v67, v11
    v_sub_f32 v68, v68, v11
    v_sub_f32 v69, v69, v11
    v_sub_f32 v70, v70, v11
    v_sub_f32 v71, v71, v11
    v_sub_f32 v72, v72, v11
    v_sub_f32 v73, v73, v11
    v_sub_f32 v74, v74, v11
    v_sub_f32 v75, v75, v11
    v_sub_f32 v76, v76, v11
    v_sub_f32 v77, v77, v11
    v_sub_f32 v78, v78, v11
    v_sub_f32 v79, v79, v11
    v_sub_f32 v96, v96, v11
    v_sub_f32 v97, v97, v11
    v_sub_f32 v98, v98, v11
    v_sub_f32 v99, v99, v11
    v_sub_f32 v100, v100, v11
    v_sub_f32 v101, v101, v11
    v_sub_f32 v102, v102, v11
    v_sub_f32 v103, v103, v11
    v_sub_f32 v104, v104, v11
    v_sub_f32 v105, v105, v11
    v_sub_f32 v106, v106, v11
    v_sub_f32 v107, v107, v11
    v_sub_f32 v108, v108, v11
    v_sub_f32 v109, v109, v11
    v_sub_f32 v110, v110, v11
    v_sub_f32 v111, v111, v11
    v_sub_f32 v12, 0, v11
    v_exp_f32 v12, v12
    s_nop 0
    v_mul_f32 v6, v6, v12
    v_mul_f32 v7, v7, v12
    v_mul_f32 v144, v144, v12
    v_mul_f32 v145, v145, v12
    v_mul_f32 v146, v146, v12
    v_mul_f32 v147, v147, v12
    v_mul_f32 v148, v148, v12
    v_mul_f32 v149, v149, v12
    v_mul_f32 v150, v150, v12
    v_mul_f32 v151, v151, v12
    v_mul_f32 v152, v152, v12
    v_mul_f32 v153, v153, v12
    v_mul_f32 v154, v154, v12
    v_mul_f32 v155, v155, v12
    v_mul_f32 v156, v156, v12
    v_mul_f32 v157, v157, v12
    v_mul_f32 v158, v158, v12
    v_mul_f32 v159, v159, v12
    v_mul_f32 v160, v160, v12
    v_mul_f32 v161, v161, v12
    v_mul_f32 v162, v162, v12
    v_mul_f32 v163, v163, v12
    v_mul_f32 v164, v164, v12
    v_mul_f32 v165, v165, v12
    v_mul_f32 v166, v166, v12
    v_mul_f32 v167, v167, v12
    v_mul_f32 v168, v168, v12
    v_mul_f32 v169, v169, v12
    v_mul_f32 v170, v170, v12
    v_mul_f32 v171, v171, v12
    v_mul_f32 v172, v172, v12
    v_mul_f32 v173, v173, v12
    v_mul_f32 v174, v174, v12
    v_mul_f32 v175, v175, v12
    v_exp_f32 v64, v64
    v_exp_f32 v65, v65
    v_exp_f32 v66, v66
    v_exp_f32 v67, v67
    v_cvt_pk_bf16_f32 v184, v64, v65
    v_exp_f32 v68, v68
    v_exp_f32 v69, v69
    v_cvt_pk_bf16_f32 v185, v66, v67
    v_add_f32 v14, v64, v66
    v_add_f32 v15, v65, v67
    v_exp_f32 v70, v70
    v_exp_f32 v71, v71
    v_cvt_pk_bf16_f32 v186, v68, v69
    v_add_f32 v14, v14, v68
    v_add_f32 v15, v15, v69
    v_exp_f32 v72, v72
    v_exp_f32 v73, v73
    v_cvt_pk_bf16_f32 v187, v70, v71
    v_add_f32 v14, v14, v70
    v_add_f32 v15, v15, v71
    v_exp_f32 v74, v74
    v_exp_f32 v75, v75
    v_cvt_pk_bf16_f32 v188, v72, v73
    v_add_f32 v14, v14, v72
    v_add_f32 v15, v15, v73
    v_exp_f32 v76, v76
    v_exp_f32 v77, v77
    v_cvt_pk_bf16_f32 v189, v74, v75
    v_add_f32 v14, v14, v74
    v_add_f32 v15, v15, v75
    v_exp_f32 v78, v78
    v_exp_f32 v79, v79
    v_cvt_pk_bf16_f32 v190, v76, v77
    v_add_f32 v14, v14, v76
    v_add_f32 v15, v15, v77
    v_cvt_pk_bf16_f32 v191, v78, v79
    v_add_f32 v14, v14, v78
    v_add_f32 v15, v15, v79
    s_nop 4
    s_branch Lrs_attn_kernel_24_ret
L_k2_end_attn_kernel:
    s_endpgm
.globl post_kernel
.p2align 8
.type post_kernel,@function
post_kernel:
    s_cmp_ge_u32 s2, 250
    s_cbranch_scc1 L_k34_end_post_kernel
    s_load_dwordx2 s[6:7], s[0:1], 96
    v_lshrrev_b32 v6, 6, v0
    v_and_b32 v7, 63, v0
    v_readfirstlane_b32 s16, v6
    v_lshlrev_b32 v1, 4, v7
    v_and_b32 v8, 31, v0
    v_bfe_u32 v9, v0, 5, 1
    v_mul_u32_u24 v3, 80, v8
    v_lshlrev_b32 v10, 1, v6
    v_add_u32 v10, v10, v9
    v_lshlrev_b32 v10, 2, v10
    v_add_u32 v3, 98304, v3
    v_add_u32 v2, v10, v3
    v_add_u32 v5, 65536, v1
    v_lshlrev_b32 v10, 11, v6
    v_add_u32 v4, v10, v1
    v_add_u32 v4, 65536, v4
    s_load_dwordx2 s[4:5], s[0:1], 48
    s_load_dwordx2 s[24:25], s[0:1], 80
    s_lshl_b32 s18, s2, 14
    s_lshl_b32 s21, s16, 11
    s_add_u32 s19, s18, s21
    s_add_u32 s20, s19, 4194304
    s_add_u32 s19, s19, 25165824
    s_add_u32 s22, s21, 25165824
    s_add_u32 s23, s21, 4194304
    s_mul_i32 s17, s16, 196608
    s_add_u32 s17, s17, 1441792
    s_cmp_ge_u32 s2, 125
    s_cselect_b32 s26, 4000, 0
    s_lshl_b32 s27, s2, 5
    s_sub_u32 s28, s27, s26
    s_lshl_b32 s29, s16, 6
    v_subrev_u32 v12, 16, v8
    v_add_u32 v13, 16, v8
    v_cmp_gt_u32 vcc, 16, v8
    s_nop 1
    v_cndmask_b32 v12, v13, v12, vcc
    v_add_u32 v13, s28, v12
    v_add_u32 v12, s27, v12
    v_lshrrev_b32 v14, 5, v12
    v_lshlrev_b32 v14, 14, v14
    v_and_b32 v12, 31, v12
    v_lshl_add_u32 v12, v9, 5, v12
    v_lshl_add_u32 v14, v12, 4, v14
    v_mov_b32 v12, 0x80000000
    v_cmp_gt_u32 vcc, 4000, v13
    s_nop 1
    v_cndmask_b32 v15, v12, v14, vcc
    s_add_u32 s30, s21, 65536
    s_waitcnt lgkmcnt(0)
    s_mov_b32 s8, s4
    s_and_b32 s9, s5, 0xffff
    s_mov_b32 s10, 2560
    s_mov_b32 s11, 0x20000
    s_mov_b32 s12, s6
    s_and_b32 s13, s7, 0xffff
    s_mov_b32 s14, 41943040
    s_mov_b32 s15, 0x20000
    s_mov_b32 m0, s30
    s_nop 0
    buffer_load_dwordx4 v1, s[12:15], s19 offen lds
    buffer_load_dwordx4 v1, s[12:15], s19 offen offset:1024 lds
    s_add_u32 s30, s30, 16384
    s_mov_b32 m0, s30
    s_nop 0
    buffer_load_dwordx4 v15, s[12:15], s22 offen lds
    buffer_load_dwordx4 v15, s[12:15], s22 offen offset:1024 lds
    buffer_load_dwordx4 v[16:19], v1, s[12:15], s20 offen
    buffer_load_dwordx4 v[20:23], v1, s[12:15], s20 offen offset:1024
    buffer_load_dwordx4 v[64:67], v15, s[12:15], s23 offen
    buffer_load_dwordx4 v[68:71], v15, s[12:15], s23 offen offset:1024
    s_mov_b32 s30, 129024
    s_mov_b32 m0, s30
    s_nop 0
    buffer_load_dwordx4 v1, s[8:11], 0 offen offset:0 lds
    buffer_load_dwordx4 v1, s[8:11], 0 offen offset:1024 lds
    buffer_load_dwordx4 v1, s[8:11], 0 offen offset:2048 lds
    s_barrier
    buffer_load_dwordx4 v[168:171], v1, s[12:15], s17 offen offset:0
    buffer_load_dwordx4 v[172:175], v1, s[12:15], s17 offen offset:1024
    buffer_load_dwordx4 v[176:179], v1, s[12:15], s17 offen offset:2048
    buffer_load_dwordx4 v[180:183], v1, s[12:15], s17 offen offset:3072
    s_add_u32 s17, s17, 4096
    buffer_load_dwordx4 v[184:187], v1, s[12:15], s17 offen offset:0
    buffer_load_dwordx4 v[188:191], v1, s[12:15], s17 offen offset:1024
    s_lshl_b32 s19, s16, 13
    v_add_u32 v14, s19, v1
    v_add_u32 v0, 0, v14
    s_mul_i32 s19, s16, 2560
    s_add_u32 s19, s19, 108544
    v_lshlrev_b32 v14, 4, v9
    v_add_u32 v14, s19, v14
    v_lshl_add_u32 v254, v8, 5, v14
    v_add_u32 v252, 64, v254
    v_subrev_u32 v6, 14, v8
    v_add_u32 v7, 18, v8
    v_cmp_gt_u32 vcc, 16, v8
    s_nop 1
    v_cndmask_b32 v6, v7, v6, vcc
    v_subrev_u32 v7, 14, v8
    v_cmp_gt_u32 vcc, 4, v7
    v_mov_b32 v7, 38
    s_nop 0
    v_cndmask_b32 v6, v7, v6, vcc
    v_lshl_add_u32 v253, v6, 5, v14
    v_lshlrev_b32 v14, 3, v9
    v_add_u32 v14, s29, v14
    v_add_u32 v255, 129024, v14
    s_waitcnt vmcnt(16)
    s_waitcnt vmcnt(15)
    s_waitcnt vmcnt(13)
    s_barrier
    ds_read_b128 v[72:75], v5 offset:0
    ds_read_b128 v[76:79], v5 offset:1024
    ds_read_b128 v[80:83], v5 offset:2048
    ds_read_b128 v[84:87], v5 offset:3072
    ds_read_b128 v[88:91], v5 offset:4096
    ds_read_b128 v[92:95], v5 offset:5120
    ds_read_b128 v[96:99], v5 offset:6144
    ds_read_b128 v[100:103], v5 offset:7168
    ds_read_b128 v[104:107], v5 offset:8192
    ds_read_b128 v[108:111], v5 offset:9216
    ds_read_b128 v[112:115], v5 offset:10240
    ds_read_b128 v[116:119], v5 offset:11264
    ds_read_b128 v[120:123], v5 offset:12288
    ds_read_b128 v[124:127], v5 offset:13312
    ds_read_b128 v[128:131], v5 offset:14336
    ds_read_b128 v[132:135], v5 offset:15360
    s_waitcnt lgkmcnt(0)
    ds_read_b128 v[24:27], v5 offset:16384
    ds_read_b128 v[28:31], v5 offset:17408
    ds_read_b128 v[32:35], v5 offset:18432
    ds_read_b128 v[36:39], v5 offset:19456
    s_waitcnt vmcnt(5)
    v_mfma_f32_32x32x16_bf16 v[136:151], v[168:171], v[72:75], 0
    s_waitcnt lgkmcnt(3)
    v_mfma_f32_32x32x16_bf16 v[152:167], v[168:171], v[24:27], 0
    buffer_load_dwordx4 v[192:195], v1, s[12:15], s17 offen offset:2048
    buffer_load_dwordx4 v[196:199], v1, s[12:15], s17 offen offset:3072
    s_add_u32 s17, s17, 4096
    ds_read_b128 v[24:27], v5 offset:20480
    s_waitcnt vmcnt(6)
    v_mfma_f32_32x32x16_bf16 v[136:151], v[172:175], v[76:79], v[136:151]
    s_waitcnt lgkmcnt(3)
    v_mfma_f32_32x32x16_bf16 v[152:167], v[172:175], v[28:31], v[152:167]
    buffer_load_dwordx4 v[200:203], v1, s[12:15], s17 offen offset:0
    buffer_load_dwordx4 v[204:207], v1, s[12:15], s17 offen offset:1024
    ds_read_b128 v[28:31], v5 offset:21504
    s_waitcnt vmcnt(7)
    v_mfma_f32_32x32x16_bf16 v[136:151], v[176:179], v[80:83], v[136:151]
    s_waitcnt lgkmcnt(3)
    v_mfma_f32_32x32x16_bf16 v[152:167], v[176:179], v[32:35], v[152:167]
    buffer_load_dwordx4 v[208:211], v1, s[12:15], s17 offen offset:2048
    buffer_load_dwordx4 v[212:215], v1, s[12:15], s17 offen offset:3072
    s_add_u32 s17, s17, 4096
    ds_read_b128 v[32:35], v5 offset:22528
    s_waitcnt vmcnt(8)
    v_mfma_f32_32x32x16_bf16 v[136:151], v[180:183], v[84:87], v[136:151]
    s_waitcnt lgkmcnt(3)
    v_mfma_f32_32x32x16_bf16 v[152:167], v[180:183], v[36:39], v[152:167]
    buffer_load_dwordx4 v[216:219], v1, s[12:15], s17 offen offset:0
    buffer_load_dwordx4 v[220:223], v1, s[12:15], s17 offen offset:1024
    ds_read_b128 v[36:39], v5 offset:23552
    s_waitcnt vmcnt(9)
    v_mfma_f32_32x32x16_bf16 v[136:151], v[184:187], v[88:91], v[136:151]
    s_waitcnt lgkmcnt(3)
    v_mfma_f32_32x32x16_bf16 v[152:167], v[184:187], v[24:27], v[152:167]
    buffer_load_dwordx4 v[224:227], v1, s[12:15], s17 offen offset:2048
    buffer_load_dwordx4 v[228:231], v1, s[12:15], s17 offen offset:3072
    s_add_u32 s17, s17, 4096
    ds_read_b128 v[24:27], v5 offset:24576
    s_waitcnt vmcnt(10)
    v_mfma_f32_32x32x16_bf16 v[136:151], v[188:191], v[92:95], v[136:151]
    s_waitcnt lgkmcnt(3)
    v_mfma_f32_32x32x16_bf16 v[152:167], v[188:191], v[28:31], v[152:167]
    buffer_load_dwordx4 v[232:235], v1, s[12:15], s17 offen offset:0
    buffer_load_dwordx4 v[236:239], v1, s[12:15], s17 offen offset:1024
    ds_read_b128 v[28:31], v5 offset:25600
    s_waitcnt vmcnt(11)
    v_mfma_f32_32x32x16_bf16 v[136:151], v[192:195], v[96:99], v[136:151]
    s_waitcnt lgkmcnt(3)
    v_mfma_f32_32x32x16_bf16 v[152:167], v[192:195], v[32:35], v[152:167]
    buffer_load_dwordx4 v[240:243], v1, s[12:15], s17 offen offset:2048
    buffer_load_dwordx4 v[244:247], v1, s[12:15], s17 offen offset:3072
    s_add_u32 s17, s17, 4096
    ds_read_b128 v[32:35], v5 offset:26624
    s_waitcnt vmcnt(12)
    v_mfma_f32_32x32x16_bf16 v[136:151], v[196:199], v[100:103], v[136:151]
    s_waitcnt lgkmcnt(3)
    v_mfma_f32_32x32x16_bf16 v[152:167], v[196:199], v[36:39], v[152:167]
    buffer_load_dwordx4 v[248:251], v1, s[12:15], s17 offen offset:0
    buffer_load_dwordx4 v[168:171], v1, s[12:15], s17 offen offset:1024
    ds_read_b128 v[36:39], v5 offset:27648
    s_waitcnt vmcnt(13)
    v_mfma_f32_32x32x16_bf16 v[136:151], v[200:203], v[104:107], v[136:151]
    s_waitcnt lgkmcnt(3)
    v_mfma_f32_32x32x16_bf16 v[152:167], v[200:203], v[24:27], v[152:167]
    buffer_load_dwordx4 v[172:175], v1, s[12:15], s17 offen offset:2048
    buffer_load_dwordx4 v[176:179], v1, s[12:15], s17 offen offset:3072
    s_add_u32 s17, s17, 4096
    ds_read_b128 v[24:27], v5 offset:28672
    s_waitcnt vmcnt(14)
    v_mfma_f32_32x32x16_bf16 v[136:151], v[204:207], v[108:111], v[136:151]
    s_waitcnt lgkmcnt(3)
    v_mfma_f32_32x32x16_bf16 v[152:167], v[204:207], v[28:31], v[152:167]
    buffer_load_dwordx4 v[180:183], v1, s[12:15], s17 offen offset:0
    buffer_load_dwordx4 v[184:187], v1, s[12:15], s17 offen offset:1024
    ds_read_b128 v[28:31], v5 offset:29696
    s_waitcnt vmcnt(15)
    v_mfma_f32_32x32x16_bf16 v[136:151], v[208:211], v[112:115], v[136:151]
    s_waitcnt lgkmcnt(3)
    v_mfma_f32_32x32x16_bf16 v[152:167], v[208:211], v[32:35], v[152:167]
    buffer_load_dwordx4 v[188:191], v1, s[12:15], s17 offen offset:2048
    buffer_load_dwordx4 v[192:195], v1, s[12:15], s17 offen offset:3072
    s_add_u32 s17, s17, 4096
    ds_read_b128 v[32:35], v5 offset:30720
    s_waitcnt vmcnt(16)
    v_mfma_f32_32x32x16_bf16 v[136:151], v[212:215], v[116:119], v[136:151]
    s_waitcnt lgkmcnt(3)
    v_mfma_f32_32x32x16_bf16 v[152:167], v[212:215], v[36:39], v[152:167]
    buffer_load_dwordx4 v[196:199], v1, s[12:15], s17 offen offset:0
    buffer_load_dwordx4 v[200:203], v1, s[12:15], s17 offen offset:1024
    ds_read_b128 v[36:39], v5 offset:31744
    s_waitcnt vmcnt(17)
    v_mfma_f32_32x32x16_bf16 v[136:151], v[216:219], v[120:123], v[136:151]
    s_waitcnt lgkmcnt(3)
    v_mfma_f32_32x32x16_bf16 v[152:167], v[216:219], v[24:27], v[152:167]
    buffer_load_dwordx4 v[204:207], v1, s[12:15], s17 offen offset:2048
    buffer_load_dwordx4 v[208:211], v1, s[12:15], s17 offen offset:3072
    s_add_u32 s17, s17, 4096
    s_waitcnt vmcnt(18)
    v_mfma_f32_32x32x16_bf16 v[136:151], v[220:223], v[124:127], v[136:151]
    s_waitcnt lgkmcnt(2)
    v_mfma_f32_32x32x16_bf16 v[152:167], v[220:223], v[28:31], v[152:167]
    buffer_load_dwordx4 v[212:215], v1, s[12:15], s17 offen offset:0
    buffer_load_dwordx4 v[216:219], v1, s[12:15], s17 offen offset:1024
    s_waitcnt vmcnt(19)
    v_mfma_f32_32x32x16_bf16 v[136:151], v[224:227], v[128:131], v[136:151]
    s_waitcnt lgkmcnt(1)
    v_mfma_f32_32x32x16_bf16 v[152:167], v[224:227], v[32:35], v[152:167]
    buffer_load_dwordx4 v[220:223], v1, s[12:15], s17 offen offset:2048
    buffer_load_dwordx4 v[224:227], v1, s[12:15], s17 offen offset:3072
    s_add_u32 s17, s17, 4096
    s_waitcnt vmcnt(20)
    v_mfma_f32_32x32x16_bf16 v[136:151], v[228:231], v[132:135], v[136:151]
    s_waitcnt lgkmcnt(0)
    v_mfma_f32_32x32x16_bf16 v[152:167], v[228:231], v[36:39], v[152:167]
    buffer_load_dwordx4 v[228:231], v1, s[12:15], s17 offen offset:0
    s_nop 10
    v_cvt_pk_bf16_f32 v6, v152, v153
    v_lshlrev_b32 v152, 16, v6
    v_and_b32 v153, 0xffff0000, v6
    v_cvt_pk_bf16_f32 v6, v154, v155
    v_lshlrev_b32 v154, 16, v6
    v_and_b32 v155, 0xffff0000, v6
    v_cvt_pk_bf16_f32 v6, v156, v157
    v_lshlrev_b32 v156, 16, v6
    v_and_b32 v157, 0xffff0000, v6
    v_cvt_pk_bf16_f32 v6, v158, v159
    v_lshlrev_b32 v158, 16, v6
    v_and_b32 v159, 0xffff0000, v6
    v_cvt_pk_bf16_f32 v6, v160, v161
    v_lshlrev_b32 v160, 16, v6
    v_and_b32 v161, 0xffff0000, v6
    v_cvt_pk_bf16_f32 v6, v162, v163
    v_lshlrev_b32 v162, 16, v6
    v_and_b32 v163, 0xffff0000, v6
    v_cvt_pk_bf16_f32 v6, v164, v165
    v_lshlrev_b32 v164, 16, v6
    v_and_b32 v165, 0xffff0000, v6
    v_cvt_pk_bf16_f32 v6, v166, v167
    v_lshlrev_b32 v166, 16, v6
    v_and_b32 v167, 0xffff0000, v6
    v_lshlrev_b32 v24, 16, v64
    v_and_b32 v25, 0xffff0000, v64
    v_lshlrev_b32 v26, 16, v65
    v_and_b32 v27, 0xffff0000, v65
    v_lshlrev_b32 v28, 16, v66
    v_and_b32 v29, 0xffff0000, v66
    v_lshlrev_b32 v30, 16, v67
    v_and_b32 v31, 0xffff0000, v67
    v_lshlrev_b32 v32, 16, v68
    v_and_b32 v33, 0xffff0000, v68
    v_lshlrev_b32 v34, 16, v69
    v_and_b32 v35, 0xffff0000, v69
    v_lshlrev_b32 v36, 16, v70
    v_and_b32 v37, 0xffff0000, v70
    v_lshlrev_b32 v38, 16, v71
    v_and_b32 v39, 0xffff0000, v71
    v_pk_add_f32 v[152:153], v[24:25], v[152:153]
    v_pk_add_f32 v[154:155], v[26:27], v[154:155]
    v_pk_add_f32 v[156:157], v[28:29], v[156:157]
    v_pk_add_f32 v[158:159], v[30:31], v[158:159]
    v_pk_add_f32 v[160:161], v[32:33], v[160:161]
    v_pk_add_f32 v[162:163], v[34:35], v[162:163]
    v_pk_add_f32 v[164:165], v[36:37], v[164:165]
    v_pk_add_f32 v[166:167], v[38:39], v[166:167]
    v_cvt_pk_bf16_f32 v6, v152, v153
    v_lshlrev_b32 v152, 16, v6
    v_and_b32 v153, 0xffff0000, v6
    v_cvt_pk_bf16_f32 v6, v154, v155
    v_lshlrev_b32 v154, 16, v6
    v_and_b32 v155, 0xffff0000, v6
    v_cvt_pk_bf16_f32 v6, v156, v157
    v_lshlrev_b32 v156, 16, v6
    v_and_b32 v157, 0xffff0000, v6
    v_cvt_pk_bf16_f32 v6, v158, v159
    v_lshlrev_b32 v158, 16, v6
    v_and_b32 v159, 0xffff0000, v6
    v_cvt_pk_bf16_f32 v6, v160, v161
    v_lshlrev_b32 v160, 16, v6
    v_and_b32 v161, 0xffff0000, v6
    v_cvt_pk_bf16_f32 v6, v162, v163
    v_lshlrev_b32 v162, 16, v6
    v_and_b32 v163, 0xffff0000, v6
    v_cvt_pk_bf16_f32 v6, v164, v165
    v_lshlrev_b32 v164, 16, v6
    v_and_b32 v165, 0xffff0000, v6
    v_cvt_pk_bf16_f32 v6, v166, v167
    v_lshlrev_b32 v166, 16, v6
    v_and_b32 v167, 0xffff0000, v6
    v_cvt_pk_bf16_f32 v6, v136, v137
    v_lshlrev_b32 v136, 16, v6
    v_and_b32 v137, 0xffff0000, v6
    v_cvt_pk_bf16_f32 v6, v138, v139
    v_lshlrev_b32 v138, 16, v6
    v_and_b32 v139, 0xffff0000, v6
    v_cvt_pk_bf16_f32 v6, v140, v141
    v_lshlrev_b32 v140, 16, v6
    v_and_b32 v141, 0xffff0000, v6
    v_cvt_pk_bf16_f32 v6, v142, v143
    v_lshlrev_b32 v142, 16, v6
    v_and_b32 v143, 0xffff0000, v6
    v_cvt_pk_bf16_f32 v6, v144, v145
    v_lshlrev_b32 v144, 16, v6
    v_and_b32 v145, 0xffff0000, v6
    v_cvt_pk_bf16_f32 v6, v146, v147
    v_lshlrev_b32 v146, 16, v6
    v_and_b32 v147, 0xffff0000, v6
    v_cvt_pk_bf16_f32 v6, v148, v149
    v_lshlrev_b32 v148, 16, v6
    v_and_b32 v149, 0xffff0000, v6
    v_cvt_pk_bf16_f32 v6, v150, v151
    v_lshlrev_b32 v150, 16, v6
    v_and_b32 v151, 0xffff0000, v6
    v_lshlrev_b32 v24, 16, v16
    v_and_b32 v25, 0xffff0000, v16
    v_lshlrev_b32 v26, 16, v17
    v_and_b32 v27, 0xffff0000, v17
    v_lshlrev_b32 v28, 16, v18
    v_and_b32 v29, 0xffff0000, v18
    v_lshlrev_b32 v30, 16, v19
    v_and_b32 v31, 0xffff0000, v19
    v_lshlrev_b32 v32, 16, v20
    v_and_b32 v33, 0xffff0000, v20
    v_lshlrev_b32 v34, 16, v21
    v_and_b32 v35, 0xffff0000, v21
    v_lshlrev_b32 v36, 16, v22
    v_and_b32 v37, 0xffff0000, v22
    v_lshlrev_b32 v38, 16, v23
    v_and_b32 v39, 0xffff0000, v23
    v_pk_add_f32 v[24:25], v[24:25], v[136:137]
    v_pk_add_f32 v[26:27], v[26:27], v[138:139]
    v_pk_add_f32 v[28:29], v[28:29], v[140:141]
    v_pk_add_f32 v[30:31], v[30:31], v[142:143]
    v_pk_add_f32 v[32:33], v[32:33], v[144:145]
    v_pk_add_f32 v[34:35], v[34:35], v[146:147]
    v_pk_add_f32 v[36:37], v[36:37], v[148:149]
    v_pk_add_f32 v[38:39], v[38:39], v[150:151]
    v_cvt_pk_bf16_f32 v16, v24, v25
    v_cvt_pk_bf16_f32 v17, v26, v27
    v_cvt_pk_bf16_f32 v18, v28, v29
    v_cvt_pk_bf16_f32 v19, v30, v31
    v_cvt_pk_bf16_f32 v20, v32, v33
    v_cvt_pk_bf16_f32 v21, v34, v35
    v_cvt_pk_bf16_f32 v22, v36, v37
    v_cvt_pk_bf16_f32 v23, v38, v39
    v_lshlrev_b32 v24, 16, v16
    v_and_b32 v25, 0xffff0000, v16
    v_lshlrev_b32 v26, 16, v17
    v_and_b32 v27, 0xffff0000, v17
    v_lshlrev_b32 v28, 16, v18
    v_and_b32 v29, 0xffff0000, v18
    v_lshlrev_b32 v30, 16, v19
    v_and_b32 v31, 0xffff0000, v19
    v_lshlrev_b32 v32, 16, v20
    v_and_b32 v33, 0xffff0000, v20
    v_lshlrev_b32 v34, 16, v21
    v_and_b32 v35, 0xffff0000, v21
    v_lshlrev_b32 v36, 16, v22
    v_and_b32 v37, 0xffff0000, v22
    v_lshlrev_b32 v38, 16, v23
    v_and_b32 v39, 0xffff0000, v23
    v_pk_add_f32 v[6:7], v[24:25], v[26:27]
    v_pk_add_f32 v[8:9], v[28:29], v[30:31]
    v_pk_add_f32 v[10:11], v[32:33], v[34:35]
    v_pk_add_f32 v[12:13], v[36:37], v[38:39]
    v_pk_add_f32 v[6:7], v[6:7], v[8:9]
    v_pk_add_f32 v[10:11], v[10:11], v[12:13]
    v_pk_add_f32 v[6:7], v[6:7], v[10:11]
    v_add_f32 v6, v6, v7
    v_mul_f32 v6, 0x3d800000, v6
    v_pk_add_f32 v[10:11], v[24:25], v[6:7] op_sel_hi:[1,0] neg_lo:[0,1] neg_hi:[0,1]
    v_pk_mul_f32 v[8:9], v[10:11], v[10:11]
    v_pk_add_f32 v[12:13], v[26:27], v[6:7] op_sel_hi:[1,0] neg_lo:[0,1] neg_hi:[0,1]
    v_pk_fma_f32 v[8:9], v[12:13], v[12:13], v[8:9]
    v_pk_add_f32 v[10:11], v[28:29], v[6:7] op_sel_hi:[1,0] neg_lo:[0,1] neg_hi:[0,1]
    v_pk_fma_f32 v[8:9], v[10:11], v[10:11], v[8:9]
    v_pk_add_f32 v[12:13], v[30:31], v[6:7] op_sel_hi:[1,0] neg_lo:[0,1] neg_hi:[0,1]
    v_pk_fma_f32 v[8:9], v[12:13], v[12:13], v[8:9]
    v_pk_add_f32 v[10:11], v[32:33], v[6:7] op_sel_hi:[1,0] neg_lo:[0,1] neg_hi:[0,1]
    v_pk_fma_f32 v[8:9], v[10:11], v[10:11], v[8:9]
    v_pk_add_f32 v[12:13], v[34:35], v[6:7] op_sel_hi:[1,0] neg_lo:[0,1] neg_hi:[0,1]
    v_pk_fma_f32 v[8:9], v[12:13], v[12:13], v[8:9]
    v_pk_add_f32 v[10:11], v[36:37], v[6:7] op_sel_hi:[1,0] neg_lo:[0,1] neg_hi:[0,1]
    v_pk_fma_f32 v[8:9], v[10:11], v[10:11], v[8:9]
    v_pk_add_f32 v[12:13], v[38:39], v[6:7] op_sel_hi:[1,0] neg_lo:[0,1] neg_hi:[0,1]
    v_pk_fma_f32 v[8:9], v[12:13], v[12:13], v[8:9]
    v_add_f32 v8, v8, v9
    ds_write_b32 v2, v6 offset:0
    ds_write_b32 v2, v8 offset:2560
    v_pk_add_f32 v[6:7], v[152:153], v[154:155]
    v_pk_add_f32 v[8:9], v[156:157], v[158:159]
    v_pk_add_f32 v[10:11], v[160:161], v[162:163]
    v_pk_add_f32 v[12:13], v[164:165], v[166:167]
    v_pk_add_f32 v[6:7], v[6:7], v[8:9]
    v_pk_add_f32 v[10:11], v[10:11], v[12:13]
    v_pk_add_f32 v[6:7], v[6:7], v[10:11]
    v_add_f32 v6, v6, v7
    v_mul_f32 v6, 0x3d800000, v6
    v_pk_add_f32 v[10:11], v[152:153], v[6:7] op_sel_hi:[1,0] neg_lo:[0,1] neg_hi:[0,1]
    v_pk_mul_f32 v[8:9], v[10:11], v[10:11]
    v_pk_add_f32 v[12:13], v[154:155], v[6:7] op_sel_hi:[1,0] neg_lo:[0,1] neg_hi:[0,1]
    v_pk_fma_f32 v[8:9], v[12:13], v[12:13], v[8:9]
    v_pk_add_f32 v[10:11], v[156:157], v[6:7] op_sel_hi:[1,0] neg_lo:[0,1] neg_hi:[0,1]
    v_pk_fma_f32 v[8:9], v[10:11], v[10:11], v[8:9]
    v_pk_add_f32 v[12:13], v[158:159], v[6:7] op_sel_hi:[1,0] neg_lo:[0,1] neg_hi:[0,1]
    v_pk_fma_f32 v[8:9], v[12:13], v[12:13], v[8:9]
    v_pk_add_f32 v[10:11], v[160:161], v[6:7] op_sel_hi:[1,0] neg_lo:[0,1] neg_hi:[0,1]
    v_pk_fma_f32 v[8:9], v[10:11], v[10:11], v[8:9]
    v_pk_add_f32 v[12:13], v[162:163], v[6:7] op_sel_hi:[1,0] neg_lo:[0,1] neg_hi:[0,1]
    v_pk_fma_f32 v[8:9], v[12:13], v[12:13], v[8:9]
    v_pk_add_f32 v[10:11], v[164:165], v[6:7] op_sel_hi:[1,0] neg_lo:[0,1] neg_hi:[0,1]
    v_pk_fma_f32 v[8:9], v[10:11], v[10:11], v[8:9]
    v_pk_add_f32 v[12:13], v[166:167], v[6:7] op_sel_hi:[1,0] neg_lo:[0,1] neg_hi:[0,1]
    v_pk_fma_f32 v[8:9], v[12:13], v[12:13], v[8:9]
    v_add_f32 v8, v8, v9
    ds_write_b32 v2, v6 offset:5120
    ds_write_b32 v2, v8 offset:7680
    s_waitcnt lgkmcnt(0)
    s_barrier
    ds_read_b128 v[40:43], v3 offset:0
    ds_read_b128 v[44:47], v3 offset:16
    ds_read_b128 v[48:51], v3 offset:32
    ds_read_b128 v[52:55], v3 offset:48
    ds_read_b128 v[56:59], v3 offset:2560
    ds_read_b128 v[60:63], v3 offset:2576
    ds_read_b128 v[64:67], v3 offset:2592
    ds_read_b128 v[68:71], v3 offset:2608
    s_waitcnt lgkmcnt(4)
    v_pk_add_f32 v[6:7], v[40:41], v[42:43]
    v_pk_add_f32 v[8:9], v[44:45], v[46:47]
    v_pk_add_f32 v[10:11], v[48:49], v[50:51]
    v_pk_add_f32 v[12:13], v[52:53], v[54:55]
    v_pk_add_f32 v[6:7], v[6:7], v[8:9]
    v_pk_add_f32 v[10:11], v[10:11], v[12:13]
    v_pk_add_f32 v[6:7], v[6:7], v[10:11]
    v_add_f32 v6, v6, v7
    v_mul_f32 v6, 0x3d800000, v6
    v_pk_add_f32 v[10:11], v[40:41], v[6:7] op_sel_hi:[1,0] neg_lo:[0,1] neg_hi:[0,1]
    v_pk_mul_f32 v[8:9], v[10:11], v[10:11]
    v_pk_add_f32 v[12:13], v[42:43], v[6:7] op_sel_hi:[1,0] neg_lo:[0,1] neg_hi:[0,1]
    v_pk_fma_f32 v[8:9], v[12:13], v[12:13], v[8:9]
    v_pk_add_f32 v[10:11], v[44:45], v[6:7] op_sel_hi:[1,0] neg_lo:[0,1] neg_hi:[0,1]
    v_pk_fma_f32 v[8:9], v[10:11], v[10:11], v[8:9]
    v_pk_add_f32 v[12:13], v[46:47], v[6:7] op_sel_hi:[1,0] neg_lo:[0,1] neg_hi:[0,1]
    v_pk_fma_f32 v[8:9], v[12:13], v[12:13], v[8:9]
    v_pk_add_f32 v[10:11], v[48:49], v[6:7] op_sel_hi:[1,0] neg_lo:[0,1] neg_hi:[0,1]
    v_pk_fma_f32 v[8:9], v[10:11], v[10:11], v[8:9]
    v_pk_add_f32 v[12:13], v[50:51], v[6:7] op_sel_hi:[1,0] neg_lo:[0,1] neg_hi:[0,1]
    v_pk_fma_f32 v[8:9], v[12:13], v[12:13], v[8:9]
    v_pk_add_f32 v[10:11], v[52:53], v[6:7] op_sel_hi:[1,0] neg_lo:[0,1] neg_hi:[0,1]
    v_pk_fma_f32 v[8:9], v[10:11], v[10:11], v[8:9]
    v_pk_add_f32 v[12:13], v[54:55], v[6:7] op_sel_hi:[1,0] neg_lo:[0,1] neg_hi:[0,1]
    v_pk_fma_f32 v[8:9], v[12:13], v[12:13], v[8:9]
    v_add_f32 v8, v8, v9
    s_waitcnt lgkmcnt(0)
    v_pk_add_f32 v[40:41], v[56:57], v[58:59]
    v_pk_add_f32 v[42:43], v[60:61], v[62:63]
    v_pk_add_f32 v[44:45], v[64:65], v[66:67]
    v_pk_add_f32 v[46:47], v[68:69], v[70:71]
    v_pk_add_f32 v[40:41], v[40:41], v[42:43]
    v_pk_add_f32 v[44:45], v[44:45], v[46:47]
    v_pk_add_f32 v[40:41], v[40:41], v[44:45]
    v_add_f32 v40, v40, v41
    v_fmac_f32 v40, 0x41800000, v8
    v_mul_f32 v8, 0x3b800000, v40
    v_cvt_pk_bf16_f32 v10, v6, v8
    v_lshlrev_b32 v6, 16, v10
    v_and_b32 v8, 0xffff0000, v10
    v_add_f32 v8, 0x3727c5ac, v8
    v_cvt_pk_bf16_f32 v10, v8, v8
    v_lshlrev_b32 v8, 16, v10
    v_sqrt_f32 v8, v8
    v_pk_add_f32 v[40:41], v[24:25], v[6:7] op_sel_hi:[1,0] neg_lo:[0,1] neg_hi:[0,1]
    v_pk_add_f32 v[42:43], v[26:27], v[6:7] op_sel_hi:[1,0] neg_lo:[0,1] neg_hi:[0,1]
    v_pk_add_f32 v[44:45], v[28:29], v[6:7] op_sel_hi:[1,0] neg_lo:[0,1] neg_hi:[0,1]
    v_pk_add_f32 v[46:47], v[30:31], v[6:7] op_sel_hi:[1,0] neg_lo:[0,1] neg_hi:[0,1]
    v_pk_add_f32 v[48:49], v[32:33], v[6:7] op_sel_hi:[1,0] neg_lo:[0,1] neg_hi:[0,1]
    v_pk_add_f32 v[50:51], v[34:35], v[6:7] op_sel_hi:[1,0] neg_lo:[0,1] neg_hi:[0,1]
    v_pk_add_f32 v[52:53], v[36:37], v[6:7] op_sel_hi:[1,0] neg_lo:[0,1] neg_hi:[0,1]
    v_pk_add_f32 v[54:55], v[38:39], v[6:7] op_sel_hi:[1,0] neg_lo:[0,1] neg_hi:[0,1]
    v_cvt_pk_bf16_f32 v10, v8, v8
    v_lshlrev_b32 v8, 16, v10
    v_rcp_f32 v8, v8
    v_cvt_pk_bf16_f32 v10, v40, v41
    v_lshlrev_b32 v40, 16, v10
    v_and_b32 v41, 0xffff0000, v10
    v_cvt_pk_bf16_f32 v10, v42, v43
    v_lshlrev_b32 v42, 16, v10
    v_and_b32 v43, 0xffff0000, v10
    v_cvt_pk_bf16_f32 v10, v44, v45
    v_lshlrev_b32 v44, 16, v10
    v_and_b32 v45, 0xffff0000, v10
    v_cvt_pk_bf16_f32 v10, v46, v47
    v_lshlrev_b32 v46, 16, v10
    v_and_b32 v47, 0xffff0000, v10
    v_cvt_pk_bf16_f32 v10, v48, v49
    v_lshlrev_b32 v48, 16, v10
    v_and_b32 v49, 0xffff0000, v10
    v_cvt_pk_bf16_f32 v10, v50, v51
    v_lshlrev_b32 v50, 16, v10
    v_and_b32 v51, 0xffff0000, v10
    v_cvt_pk_bf16_f32 v10, v52, v53
    v_lshlrev_b32 v52, 16, v10
    v_and_b32 v53, 0xffff0000, v10
    v_cvt_pk_bf16_f32 v10, v54, v55
    v_lshlrev_b32 v54, 16, v10
    v_and_b32 v55, 0xffff0000, v10
    v_pk_mul_f32 v[40:41], v[40:41], v[8:9] op_sel_hi:[1,0]
    v_pk_mul_f32 v[42:43], v[42:43], v[8:9] op_sel_hi:[1,0]
    v_pk_mul_f32 v[44:45], v[44:45], v[8:9] op_sel_hi:[1,0]
    v_pk_mul_f32 v[46:47], v[46:47], v[8:9] op_sel_hi:[1,0]
    v_pk_mul_f32 v[48:49], v[48:49], v[8:9] op_sel_hi:[1,0]
    v_pk_mul_f32 v[50:51], v[50:51], v[8:9] op_sel_hi:[1,0]
    v_pk_mul_f32 v[52:53], v[52:53], v[8:9] op_sel_hi:[1,0]
    v_pk_mul_f32 v[54:55], v[54:55], v[8:9] op_sel_hi:[1,0]
    v_cvt_pk_bf16_f32 v56, v40, v41
    v_cvt_pk_bf16_f32 v57, v42, v43
    v_cvt_pk_bf16_f32 v58, v44, v45
    v_cvt_pk_bf16_f32 v59, v46, v47
    v_cvt_pk_bf16_f32 v60, v48, v49
    v_cvt_pk_bf16_f32 v61, v50, v51
    v_cvt_pk_bf16_f32 v62, v52, v53
    v_cvt_pk_bf16_f32 v63, v54, v55
    ds_write_b128 v4, v[56:59] offset:0
    ds_write_b128 v4, v[60:63] offset:1024
    ds_read_b128 v[40:43], v3 offset:5120
    ds_read_b128 v[44:47], v3 offset:5136
    ds_read_b128 v[48:51], v3 offset:5152
    ds_read_b128 v[52:55], v3 offset:5168
    ds_read_b128 v[56:59], v3 offset:7680
    ds_read_b128 v[60:63], v3 offset:7696
    ds_read_b128 v[64:67], v3 offset:7712
    ds_read_b128 v[68:71], v3 offset:7728
    s_waitcnt lgkmcnt(4)
    v_pk_add_f32 v[6:7], v[40:41], v[42:43]
    v_pk_add_f32 v[8:9], v[44:45], v[46:47]
    v_pk_add_f32 v[10:11], v[48:49], v[50:51]
    v_pk_add_f32 v[12:13], v[52:53], v[54:55]
    v_pk_add_f32 v[6:7], v[6:7], v[8:9]
    v_pk_add_f32 v[10:11], v[10:11], v[12:13]
    v_pk_add_f32 v[6:7], v[6:7], v[10:11]
    v_add_f32 v6, v6, v7
    v_mul_f32 v6, 0x3d800000, v6
    v_pk_add_f32 v[10:11], v[40:41], v[6:7] op_sel_hi:[1,0] neg_lo:[0,1] neg_hi:[0,1]
    v_pk_mul_f32 v[8:9], v[10:11], v[10:11]
    v_pk_add_f32 v[12:13], v[42:43], v[6:7] op_sel_hi:[1,0] neg_lo:[0,1] neg_hi:[0,1]
    v_pk_fma_f32 v[8:9], v[12:13], v[12:13], v[8:9]
    v_pk_add_f32 v[10:11], v[44:45], v[6:7] op_sel_hi:[1,0] neg_lo:[0,1] neg_hi:[0,1]
    v_pk_fma_f32 v[8:9], v[10:11], v[10:11], v[8:9]
    v_pk_add_f32 v[12:13], v[46:47], v[6:7] op_sel_hi:[1,0] neg_lo:[0,1] neg_hi:[0,1]
    v_pk_fma_f32 v[8:9], v[12:13], v[12:13], v[8:9]
    v_pk_add_f32 v[10:11], v[48:49], v[6:7] op_sel_hi:[1,0] neg_lo:[0,1] neg_hi:[0,1]
    v_pk_fma_f32 v[8:9], v[10:11], v[10:11], v[8:9]
    v_pk_add_f32 v[12:13], v[50:51], v[6:7] op_sel_hi:[1,0] neg_lo:[0,1] neg_hi:[0,1]
    v_pk_fma_f32 v[8:9], v[12:13], v[12:13], v[8:9]
    v_pk_add_f32 v[10:11], v[52:53], v[6:7] op_sel_hi:[1,0] neg_lo:[0,1] neg_hi:[0,1]
    v_pk_fma_f32 v[8:9], v[10:11], v[10:11], v[8:9]
    v_pk_add_f32 v[12:13], v[54:55], v[6:7] op_sel_hi:[1,0] neg_lo:[0,1] neg_hi:[0,1]
    v_pk_fma_f32 v[8:9], v[12:13], v[12:13], v[8:9]
    v_add_f32 v8, v8, v9
    s_waitcnt lgkmcnt(0)
    v_pk_add_f32 v[40:41], v[56:57], v[58:59]
    v_pk_add_f32 v[42:43], v[60:61], v[62:63]
    v_pk_add_f32 v[44:45], v[64:65], v[66:67]
    v_pk_add_f32 v[46:47], v[68:69], v[70:71]
    v_pk_add_f32 v[40:41], v[40:41], v[42:43]
    v_pk_add_f32 v[44:45], v[44:45], v[46:47]
    v_pk_add_f32 v[40:41], v[40:41], v[44:45]
    v_add_f32 v40, v40, v41
    v_fmac_f32 v40, 0x41800000, v8
    v_mul_f32 v8, 0x3b800000, v40
    v_cvt_pk_bf16_f32 v10, v6, v8
    v_lshlrev_b32 v6, 16, v10
    v_and_b32 v8, 0xffff0000, v10
    v_add_f32 v8, 0x3727c5ac, v8
    v_cvt_pk_bf16_f32 v10, v8, v8
    v_lshlrev_b32 v8, 16, v10
    v_sqrt_f32 v8, v8
    v_pk_add_f32 v[40:41], v[152:153], v[6:7] op_sel_hi:[1,0] neg_lo:[0,1] neg_hi:[0,1]
    v_pk_add_f32 v[42:43], v[154:155], v[6:7] op_sel_hi:[1,0] neg_lo:[0,1] neg_hi:[0,1]
    v_pk_add_f32 v[44:45], v[156:157], v[6:7] op_sel_hi:[1,0] neg_lo:[0,1] neg_hi:[0,1]
    v_pk_add_f32 v[46:47], v[158:159], v[6:7] op_sel_hi:[1,0] neg_lo:[0,1] neg_hi:[0,1]
    v_pk_add_f32 v[48:49], v[160:161], v[6:7] op_sel_hi:[1,0] neg_lo:[0,1] neg_hi:[0,1]
    v_pk_add_f32 v[50:51], v[162:163], v[6:7] op_sel_hi:[1,0] neg_lo:[0,1] neg_hi:[0,1]
    v_pk_add_f32 v[52:53], v[164:165], v[6:7] op_sel_hi:[1,0] neg_lo:[0,1] neg_hi:[0,1]
    v_pk_add_f32 v[54:55], v[166:167], v[6:7] op_sel_hi:[1,0] neg_lo:[0,1] neg_hi:[0,1]
    v_cvt_pk_bf16_f32 v10, v8, v8
    v_lshlrev_b32 v8, 16, v10
    v_rcp_f32 v8, v8
    v_cvt_pk_bf16_f32 v10, v40, v41
    v_lshlrev_b32 v40, 16, v10
    v_and_b32 v41, 0xffff0000, v10
    v_cvt_pk_bf16_f32 v10, v42, v43
    v_lshlrev_b32 v42, 16, v10
    v_and_b32 v43, 0xffff0000, v10
    v_cvt_pk_bf16_f32 v10, v44, v45
    v_lshlrev_b32 v44, 16, v10
    v_and_b32 v45, 0xffff0000, v10
    v_cvt_pk_bf16_f32 v10, v46, v47
    v_lshlrev_b32 v46, 16, v10
    v_and_b32 v47, 0xffff0000, v10
    v_cvt_pk_bf16_f32 v10, v48, v49
    v_lshlrev_b32 v48, 16, v10
    v_and_b32 v49, 0xffff0000, v10
    v_cvt_pk_bf16_f32 v10, v50, v51
    v_lshlrev_b32 v50, 16, v10
    v_and_b32 v51, 0xffff0000, v10
    v_cvt_pk_bf16_f32 v10, v52, v53
    v_lshlrev_b32 v52, 16, v10
    v_and_b32 v53, 0xffff0000, v10
    v_cvt_pk_bf16_f32 v10, v54, v55
    v_lshlrev_b32 v54, 16, v10
    v_and_b32 v55, 0xffff0000, v10
    v_pk_mul_f32 v[40:41], v[40:41], v[8:9] op_sel_hi:[1,0]
    v_pk_mul_f32 v[42:43], v[42:43], v[8:9] op_sel_hi:[1,0]
    v_pk_mul_f32 v[44:45], v[44:45], v[8:9] op_sel_hi:[1,0]
    v_pk_mul_f32 v[46:47], v[46:47], v[8:9] op_sel_hi:[1,0]
    v_pk_mul_f32 v[48:49], v[48:49], v[8:9] op_sel_hi:[1,0]
    v_pk_mul_f32 v[50:51], v[50:51], v[8:9] op_sel_hi:[1,0]
    v_pk_mul_f32 v[52:53], v[52:53], v[8:9] op_sel_hi:[1,0]
    v_pk_mul_f32 v[54:55], v[54:55], v[8:9] op_sel_hi:[1,0]
    v_cvt_pk_bf16_f32 v56, v40, v41
    v_cvt_pk_bf16_f32 v57, v42, v43
    v_cvt_pk_bf16_f32 v58, v44, v45
    v_cvt_pk_bf16_f32 v59, v46, v47
    v_cvt_pk_bf16_f32 v60, v48, v49
    v_cvt_pk_bf16_f32 v61, v50, v51
    v_cvt_pk_bf16_f32 v62, v52, v53
    v_cvt_pk_bf16_f32 v63, v54, v55
    ds_write_b128 v4, v[56:59] offset:16384
    ds_write_b128 v4, v[60:63] offset:17408
    s_waitcnt lgkmcnt(0)
    s_barrier
    ds_read_b128 v[72:75], v5 offset:0
    ds_read_b128 v[76:79], v5 offset:1024
    ds_read_b128 v[80:83], v5 offset:2048
    ds_read_b128 v[84:87], v5 offset:3072
    ds_read_b128 v[88:91], v5 offset:4096
    ds_read_b128 v[92:95], v5 offset:5120
    ds_read_b128 v[96:99], v5 offset:6144
    ds_read_b128 v[100:103], v5 offset:7168
    ds_read_b128 v[104:107], v5 offset:8192
    ds_read_b128 v[108:111], v5 offset:9216
    ds_read_b128 v[112:115], v5 offset:10240
    ds_read_b128 v[116:119], v5 offset:11264
    ds_read_b128 v[120:123], v5 offset:12288
    ds_read_b128 v[124:127], v5 offset:13312
    ds_read_b128 v[128:131], v5 offset:14336
    ds_read_b128 v[132:135], v5 offset:15360
    s_waitcnt lgkmcnt(0)
    ds_read_b128 v[24:27], v5 offset:16384
    ds_read_b128 v[28:31], v5 offset:17408
    ds_read_b128 v[32:35], v5 offset:18432
    ds_read_b128 v[36:39], v5 offset:19456
    s_waitcnt vmcnt(20)
    v_mfma_f32_32x32x16_bf16 v[136:151], v[232:235], v[72:75], 0
    s_waitcnt lgkmcnt(3)
    v_mfma_f32_32x32x16_bf16 v[40:55], v[232:235], v[24:27], 0
    buffer_load_dwordx4 v[232:235], v1, s[12:15], s17 offen offset:1024
    ds_read_b128 v[24:27], v5 offset:20480
    s_waitcnt vmcnt(20)
    v_mfma_f32_32x32x16_bf16 v[136:151], v[236:239], v[76:79], v[136:151]
    s_waitcnt lgkmcnt(3)
    v_mfma_f32_32x32x16_bf16 v[40:55], v[236:239], v[28:31], v[40:55]
    buffer_load_dwordx4 v[236:239], v1, s[12:15], s17 offen offset:2048
    ds_read_b128 v[28:31], v5 offset:21504
    s_waitcnt vmcnt(20)
    v_mfma_f32_32x32x16_bf16 v[136:151], v[240:243], v[80:83], v[136:151]
    s_waitcnt lgkmcnt(3)
    v_mfma_f32_32x32x16_bf16 v[40:55], v[240:243], v[32:35], v[40:55]
    buffer_load_dwordx4 v[240:243], v1, s[12:15], s17 offen offset:3072
    s_add_u32 s17, s17, 4096
    ds_read_b128 v[32:35], v5 offset:22528
    s_waitcnt vmcnt(20)
    v_mfma_f32_32x32x16_bf16 v[136:151], v[244:247], v[84:87], v[136:151]
    s_waitcnt lgkmcnt(3)
    v_mfma_f32_32x32x16_bf16 v[40:55], v[244:247], v[36:39], v[40:55]
    buffer_load_dwordx4 v[244:247], v1, s[12:15], s17 offen offset:0
    ds_read_b128 v[36:39], v5 offset:23552
    s_waitcnt vmcnt(20)
    v_mfma_f32_32x32x16_bf16 v[136:151], v[248:251], v[88:91], v[136:151]
    s_waitcnt lgkmcnt(3)
    v_mfma_f32_32x32x16_bf16 v[40:55], v[248:251], v[24:27], v[40:55]
    buffer_load_dwordx4 v[248:251], v1, s[12:15], s17 offen offset:1024
    ds_read_b128 v[24:27], v5 offset:24576
    s_waitcnt vmcnt(20)
    v_mfma_f32_32x32x16_bf16 v[136:151], v[168:171], v[92:95], v[136:151]
    s_waitcnt lgkmcnt(3)
    v_mfma_f32_32x32x16_bf16 v[40:55], v[168:171], v[28:31], v[40:55]
    buffer_load_dwordx4 v[168:171], v1, s[12:15], s17 offen offset:2048
    ds_read_b128 v[28:31], v5 offset:25600
    s_waitcnt vmcnt(20)
    v_mfma_f32_32x32x16_bf16 v[136:151], v[172:175], v[96:99], v[136:151]
    s_waitcnt lgkmcnt(3)
    v_mfma_f32_32x32x16_bf16 v[40:55], v[172:175], v[32:35], v[40:55]
    buffer_load_dwordx4 v[172:175], v1, s[12:15], s17 offen offset:3072
    s_add_u32 s17, s17, 4096
    ds_read_b128 v[32:35], v5 offset:26624
    s_waitcnt vmcnt(20)
    v_mfma_f32_32x32x16_bf16 v[136:151], v[176:179], v[100:103], v[136:151]
    s_waitcnt lgkmcnt(3)
    v_mfma_f32_32x32x16_bf16 v[40:55], v[176:179], v[36:39], v[40:55]
    buffer_load_dwordx4 v[176:179], v1, s[12:15], s17 offen offset:0
    ds_read_b128 v[36:39], v5 offset:27648
    s_waitcnt vmcnt(20)
    v_mfma_f32_32x32x16_bf16 v[136:151], v[180:183], v[104:107], v[136:151]
    s_waitcnt lgkmcnt(3)
    v_mfma_f32_32x32x16_bf16 v[40:55], v[180:183], v[24:27], v[40:55]
    buffer_load_dwordx4 v[180:183], v1, s[12:15], s17 offen offset:1024
    ds_read_b128 v[24:27], v5 offset:28672
    s_waitcnt vmcnt(20)
    v_mfma_f32_32x32x16_bf16 v[136:151], v[184:187], v[108:111], v[136:151]
    s_waitcnt lgkmcnt(3)
    v_mfma_f32_32x32x16_bf16 v[40:55], v[184:187], v[28:31], v[40:55]
    buffer_load_dwordx4 v[184:187], v1, s[12:15], s17 offen offset:2048
    ds_read_b128 v[28:31], v5 offset:29696
    s_waitcnt vmcnt(20)
    v_mfma_f32_32x32x16_bf16 v[136:151], v[188:191], v[112:115], v[136:151]
    s_waitcnt lgkmcnt(3)
    v_mfma_f32_32x32x16_bf16 v[40:55], v[188:191], v[32:35], v[40:55]
    buffer_load_dwordx4 v[188:191], v1, s[12:15], s17 offen offset:3072
    s_add_u32 s17, s17, 4096
    ds_read_b128 v[32:35], v5 offset:30720
    s_waitcnt vmcnt(20)
    v_mfma_f32_32x32x16_bf16 v[136:151], v[192:195], v[116:119], v[136:151]
    s_waitcnt lgkmcnt(3)
    v_mfma_f32_32x32x16_bf16 v[40:55], v[192:195], v[36:39], v[40:55]
    buffer_load_dwordx4 v[192:195], v1, s[12:15], s17 offen offset:0
    ds_read_b128 v[36:39], v5 offset:31744
    s_waitcnt vmcnt(20)
    v_mfma_f32_32x32x16_bf16 v[136:151], v[196:199], v[120:123], v[136:151]
    s_waitcnt lgkmcnt(3)
    v_mfma_f32_32x32x16_bf16 v[40:55], v[196:199], v[24:27], v[40:55]
    buffer_load_dwordx4 v[196:199], v1, s[12:15], s17 offen offset:1024
    s_waitcnt vmcnt(20)
    v_mfma_f32_32x32x16_bf16 v[136:151], v[200:203], v[124:127], v[136:151]
    s_waitcnt lgkmcnt(2)
    v_mfma_f32_32x32x16_bf16 v[40:55], v[200:203], v[28:31], v[40:55]
    buffer_load_dwordx4 v[200:203], v1, s[12:15], s17 offen offset:2048
    s_waitcnt vmcnt(20)
    v_mfma_f32_32x32x16_bf16 v[136:151], v[204:207], v[128:131], v[136:151]
    s_waitcnt lgkmcnt(1)
    v_mfma_f32_32x32x16_bf16 v[40:55], v[204:207], v[32:35], v[40:55]
    buffer_load_dwordx4 v[204:207], v1, s[12:15], s17 offen offset:3072
    s_add_u32 s17, s17, 4096
    s_waitcnt vmcnt(20)
    v_mfma_f32_32x32x16_bf16 v[136:151], v[208:211], v[132:135], v[136:151]
    s_waitcnt lgkmcnt(0)
    v_mfma_f32_32x32x16_bf16 v[40:55], v[208:211], v[36:39], v[40:55]
    buffer_load_dwordx4 v[208:211], v1, s[12:15], s17 offen offset:0
    ds_read_b128 v[24:27], v5 offset:16384
    ds_read_b128 v[28:31], v5 offset:17408
    ds_read_b128 v[32:35], v5 offset:18432
    ds_read_b128 v[36:39], v5 offset:19456
    s_waitcnt vmcnt(20)
    v_mfma_f32_32x32x16_bf16 v[152:167], v[212:215], v[72:75], 0
    s_waitcnt lgkmcnt(3)
    v_mfma_f32_32x32x16_bf16 v[56:71], v[212:215], v[24:27], 0
    buffer_load_dwordx4 v[212:215], v1, s[12:15], s17 offen offset:1024
    ds_read_b128 v[24:27], v5 offset:20480
    s_waitcnt vmcnt(20)
    v_mfma_f32_32x32x16_bf16 v[152:167], v[216:219], v[76:79], v[152:167]
    s_waitcnt lgkmcnt(3)
    v_mfma_f32_32x32x16_bf16 v[56:71], v[216:219], v[28:31], v[56:71]
    buffer_load_dwordx4 v[216:219], v1, s[12:15], s17 offen offset:2048
    ds_read_b128 v[28:31], v5 offset:21504
    s_waitcnt vmcnt(20)
    v_mfma_f32_32x32x16_bf16 v[152:167], v[220:223], v[80:83], v[152:167]
    s_waitcnt lgkmcnt(3)
    v_mfma_f32_32x32x16_bf16 v[56:71], v[220:223], v[32:35], v[56:71]
    buffer_load_dwordx4 v[220:223], v1, s[12:15], s17 offen offset:3072
    s_add_u32 s17, s17, 4096
    ds_read_b128 v[32:35], v5 offset:22528
    s_waitcnt vmcnt(20)
    v_mfma_f32_32x32x16_bf16 v[152:167], v[224:227], v[84:87], v[152:167]
    s_waitcnt lgkmcnt(3)
    v_mfma_f32_32x32x16_bf16 v[56:71], v[224:227], v[36:39], v[56:71]
    buffer_load_dwordx4 v[224:227], v1, s[12:15], s17 offen offset:0
    ds_read_b128 v[36:39], v5 offset:23552
    s_waitcnt vmcnt(20)
    v_mfma_f32_32x32x16_bf16 v[152:167], v[228:231], v[88:91], v[152:167]
    s_waitcnt lgkmcnt(3)
    v_mfma_f32_32x32x16_bf16 v[56:71], v[228:231], v[24:27], v[56:71]
    buffer_load_dwordx4 v[228:231], v1, s[12:15], s17 offen offset:1024
    ds_read_b128 v[24:27], v5 offset:24576
    s_waitcnt vmcnt(20)
    v_mfma_f32_32x32x16_bf16 v[152:167], v[232:235], v[92:95], v[152:167]
    s_waitcnt lgkmcnt(3)
    v_mfma_f32_32x32x16_bf16 v[56:71], v[232:235], v[28:31], v[56:71]
    buffer_load_dwordx4 v[232:235], v1, s[12:15], s17 offen offset:2048
    ds_read_b128 v[28:31], v5 offset:25600
    s_waitcnt vmcnt(20)
    v_mfma_f32_32x32x16_bf16 v[152:167], v[236:239], v[96:99], v[152:167]
    s_waitcnt lgkmcnt(3)
    v_mfma_f32_32x32x16_bf16 v[56:71], v[236:239], v[32:35], v[56:71]
    buffer_load_dwordx4 v[236:239], v1, s[12:15], s17 offen offset:3072
    s_add_u32 s17, s17, 4096
    ds_read_b128 v[32:35], v5 offset:26624
    s_waitcnt vmcnt(20)
    v_mfma_f32_32x32x16_bf16 v[152:167], v[240:243], v[100:103], v[152:167]
    s_waitcnt lgkmcnt(3)
    v_mfma_f32_32x32x16_bf16 v[56:71], v[240:243], v[36:39], v[56:71]
    buffer_load_dwordx4 v[240:243], v1, s[12:15], s17 offen offset:0
    ds_read_b128 v[36:39], v5 offset:27648
    s_waitcnt vmcnt(20)
    v_mfma_f32_32x32x16_bf16 v[152:167], v[244:247], v[104:107], v[152:167]
    s_waitcnt lgkmcnt(3)
    v_mfma_f32_32x32x16_bf16 v[56:71], v[244:247], v[24:27], v[56:71]
    buffer_load_dwordx4 v[244:247], v1, s[12:15], s17 offen offset:1024
    ds_read_b128 v[24:27], v5 offset:28672
    s_waitcnt vmcnt(20)
    v_mfma_f32_32x32x16_bf16 v[152:167], v[248:251], v[108:111], v[152:167]
    s_waitcnt lgkmcnt(3)
    v_mfma_f32_32x32x16_bf16 v[56:71], v[248:251], v[28:31], v[56:71]
    buffer_load_dwordx4 v[248:251], v1, s[12:15], s17 offen offset:2048
    ds_read_b128 v[28:31], v5 offset:29696
    s_waitcnt vmcnt(20)
    v_mfma_f32_32x32x16_bf16 v[152:167], v[168:171], v[112:115], v[152:167]
    s_waitcnt lgkmcnt(3)
    v_mfma_f32_32x32x16_bf16 v[56:71], v[168:171], v[32:35], v[56:71]
    buffer_load_dwordx4 v[168:171], v1, s[12:15], s17 offen offset:3072
    s_add_u32 s17, s17, 4096
    ds_read_b128 v[32:35], v5 offset:30720
    s_waitcnt vmcnt(20)
    v_mfma_f32_32x32x16_bf16 v[152:167], v[172:175], v[116:119], v[152:167]
    s_waitcnt lgkmcnt(3)
    v_mfma_f32_32x32x16_bf16 v[56:71], v[172:175], v[36:39], v[56:71]
    buffer_load_dwordx4 v[172:175], v1, s[12:15], s17 offen offset:0
    ds_read_b128 v[36:39], v5 offset:31744
    s_waitcnt vmcnt(20)
    v_mfma_f32_32x32x16_bf16 v[152:167], v[176:179], v[120:123], v[152:167]
    s_waitcnt lgkmcnt(3)
    v_mfma_f32_32x32x16_bf16 v[56:71], v[176:179], v[24:27], v[56:71]
    buffer_load_dwordx4 v[176:179], v1, s[12:15], s17 offen offset:1024
    s_waitcnt vmcnt(20)
    v_mfma_f32_32x32x16_bf16 v[152:167], v[180:183], v[124:127], v[152:167]
    s_waitcnt lgkmcnt(2)
    v_mfma_f32_32x32x16_bf16 v[56:71], v[180:183], v[28:31], v[56:71]
    buffer_load_dwordx4 v[180:183], v1, s[12:15], s17 offen offset:2048
    s_waitcnt vmcnt(20)
    v_mfma_f32_32x32x16_bf16 v[152:167], v[184:187], v[128:131], v[152:167]
    s_waitcnt lgkmcnt(1)
    v_mfma_f32_32x32x16_bf16 v[56:71], v[184:187], v[32:35], v[56:71]
    buffer_load_dwordx4 v[184:187], v1, s[12:15], s17 offen offset:3072
    s_add_u32 s17, s17, 4096
    s_waitcnt vmcnt(20)
    v_mfma_f32_32x32x16_bf16 v[152:167], v[188:191], v[132:135], v[152:167]
    s_waitcnt lgkmcnt(0)
    v_mfma_f32_32x32x16_bf16 v[56:71], v[188:191], v[36:39], v[56:71]
    buffer_load_dwordx4 v[188:191], v1, s[12:15], s17 offen offset:0
    v_mov_b32 v12, 0xbfb8aa3b
    v_mov_b32 v14, 1.0
    s_nop 6
    v_cvt_pk_bf16_f32 v6, v152, v153
    v_lshlrev_b32 v152, 16, v6
    v_and_b32 v153, 0xffff0000, v6
    v_cvt_pk_bf16_f32 v6, v154, v155
    v_lshlrev_b32 v154, 16, v6
    v_and_b32 v155, 0xffff0000, v6
    v_cvt_pk_bf16_f32 v6, v156, v157
    v_lshlrev_b32 v156, 16, v6
    v_and_b32 v157, 0xffff0000, v6
    v_cvt_pk_bf16_f32 v6, v158, v159
    v_lshlrev_b32 v158, 16, v6
    v_and_b32 v159, 0xffff0000, v6
    v_cvt_pk_bf16_f32 v6, v160, v161
    v_lshlrev_b32 v160, 16, v6
    v_and_b32 v161, 0xffff0000, v6
    v_cvt_pk_bf16_f32 v6, v162, v163
    v_lshlrev_b32 v162, 16, v6
    v_and_b32 v163, 0xffff0000, v6
    v_cvt_pk_bf16_f32 v6, v164, v165
    v_lshlrev_b32 v164, 16, v6
    v_and_b32 v165, 0xffff0000, v6
    v_cvt_pk_bf16_f32 v6, v166, v167
    v_lshlrev_b32 v166, 16, v6
    v_and_b32 v167, 0xffff0000, v6
    v_pk_mul_f32 v[152:153], v[152:153], v[12:13] op_sel_hi:[1,0]
    v_pk_mul_f32 v[154:155], v[154:155], v[12:13] op_sel_hi:[1,0]
    v_pk_mul_f32 v[156:157], v[156:157], v[12:13] op_sel_hi:[1,0]
    v_pk_mul_f32 v[158:159], v[158:159], v[12:13] op_sel_hi:[1,0]
    v_pk_mul_f32 v[160:161], v[160:161], v[12:13] op_sel_hi:[1,0]
    v_pk_mul_f32 v[162:163], v[162:163], v[12:13] op_sel_hi:[1,0]
    v_pk_mul_f32 v[164:165], v[164:165], v[12:13] op_sel_hi:[1,0]
    v_pk_mul_f32 v[166:167], v[166:167], v[12:13] op_sel_hi:[1,0]
    v_exp_f32 v152, v152
    v_exp_f32 v153, v153
    v_exp_f32 v154, v154
    v_exp_f32 v155, v155
    v_exp_f32 v156, v156
    v_exp_f32 v157, v157
    v_exp_f32 v158, v158
    v_exp_f32 v159, v159
    v_exp_f32 v160, v160
    v_exp_f32 v161, v161
    v_exp_f32 v162, v162
    v_exp_f32 v163, v163
    v_exp_f32 v164, v164
    v_exp_f32 v165, v165
    v_exp_f32 v166, v166
    v_exp_f32 v167, v167
    v_cvt_pk_bf16_f32 v6, v136, v137
    v_lshlrev_b32 v136, 16, v6
    v_and_b32 v137, 0xffff0000, v6
    v_cvt_pk_bf16_f32 v6, v138, v139
    v_lshlrev_b32 v138, 16, v6
    v_and_b32 v139, 0xffff0000, v6
    v_cvt_pk_bf16_f32 v6, v140, v141
    v_lshlrev_b32 v140, 16, v6
    v_and_b32 v141, 0xffff0000, v6
    v_cvt_pk_bf16_f32 v6, v142, v143
    v_lshlrev_b32 v142, 16, v6
    v_and_b32 v143, 0xffff0000, v6
    v_cvt_pk_bf16_f32 v6, v144, v145
    v_lshlrev_b32 v144, 16, v6
    v_and_b32 v145, 0xffff0000, v6
    v_cvt_pk_bf16_f32 v6, v146, v147
    v_lshlrev_b32 v146, 16, v6
    v_and_b32 v147, 0xffff0000, v6
    v_cvt_pk_bf16_f32 v6, v148, v149
    v_lshlrev_b32 v148, 16, v6
    v_and_b32 v149, 0xffff0000, v6
    v_cvt_pk_bf16_f32 v6, v150, v151
    v_lshlrev_b32 v150, 16, v6
    v_and_b32 v151, 0xffff0000, v6
    v_pk_add_f32 v[152:153], v[152:153], v[14:15] op_sel_hi:[1,0]
    v_pk_add_f32 v[154:155], v[154:155], v[14:15] op_sel_hi:[1,0]
    v_pk_add_f32 v[156:157], v[156:157], v[14:15] op_sel_hi:[1,0]
    v_pk_add_f32 v[158:159], v[158:159], v[14:15] op_sel_hi:[1,0]
    v_pk_add_f32 v[160:161], v[160:161], v[14:15] op_sel_hi:[1,0]
    v_pk_add_f32 v[162:163], v[162:163], v[14:15] op_sel_hi:[1,0]
    v_pk_add_f32 v[164:165], v[164:165], v[14:15] op_sel_hi:[1,0]
    v_pk_add_f32 v[166:167], v[166:167], v[14:15] op_sel_hi:[1,0]
    v_rcp_f32 v152, v152
    v_rcp_f32 v153, v153
    v_rcp_f32 v154, v154
    v_rcp_f32 v155, v155
    v_rcp_f32 v156, v156
    v_rcp_f32 v157, v157
    v_rcp_f32 v158, v158
    v_rcp_f32 v159, v159
    v_rcp_f32 v160, v160
    v_rcp_f32 v161, v161
    v_rcp_f32 v162, v162
    v_rcp_f32 v163, v163
    v_rcp_f32 v164, v164
    v_rcp_f32 v165, v165
    v_rcp_f32 v166, v166
    v_rcp_f32 v167, v167
    v_cvt_pk_bf16_f32 v6, v152, v153
    v_lshlrev_b32 v152, 16, v6
    v_and_b32 v153, 0xffff0000, v6
    v_cvt_pk_bf16_f32 v6, v154, v155
    v_lshlrev_b32 v154, 16, v6
    v_and_b32 v155, 0xffff0000, v6
    v_cvt_pk_bf16_f32 v6, v156, v157
    v_lshlrev_b32 v156, 16, v6
    v_and_b32 v157, 0xffff0000, v6
    v_cvt_pk_bf16_f32 v6, v158, v159
    v_lshlrev_b32 v158, 16, v6
    v_and_b32 v159, 0xffff0000, v6
    v_cvt_pk_bf16_f32 v6, v160, v161
    v_lshlrev_b32 v160, 16, v6
    v_and_b32 v161, 0xffff0000, v6
    v_cvt_pk_bf16_f32 v6, v162, v163
    v_lshlrev_b32 v162, 16, v6
    v_and_b32 v163, 0xffff0000, v6
    v_cvt_pk_bf16_f32 v6, v164, v165
    v_lshlrev_b32 v164, 16, v6
    v_and_b32 v165, 0xffff0000, v6
    v_cvt_pk_bf16_f32 v6, v166, v167
    v_lshlrev_b32 v166, 16, v6
    v_and_b32 v167, 0xffff0000, v6
    v_pk_mul_f32 v[136:137], v[136:137], v[152:153]
    v_pk_mul_f32 v[138:139], v[138:139], v[154:155]
    v_pk_mul_f32 v[140:141], v[140:141], v[156:157]
    v_pk_mul_f32 v[142:143], v[142:143], v[158:159]
    v_pk_mul_f32 v[144:145], v[144:145], v[160:161]
    v_pk_mul_f32 v[146:147], v[146:147], v[162:163]
    v_pk_mul_f32 v[148:149], v[148:149], v[164:165]
    v_pk_mul_f32 v[150:151], v[150:151], v[166:167]
    v_cvt_pk_bf16_f32 v24, v136, v137
    v_cvt_pk_bf16_f32 v25, v138, v139
    v_cvt_pk_bf16_f32 v26, v140, v141
    v_cvt_pk_bf16_f32 v27, v142, v143
    v_cvt_pk_bf16_f32 v28, v144, v145
    v_cvt_pk_bf16_f32 v29, v146, v147
    v_cvt_pk_bf16_f32 v30, v148, v149
    v_cvt_pk_bf16_f32 v31, v150, v151
    ds_write_b128 v252, v[24:27]
    ds_write_b128 v252, v[28:31] offset:1280
    v_cvt_pk_bf16_f32 v6, v56, v57
    v_lshlrev_b32 v56, 16, v6
    v_and_b32 v57, 0xffff0000, v6
    v_cvt_pk_bf16_f32 v6, v58, v59
    v_lshlrev_b32 v58, 16, v6
    v_and_b32 v59, 0xffff0000, v6
    v_cvt_pk_bf16_f32 v6, v60, v61
    v_lshlrev_b32 v60, 16, v6
    v_and_b32 v61, 0xffff0000, v6
    v_cvt_pk_bf16_f32 v6, v62, v63
    v_lshlrev_b32 v62, 16, v6
    v_and_b32 v63, 0xffff0000, v6
    v_cvt_pk_bf16_f32 v6, v64, v65
    v_lshlrev_b32 v64, 16, v6
    v_and_b32 v65, 0xffff0000, v6
    v_cvt_pk_bf16_f32 v6, v66, v67
    v_lshlrev_b32 v66, 16, v6
    v_and_b32 v67, 0xffff0000, v6
    v_cvt_pk_bf16_f32 v6, v68, v69
    v_lshlrev_b32 v68, 16, v6
    v_and_b32 v69, 0xffff0000, v6
    v_cvt_pk_bf16_f32 v6, v70, v71
    v_lshlrev_b32 v70, 16, v6
    v_and_b32 v71, 0xffff0000, v6
    v_pk_mul_f32 v[56:57], v[56:57], v[12:13] op_sel_hi:[1,0]
    v_pk_mul_f32 v[58:59], v[58:59], v[12:13] op_sel_hi:[1,0]
    v_pk_mul_f32 v[60:61], v[60:61], v[12:13] op_sel_hi:[1,0]
    v_pk_mul_f32 v[62:63], v[62:63], v[12:13] op_sel_hi:[1,0]
    v_pk_mul_f32 v[64:65], v[64:65], v[12:13] op_sel_hi:[1,0]
    v_pk_mul_f32 v[66:67], v[66:67], v[12:13] op_sel_hi:[1,0]
    v_pk_mul_f32 v[68:69], v[68:69], v[12:13] op_sel_hi:[1,0]
    v_pk_mul_f32 v[70:71], v[70:71], v[12:13] op_sel_hi:[1,0]
    v_exp_f32 v56, v56
    v_exp_f32 v57, v57
    v_exp_f32 v58, v58
    v_exp_f32 v59, v59
    v_exp_f32 v60, v60
    v_exp_f32 v61, v61
    v_exp_f32 v62, v62
    v_exp_f32 v63, v63
    v_exp_f32 v64, v64
    v_exp_f32 v65, v65
    v_exp_f32 v66, v66
    v_exp_f32 v67, v67
    v_exp_f32 v68, v68
    v_exp_f32 v69, v69
    v_exp_f32 v70, v70
    v_exp_f32 v71, v71
    v_cvt_pk_bf16_f32 v6, v40, v41
    v_lshlrev_b32 v40, 16, v6
    v_and_b32 v41, 0xffff0000, v6
    v_cvt_pk_bf16_f32 v6, v42, v43
    v_lshlrev_b32 v42, 16, v6
    v_and_b32 v43, 0xffff0000, v6
    v_cvt_pk_bf16_f32 v6, v44, v45
    v_lshlrev_b32 v44, 16, v6
    v_and_b32 v45, 0xffff0000, v6
    v_cvt_pk_bf16_f32 v6, v46, v47
    v_lshlrev_b32 v46, 16, v6
    v_and_b32 v47, 0xffff0000, v6
    v_cvt_pk_bf16_f32 v6, v48, v49
    v_lshlrev_b32 v48, 16, v6
    v_and_b32 v49, 0xffff0000, v6
    v_cvt_pk_bf16_f32 v6, v50, v51
    v_lshlrev_b32 v50, 16, v6
    v_and_b32 v51, 0xffff0000, v6
    v_cvt_pk_bf16_f32 v6, v52, v53
    v_lshlrev_b32 v52, 16, v6
    v_and_b32 v53, 0xffff0000, v6
    v_cvt_pk_bf16_f32 v6, v54, v55
    v_lshlrev_b32 v54, 16, v6
    v_and_b32 v55, 0xffff0000, v6
    v_pk_add_f32 v[56:57], v[56:57], v[14:15] op_sel_hi:[1,0]
    v_pk_add_f32 v[58:59], v[58:59], v[14:15] op_sel_hi:[1,0]
    v_pk_add_f32 v[60:61], v[60:61], v[14:15] op_sel_hi:[1,0]
    v_pk_add_f32 v[62:63], v[62:63], v[14:15] op_sel_hi:[1,0]
    v_pk_add_f32 v[64:65], v[64:65], v[14:15] op_sel_hi:[1,0]
    v_pk_add_f32 v[66:67], v[66:67], v[14:15] op_sel_hi:[1,0]
    v_pk_add_f32 v[68:69], v[68:69], v[14:15] op_sel_hi:[1,0]
    v_pk_add_f32 v[70:71], v[70:71], v[14:15] op_sel_hi:[1,0]
    v_rcp_f32 v56, v56
    v_rcp_f32 v57, v57
    v_rcp_f32 v58, v58
    v_rcp_f32 v59, v59
    v_rcp_f32 v60, v60
    v_rcp_f32 v61, v61
    v_rcp_f32 v62, v62
    v_rcp_f32 v63, v63
    v_rcp_f32 v64, v64
    v_rcp_f32 v65, v65
    v_rcp_f32 v66, v66
    v_rcp_f32 v67, v67
    v_rcp_f32 v68, v68
    v_rcp_f32 v69, v69
    v_rcp_f32 v70, v70
    v_rcp_f32 v71, v71
    v_cvt_pk_bf16_f32 v6, v56, v57
    v_lshlrev_b32 v56, 16, v6
    v_and_b32 v57, 0xffff0000, v6
    v_cvt_pk_bf16_f32 v6, v58, v59
    v_lshlrev_b32 v58, 16, v6
    v_and_b32 v59, 0xffff0000, v6
    v_cvt_pk_bf16_f32 v6, v60, v61
    v_lshlrev_b32 v60, 16, v6
    v_and_b32 v61, 0xffff0000, v6
    v_cvt_pk_bf16_f32 v6, v62, v63
    v_lshlrev_b32 v62, 16, v6
    v_and_b32 v63, 0xffff0000, v6
    v_cvt_pk_bf16_f32 v6, v64, v65
    v_lshlrev_b32 v64, 16, v6
    v_and_b32 v65, 0xffff0000, v6
    v_cvt_pk_bf16_f32 v6, v66, v67
    v_lshlrev_b32 v66, 16, v6
    v_and_b32 v67, 0xffff0000, v6
    v_cvt_pk_bf16_f32 v6, v68, v69
    v_lshlrev_b32 v68, 16, v6
    v_and_b32 v69, 0xffff0000, v6
    v_cvt_pk_bf16_f32 v6, v70, v71
    v_lshlrev_b32 v70, 16, v6
    v_and_b32 v71, 0xffff0000, v6
    v_pk_mul_f32 v[40:41], v[40:41], v[56:57]
    v_pk_mul_f32 v[42:43], v[42:43], v[58:59]
    v_pk_mul_f32 v[44:45], v[44:45], v[60:61]
    v_pk_mul_f32 v[46:47], v[46:47], v[62:63]
    v_pk_mul_f32 v[48:49], v[48:49], v[64:65]
    v_pk_mul_f32 v[50:51], v[50:51], v[66:67]
    v_pk_mul_f32 v[52:53], v[52:53], v[68:69]
    v_pk_mul_f32 v[54:55], v[54:55], v[70:71]
    v_cvt_pk_bf16_f32 v32, v40, v41
    v_cvt_pk_bf16_f32 v33, v42, v43
    v_cvt_pk_bf16_f32 v34, v44, v45
    v_cvt_pk_bf16_f32 v35, v46, v47
    v_cvt_pk_bf16_f32 v36, v48, v49
    v_cvt_pk_bf16_f32 v37, v50, v51
    v_cvt_pk_bf16_f32 v38, v52, v53
    v_cvt_pk_bf16_f32 v39, v54, v55
    ds_write_b128 v253, v[32:35]
    ds_write_b128 v253, v[36:39] offset:1280
    s_waitcnt lgkmcnt(0)
    ds_read_b128 v[72:75], v254 offset:0
    ds_read_b128 v[76:79], v254 offset:1280
    ds_read_b128 v[80:83], v254 offset:32
    ds_read_b128 v[84:87], v254 offset:1312
    ds_read_b128 v[88:91], v254 offset:64
    ds_read_b128 v[92:95], v254 offset:1344
    ds_read_b128 v[96:99], v254 offset:96
    ds_read_b128 v[100:103], v254 offset:1376
    ds_read_b128 v[104:107], v254 offset:128
    ds_read_b128 v[108:111], v254 offset:1408
    ds_read_b64 v[112:113], v255 offset:0
    ds_read_b64 v[114:115], v255 offset:16
    ds_read_b64 v[116:117], v255 offset:32
    ds_read_b64 v[118:119], v255 offset:48
    ds_read_b64 v[120:121], v255 offset:512
    ds_read_b64 v[122:123], v255 offset:528
    ds_read_b64 v[124:125], v255 offset:544
    ds_read_b64 v[126:127], v255 offset:560
    ds_read_b64 v[128:129], v255 offset:1024
    ds_read_b64 v[130:131], v255 offset:1040
    ds_read_b64 v[132:133], v255 offset:1056
    ds_read_b64 v[134:135], v255 offset:1072
    ds_read_b64 v[136:137], v255 offset:1536
    ds_read_b64 v[138:139], v255 offset:1552
    ds_read_b64 v[140:141], v255 offset:1568
    ds_read_b64 v[142:143], v255 offset:1584
    ds_read_b64 v[144:145], v255 offset:2048
    ds_read_b64 v[146:147], v255 offset:2064
    ds_read_b64 v[148:149], v255 offset:2080
    ds_read_b64 v[150:151], v255 offset:2096
    s_waitcnt lgkmcnt(0)
    v_lshlrev_b32 v40, 16, v72
    v_and_b32 v41, 0xffff0000, v72
    v_lshlrev_b32 v42, 16, v73
    v_and_b32 v43, 0xffff0000, v73
    v_lshlrev_b32 v44, 16, v74
    v_and_b32 v45, 0xffff0000, v74
    v_lshlrev_b32 v46, 16, v75
    v_and_b32 v47, 0xffff0000, v75
    v_lshlrev_b32 v48, 16, v76
    v_and_b32 v49, 0xffff0000, v76
    v_lshlrev_b32 v50, 16, v77
    v_and_b32 v51, 0xffff0000, v77
    v_lshlrev_b32 v52, 16, v78
    v_and_b32 v53, 0xffff0000, v78
    v_lshlrev_b32 v54, 16, v79
    v_and_b32 v55, 0xffff0000, v79
    v_lshlrev_b32 v56, 16, v112
    v_and_b32 v57, 0xffff0000, v112
    v_lshlrev_b32 v58, 16, v113
    v_and_b32 v59, 0xffff0000, v113
    v_lshlrev_b32 v60, 16, v114
    v_and_b32 v61, 0xffff0000, v114
    v_lshlrev_b32 v62, 16, v115
    v_and_b32 v63, 0xffff0000, v115
    v_lshlrev_b32 v64, 16, v116
    v_and_b32 v65, 0xffff0000, v116
    v_lshlrev_b32 v66, 16, v117
    v_and_b32 v67, 0xffff0000, v117
    v_lshlrev_b32 v68, 16, v118
    v_and_b32 v69, 0xffff0000, v118
    v_lshlrev_b32 v70, 16, v119
    v_and_b32 v71, 0xffff0000, v119
    v_pk_mul_f32 v[24:25], v[40:41], v[56:57]
    v_pk_mul_f32 v[26:27], v[42:43], v[58:59]
    v_pk_mul_f32 v[28:29], v[44:45], v[60:61]
    v_pk_mul_f32 v[30:31], v[46:47], v[62:63]
    v_pk_mul_f32 v[32:33], v[48:49], v[64:65]
    v_pk_mul_f32 v[34:35], v[50:51], v[66:67]
    v_pk_mul_f32 v[36:37], v[52:53], v[68:69]
    v_pk_mul_f32 v[38:39], v[54:55], v[70:71]
    v_cvt_pk_bf16_f32 v6, v24, v25
    v_lshlrev_b32 v24, 16, v6
    v_and_b32 v25, 0xffff0000, v6
    v_cvt_pk_bf16_f32 v6, v26, v27
    v_lshlrev_b32 v26, 16, v6
    v_and_b32 v27, 0xffff0000, v6
    v_cvt_pk_bf16_f32 v6, v28, v29
    v_lshlrev_b32 v28, 16, v6
    v_and_b32 v29, 0xffff0000, v6
    v_cvt_pk_bf16_f32 v6, v30, v31
    v_lshlrev_b32 v30, 16, v6
    v_and_b32 v31, 0xffff0000, v6
    v_cvt_pk_bf16_f32 v6, v32, v33
    v_lshlrev_b32 v32, 16, v6
    v_and_b32 v33, 0xffff0000, v6
    v_cvt_pk_bf16_f32 v6, v34, v35
    v_lshlrev_b32 v34, 16, v6
    v_and_b32 v35, 0xffff0000, v6
    v_cvt_pk_bf16_f32 v6, v36, v37
    v_lshlrev_b32 v36, 16, v6
    v_and_b32 v37, 0xffff0000, v6
    v_cvt_pk_bf16_f32 v6, v38, v39
    v_lshlrev_b32 v38, 16, v6
    v_and_b32 v39, 0xffff0000, v6
    v_lshlrev_b32 v40, 16, v80
    v_and_b32 v41, 0xffff0000, v80
    v_lshlrev_b32 v42, 16, v81
    v_and_b32 v43, 0xffff0000, v81
    v_lshlrev_b32 v44, 16, v82
    v_and_b32 v45, 0xffff0000, v82
    v_lshlrev_b32 v46, 16, v83
    v_and_b32 v47, 0xffff0000, v83
    v_lshlrev_b32 v48, 16, v84
    v_and_b32 v49, 0xffff0000, v84
    v_lshlrev_b32 v50, 16, v85
    v_and_b32 v51, 0xffff0000, v85
    v_lshlrev_b32 v52, 16, v86
    v_and_b32 v53, 0xffff0000, v86
    v_lshlrev_b32 v54, 16, v87
    v_and_b32 v55, 0xffff0000, v87
    v_lshlrev_b32 v56, 16, v120
    v_and_b32 v57, 0xffff0000, v120
    v_lshlrev_b32 v58, 16, v121
    v_and_b32 v59, 0xffff0000, v121
    v_lshlrev_b32 v60, 16, v122
    v_and_b32 v61, 0xffff0000, v122
    v_lshlrev_b32 v62, 16, v123
    v_and_b32 v63, 0xffff0000, v123
    v_lshlrev_b32 v64, 16, v124
    v_and_b32 v65, 0xffff0000, v124
    v_lshlrev_b32 v66, 16, v125
    v_and_b32 v67, 0xffff0000, v125
    v_lshlrev_b32 v68, 16, v126
    v_and_b32 v69, 0xffff0000, v126
    v_lshlrev_b32 v70, 16, v127
    v_and_b32 v71, 0xffff0000, v127
    v_pk_mul_f32 v[40:41], v[40:41], v[56:57]
    v_pk_mul_f32 v[42:43], v[42:43], v[58:59]
    v_pk_mul_f32 v[44:45], v[44:45], v[60:61]
    v_pk_mul_f32 v[46:47], v[46:47], v[62:63]
    v_pk_mul_f32 v[48:49], v[48:49], v[64:65]
    v_pk_mul_f32 v[50:51], v[50:51], v[66:67]
    v_pk_mul_f32 v[52:53], v[52:53], v[68:69]
    v_pk_mul_f32 v[54:55], v[54:55], v[70:71]
    v_cvt_pk_bf16_f32 v6, v40, v41
    v_lshlrev_b32 v40, 16, v6
    v_and_b32 v41, 0xffff0000, v6
    v_cvt_pk_bf16_f32 v6, v42, v43
    v_lshlrev_b32 v42, 16, v6
    v_and_b32 v43, 0xffff0000, v6
    v_cvt_pk_bf16_f32 v6, v44, v45
    v_lshlrev_b32 v44, 16, v6
    v_and_b32 v45, 0xffff0000, v6
    v_cvt_pk_bf16_f32 v6, v46, v47
    v_lshlrev_b32 v46, 16, v6
    v_and_b32 v47, 0xffff0000, v6
    v_cvt_pk_bf16_f32 v6, v48, v49
    v_lshlrev_b32 v48, 16, v6
    v_and_b32 v49, 0xffff0000, v6
    v_cvt_pk_bf16_f32 v6, v50, v51
    v_lshlrev_b32 v50, 16, v6
    v_and_b32 v51, 0xffff0000, v6
    v_cvt_pk_bf16_f32 v6, v52, v53
    v_lshlrev_b32 v52, 16, v6
    v_and_b32 v53, 0xffff0000, v6
    v_cvt_pk_bf16_f32 v6, v54, v55
    v_lshlrev_b32 v54, 16, v6
    v_and_b32 v55, 0xffff0000, v6
    v_pk_add_f32 v[24:25], v[24:25], v[40:41]
    v_pk_add_f32 v[26:27], v[26:27], v[42:43]
    v_pk_add_f32 v[28:29], v[28:29], v[44:45]
    v_pk_add_f32 v[30:31], v[30:31], v[46:47]
    v_pk_add_f32 v[32:33], v[32:33], v[48:49]
    v_pk_add_f32 v[34:35], v[34:35], v[50:51]
    v_pk_add_f32 v[36:37], v[36:37], v[52:53]
    v_pk_add_f32 v[38:39], v[38:39], v[54:55]
    v_cvt_pk_bf16_f32 v6, v24, v25
    v_lshlrev_b32 v24, 16, v6
    v_and_b32 v25, 0xffff0000, v6
    v_cvt_pk_bf16_f32 v6, v26, v27
    v_lshlrev_b32 v26, 16, v6
    v_and_b32 v27, 0xffff0000, v6
    v_cvt_pk_bf16_f32 v6, v28, v29
    v_lshlrev_b32 v28, 16, v6
    v_and_b32 v29, 0xffff0000, v6
    v_cvt_pk_bf16_f32 v6, v30, v31
    v_lshlrev_b32 v30, 16, v6
    v_and_b32 v31, 0xffff0000, v6
    v_cvt_pk_bf16_f32 v6, v32, v33
    v_lshlrev_b32 v32, 16, v6
    v_and_b32 v33, 0xffff0000, v6
    v_cvt_pk_bf16_f32 v6, v34, v35
    v_lshlrev_b32 v34, 16, v6
    v_and_b32 v35, 0xffff0000, v6
    v_cvt_pk_bf16_f32 v6, v36, v37
    v_lshlrev_b32 v36, 16, v6
    v_and_b32 v37, 0xffff0000, v6
    v_cvt_pk_bf16_f32 v6, v38, v39
    v_lshlrev_b32 v38, 16, v6
    v_and_b32 v39, 0xffff0000, v6
    v_lshlrev_b32 v40, 16, v88
    v_and_b32 v41, 0xffff0000, v88
    v_lshlrev_b32 v42, 16, v89
    v_and_b32 v43, 0xffff0000, v89
    v_lshlrev_b32 v44, 16, v90
    v_and_b32 v45, 0xffff0000, v90
    v_lshlrev_b32 v46, 16, v91
    v_and_b32 v47, 0xffff0000, v91
    v_lshlrev_b32 v48, 16, v92
    v_and_b32 v49, 0xffff0000, v92
    v_lshlrev_b32 v50, 16, v93
    v_and_b32 v51, 0xffff0000, v93
    v_lshlrev_b32 v52, 16, v94
    v_and_b32 v53, 0xffff0000, v94
    v_lshlrev_b32 v54, 16, v95
    v_and_b32 v55, 0xffff0000, v95
    v_lshlrev_b32 v56, 16, v128
    v_and_b32 v57, 0xffff0000, v128
    v_lshlrev_b32 v58, 16, v129
    v_and_b32 v59, 0xffff0000, v129
    v_lshlrev_b32 v60, 16, v130
    v_and_b32 v61, 0xffff0000, v130
    v_lshlrev_b32 v62, 16, v131
    v_and_b32 v63, 0xffff0000, v131
    v_lshlrev_b32 v64, 16, v132
    v_and_b32 v65, 0xffff0000, v132
    v_lshlrev_b32 v66, 16, v133
    v_and_b32 v67, 0xffff0000, v133
    v_lshlrev_b32 v68, 16, v134
    v_and_b32 v69, 0xffff0000, v134
    v_lshlrev_b32 v70, 16, v135
    v_and_b32 v71, 0xffff0000, v135
    v_pk_mul_f32 v[40:41], v[40:41], v[56:57]
    v_pk_mul_f32 v[42:43], v[42:43], v[58:59]
    v_pk_mul_f32 v[44:45], v[44:45], v[60:61]
    v_pk_mul_f32 v[46:47], v[46:47], v[62:63]
    v_pk_mul_f32 v[48:49], v[48:49], v[64:65]
    v_pk_mul_f32 v[50:51], v[50:51], v[66:67]
    v_pk_mul_f32 v[52:53], v[52:53], v[68:69]
    v_pk_mul_f32 v[54:55], v[54:55], v[70:71]
    v_cvt_pk_bf16_f32 v6, v40, v41
    v_lshlrev_b32 v40, 16, v6
    v_and_b32 v41, 0xffff0000, v6
    v_cvt_pk_bf16_f32 v6, v42, v43
    v_lshlrev_b32 v42, 16, v6
    v_and_b32 v43, 0xffff0000, v6
    v_cvt_pk_bf16_f32 v6, v44, v45
    v_lshlrev_b32 v44, 16, v6
    v_and_b32 v45, 0xffff0000, v6
    v_cvt_pk_bf16_f32 v6, v46, v47
    v_lshlrev_b32 v46, 16, v6
    v_and_b32 v47, 0xffff0000, v6
    v_cvt_pk_bf16_f32 v6, v48, v49
    v_lshlrev_b32 v48, 16, v6
    v_and_b32 v49, 0xffff0000, v6
    v_cvt_pk_bf16_f32 v6, v50, v51
    v_lshlrev_b32 v50, 16, v6
    v_and_b32 v51, 0xffff0000, v6
    v_cvt_pk_bf16_f32 v6, v52, v53
    v_lshlrev_b32 v52, 16, v6
    v_and_b32 v53, 0xffff0000, v6
    v_cvt_pk_bf16_f32 v6, v54, v55
    v_lshlrev_b32 v54, 16, v6
    v_and_b32 v55, 0xffff0000, v6
    v_pk_add_f32 v[24:25], v[24:25], v[40:41]
    v_pk_add_f32 v[26:27], v[26:27], v[42:43]
    v_pk_add_f32 v[28:29], v[28:29], v[44:45]
    v_pk_add_f32 v[30:31], v[30:31], v[46:47]
    v_pk_add_f32 v[32:33], v[32:33], v[48:49]
    v_pk_add_f32 v[34:35], v[34:35], v[50:51]
    v_pk_add_f32 v[36:37], v[36:37], v[52:53]
    v_pk_add_f32 v[38:39], v[38:39], v[54:55]
    v_cvt_pk_bf16_f32 v6, v24, v25
    v_lshlrev_b32 v24, 16, v6
    v_and_b32 v25, 0xffff0000, v6
    v_cvt_pk_bf16_f32 v6, v26, v27
    v_lshlrev_b32 v26, 16, v6
    v_and_b32 v27, 0xffff0000, v6
    v_cvt_pk_bf16_f32 v6, v28, v29
    v_lshlrev_b32 v28, 16, v6
    v_and_b32 v29, 0xffff0000, v6
    v_cvt_pk_bf16_f32 v6, v30, v31
    v_lshlrev_b32 v30, 16, v6
    v_and_b32 v31, 0xffff0000, v6
    v_cvt_pk_bf16_f32 v6, v32, v33
    v_lshlrev_b32 v32, 16, v6
    v_and_b32 v33, 0xffff0000, v6
    v_cvt_pk_bf16_f32 v6, v34, v35
    v_lshlrev_b32 v34, 16, v6
    v_and_b32 v35, 0xffff0000, v6
    v_cvt_pk_bf16_f32 v6, v36, v37
    v_lshlrev_b32 v36, 16, v6
    v_and_b32 v37, 0xffff0000, v6
    v_cvt_pk_bf16_f32 v6, v38, v39
    v_lshlrev_b32 v38, 16, v6
    v_and_b32 v39, 0xffff0000, v6
    v_lshlrev_b32 v40, 16, v96
    v_and_b32 v41, 0xffff0000, v96
    v_lshlrev_b32 v42, 16, v97
    v_and_b32 v43, 0xffff0000, v97
    v_lshlrev_b32 v44, 16, v98
    v_and_b32 v45, 0xffff0000, v98
    v_lshlrev_b32 v46, 16, v99
    v_and_b32 v47, 0xffff0000, v99
    v_lshlrev_b32 v48, 16, v100
    v_and_b32 v49, 0xffff0000, v100
    v_lshlrev_b32 v50, 16, v101
    v_and_b32 v51, 0xffff0000, v101
    v_lshlrev_b32 v52, 16, v102
    v_and_b32 v53, 0xffff0000, v102
    v_lshlrev_b32 v54, 16, v103
    v_and_b32 v55, 0xffff0000, v103
    v_lshlrev_b32 v56, 16, v136
    v_and_b32 v57, 0xffff0000, v136
    v_lshlrev_b32 v58, 16, v137
    v_and_b32 v59, 0xffff0000, v137
    v_lshlrev_b32 v60, 16, v138
    v_and_b32 v61, 0xffff0000, v138
    v_lshlrev_b32 v62, 16, v139
    v_and_b32 v63, 0xffff0000, v139
    v_lshlrev_b32 v64, 16, v140
    v_and_b32 v65, 0xffff0000, v140
    v_lshlrev_b32 v66, 16, v141
    v_and_b32 v67, 0xffff0000, v141
    v_lshlrev_b32 v68, 16, v142
    v_and_b32 v69, 0xffff0000, v142
    v_lshlrev_b32 v70, 16, v143
    v_and_b32 v71, 0xffff0000, v143
    v_pk_mul_f32 v[40:41], v[40:41], v[56:57]
    v_pk_mul_f32 v[42:43], v[42:43], v[58:59]
    v_pk_mul_f32 v[44:45], v[44:45], v[60:61]
    v_pk_mul_f32 v[46:47], v[46:47], v[62:63]
    v_pk_mul_f32 v[48:49], v[48:49], v[64:65]
    v_pk_mul_f32 v[50:51], v[50:51], v[66:67]
    v_pk_mul_f32 v[52:53], v[52:53], v[68:69]
    v_pk_mul_f32 v[54:55], v[54:55], v[70:71]
    v_cvt_pk_bf16_f32 v6, v40, v41
    v_lshlrev_b32 v40, 16, v6
    v_and_b32 v41, 0xffff0000, v6
    v_cvt_pk_bf16_f32 v6, v42, v43
    v_lshlrev_b32 v42, 16, v6
    v_and_b32 v43, 0xffff0000, v6
    v_cvt_pk_bf16_f32 v6, v44, v45
    v_lshlrev_b32 v44, 16, v6
    v_and_b32 v45, 0xffff0000, v6
    v_cvt_pk_bf16_f32 v6, v46, v47
    v_lshlrev_b32 v46, 16, v6
    v_and_b32 v47, 0xffff0000, v6
    v_cvt_pk_bf16_f32 v6, v48, v49
    v_lshlrev_b32 v48, 16, v6
    v_and_b32 v49, 0xffff0000, v6
    v_cvt_pk_bf16_f32 v6, v50, v51
    v_lshlrev_b32 v50, 16, v6
    v_and_b32 v51, 0xffff0000, v6
    v_cvt_pk_bf16_f32 v6, v52, v53
    v_lshlrev_b32 v52, 16, v6
    v_and_b32 v53, 0xffff0000, v6
    v_cvt_pk_bf16_f32 v6, v54, v55
    v_lshlrev_b32 v54, 16, v6
    v_and_b32 v55, 0xffff0000, v6
    v_pk_add_f32 v[24:25], v[24:25], v[40:41]
    v_pk_add_f32 v[26:27], v[26:27], v[42:43]
    v_pk_add_f32 v[28:29], v[28:29], v[44:45]
    v_pk_add_f32 v[30:31], v[30:31], v[46:47]
    v_pk_add_f32 v[32:33], v[32:33], v[48:49]
    v_pk_add_f32 v[34:35], v[34:35], v[50:51]
    v_pk_add_f32 v[36:37], v[36:37], v[52:53]
    v_pk_add_f32 v[38:39], v[38:39], v[54:55]
    v_cvt_pk_bf16_f32 v6, v24, v25
    v_lshlrev_b32 v24, 16, v6
    v_and_b32 v25, 0xffff0000, v6
    v_cvt_pk_bf16_f32 v6, v26, v27
    v_lshlrev_b32 v26, 16, v6
    v_and_b32 v27, 0xffff0000, v6
    v_cvt_pk_bf16_f32 v6, v28, v29
    v_lshlrev_b32 v28, 16, v6
    v_and_b32 v29, 0xffff0000, v6
    v_cvt_pk_bf16_f32 v6, v30, v31
    v_lshlrev_b32 v30, 16, v6
    v_and_b32 v31, 0xffff0000, v6
    v_cvt_pk_bf16_f32 v6, v32, v33
    v_lshlrev_b32 v32, 16, v6
    v_and_b32 v33, 0xffff0000, v6
    v_cvt_pk_bf16_f32 v6, v34, v35
    v_lshlrev_b32 v34, 16, v6
    v_and_b32 v35, 0xffff0000, v6
    v_cvt_pk_bf16_f32 v6, v36, v37
    v_lshlrev_b32 v36, 16, v6
    v_and_b32 v37, 0xffff0000, v6
    v_cvt_pk_bf16_f32 v6, v38, v39
    v_lshlrev_b32 v38, 16, v6
    v_and_b32 v39, 0xffff0000, v6
    v_lshlrev_b32 v40, 16, v104
    v_and_b32 v41, 0xffff0000, v104
    v_lshlrev_b32 v42, 16, v105
    v_and_b32 v43, 0xffff0000, v105
    v_lshlrev_b32 v44, 16, v106
    v_and_b32 v45, 0xffff0000, v106
    v_lshlrev_b32 v46, 16, v107
    v_and_b32 v47, 0xffff0000, v107
    v_lshlrev_b32 v48, 16, v108
    v_and_b32 v49, 0xffff0000, v108
    v_lshlrev_b32 v50, 16, v109
    v_and_b32 v51, 0xffff0000, v109
    v_lshlrev_b32 v52, 16, v110
    v_and_b32 v53, 0xffff0000, v110
    v_lshlrev_b32 v54, 16, v111
    v_and_b32 v55, 0xffff0000, v111
    v_lshlrev_b32 v56, 16, v144
    v_and_b32 v57, 0xffff0000, v144
    v_lshlrev_b32 v58, 16, v145
    v_and_b32 v59, 0xffff0000, v145
    v_lshlrev_b32 v60, 16, v146
    v_and_b32 v61, 0xffff0000, v146
    v_lshlrev_b32 v62, 16, v147
    v_and_b32 v63, 0xffff0000, v147
    v_lshlrev_b32 v64, 16, v148
    v_and_b32 v65, 0xffff0000, v148
    v_lshlrev_b32 v66, 16, v149
    v_and_b32 v67, 0xffff0000, v149
    v_lshlrev_b32 v68, 16, v150
    v_and_b32 v69, 0xffff0000, v150
    v_lshlrev_b32 v70, 16, v151
    v_and_b32 v71, 0xffff0000, v151
    v_pk_mul_f32 v[40:41], v[40:41], v[56:57]
    v_pk_mul_f32 v[42:43], v[42:43], v[58:59]
    v_pk_mul_f32 v[44:45], v[44:45], v[60:61]
    v_pk_mul_f32 v[46:47], v[46:47], v[62:63]
    v_pk_mul_f32 v[48:49], v[48:49], v[64:65]
    v_pk_mul_f32 v[50:51], v[50:51], v[66:67]
    v_pk_mul_f32 v[52:53], v[52:53], v[68:69]
    v_pk_mul_f32 v[54:55], v[54:55], v[70:71]
    v_cvt_pk_bf16_f32 v6, v40, v41
    v_lshlrev_b32 v40, 16, v6
    v_and_b32 v41, 0xffff0000, v6
    v_cvt_pk_bf16_f32 v6, v42, v43
    v_lshlrev_b32 v42, 16, v6
    v_and_b32 v43, 0xffff0000, v6
    v_cvt_pk_bf16_f32 v6, v44, v45
    v_lshlrev_b32 v44, 16, v6
    v_and_b32 v45, 0xffff0000, v6
    v_cvt_pk_bf16_f32 v6, v46, v47
    v_lshlrev_b32 v46, 16, v6
    v_and_b32 v47, 0xffff0000, v6
    v_cvt_pk_bf16_f32 v6, v48, v49
    v_lshlrev_b32 v48, 16, v6
    v_and_b32 v49, 0xffff0000, v6
    v_cvt_pk_bf16_f32 v6, v50, v51
    v_lshlrev_b32 v50, 16, v6
    v_and_b32 v51, 0xffff0000, v6
    v_cvt_pk_bf16_f32 v6, v52, v53
    v_lshlrev_b32 v52, 16, v6
    v_and_b32 v53, 0xffff0000, v6
    v_cvt_pk_bf16_f32 v6, v54, v55
    v_lshlrev_b32 v54, 16, v6
    v_and_b32 v55, 0xffff0000, v6
    v_pk_add_f32 v[24:25], v[24:25], v[40:41]
    v_pk_add_f32 v[26:27], v[26:27], v[42:43]
    v_pk_add_f32 v[28:29], v[28:29], v[44:45]
    v_pk_add_f32 v[30:31], v[30:31], v[46:47]
    v_pk_add_f32 v[32:33], v[32:33], v[48:49]
    v_pk_add_f32 v[34:35], v[34:35], v[50:51]
    v_pk_add_f32 v[36:37], v[36:37], v[52:53]
    v_pk_add_f32 v[38:39], v[38:39], v[54:55]
    v_cvt_pk_bf16_f32 v6, v24, v25
    v_lshlrev_b32 v24, 16, v6
    v_and_b32 v25, 0xffff0000, v6
    v_cvt_pk_bf16_f32 v6, v26, v27
    v_lshlrev_b32 v26, 16, v6
    v_and_b32 v27, 0xffff0000, v6
    v_cvt_pk_bf16_f32 v6, v28, v29
    v_lshlrev_b32 v28, 16, v6
    v_and_b32 v29, 0xffff0000, v6
    v_cvt_pk_bf16_f32 v6, v30, v31
    v_lshlrev_b32 v30, 16, v6
    v_and_b32 v31, 0xffff0000, v6
    v_cvt_pk_bf16_f32 v6, v32, v33
    v_lshlrev_b32 v32, 16, v6
    v_and_b32 v33, 0xffff0000, v6
    v_cvt_pk_bf16_f32 v6, v34, v35
    v_lshlrev_b32 v34, 16, v6
    v_and_b32 v35, 0xffff0000, v6
    v_cvt_pk_bf16_f32 v6, v36, v37
    v_lshlrev_b32 v36, 16, v6
    v_and_b32 v37, 0xffff0000, v6
    v_cvt_pk_bf16_f32 v6, v38, v39
    v_lshlrev_b32 v38, 16, v6
    v_and_b32 v39, 0xffff0000, v6
    v_cvt_pk_bf16_f32 v6, v24, v25
    v_lshlrev_b32 v24, 16, v6
    v_and_b32 v25, 0xffff0000, v6
    v_mul_f32 v7, 0xbfb8aa3b, v24
    v_mul_f32 v8, 0xbfb8aa3b, v25
    v_exp_f32 v7, v7
    v_exp_f32 v8, v8
    v_add_f32 v7, 1.0, v7
    v_add_f32 v8, 1.0, v8
    v_rcp_f32 v7, v7
    v_rcp_f32 v8, v8
    v_mul_f32 v24, v24, v7
    v_mul_f32 v25, v25, v8
    v_cvt_pk_bf16_f32 v56, v24, v25
    v_cvt_pk_bf16_f32 v6, v26, v27
    v_lshlrev_b32 v26, 16, v6
    v_and_b32 v27, 0xffff0000, v6
    v_mul_f32 v9, 0xbfb8aa3b, v26
    v_mul_f32 v10, 0xbfb8aa3b, v27
    v_exp_f32 v9, v9
    v_exp_f32 v10, v10
    v_add_f32 v9, 1.0, v9
    v_add_f32 v10, 1.0, v10
    v_rcp_f32 v9, v9
    v_rcp_f32 v10, v10
    v_mul_f32 v26, v26, v9
    v_mul_f32 v27, v27, v10
    v_cvt_pk_bf16_f32 v57, v26, v27
    v_cvt_pk_bf16_f32 v6, v28, v29
    v_lshlrev_b32 v28, 16, v6
    v_and_b32 v29, 0xffff0000, v6
    v_mul_f32 v7, 0xbfb8aa3b, v28
    v_mul_f32 v8, 0xbfb8aa3b, v29
    v_exp_f32 v7, v7
    v_exp_f32 v8, v8
    v_add_f32 v7, 1.0, v7
    v_add_f32 v8, 1.0, v8
    v_rcp_f32 v7, v7
    v_rcp_f32 v8, v8
    v_mul_f32 v28, v28, v7
    v_mul_f32 v29, v29, v8
    v_cvt_pk_bf16_f32 v58, v28, v29
    v_cvt_pk_bf16_f32 v6, v30, v31
    v_lshlrev_b32 v30, 16, v6
    v_and_b32 v31, 0xffff0000, v6
    v_mul_f32 v9, 0xbfb8aa3b, v30
    v_mul_f32 v10, 0xbfb8aa3b, v31
    v_exp_f32 v9, v9
    v_exp_f32 v10, v10
    v_add_f32 v9, 1.0, v9
    v_add_f32 v10, 1.0, v10
    v_rcp_f32 v9, v9
    v_rcp_f32 v10, v10
    v_mul_f32 v30, v30, v9
    v_mul_f32 v31, v31, v10
    v_cvt_pk_bf16_f32 v59, v30, v31
    v_cvt_pk_bf16_f32 v6, v32, v33
    v_lshlrev_b32 v32, 16, v6
    v_and_b32 v33, 0xffff0000, v6
    v_mul_f32 v7, 0xbfb8aa3b, v32
    v_mul_f32 v8, 0xbfb8aa3b, v33
    v_exp_f32 v7, v7
    v_exp_f32 v8, v8
    v_add_f32 v7, 1.0, v7
    v_add_f32 v8, 1.0, v8
    v_rcp_f32 v7, v7
    v_rcp_f32 v8, v8
    v_mul_f32 v32, v32, v7
    v_mul_f32 v33, v33, v8
    v_cvt_pk_bf16_f32 v60, v32, v33
    v_cvt_pk_bf16_f32 v6, v34, v35
    v_lshlrev_b32 v34, 16, v6
    v_and_b32 v35, 0xffff0000, v6
    v_mul_f32 v9, 0xbfb8aa3b, v34
    v_mul_f32 v10, 0xbfb8aa3b, v35
    v_exp_f32 v9, v9
    v_exp_f32 v10, v10
    v_add_f32 v9, 1.0, v9
    v_add_f32 v10, 1.0, v10
    v_rcp_f32 v9, v9
    v_rcp_f32 v10, v10
    v_mul_f32 v34, v34, v9
    v_mul_f32 v35, v35, v10
    v_cvt_pk_bf16_f32 v61, v34, v35
    v_cvt_pk_bf16_f32 v6, v36, v37
    v_lshlrev_b32 v36, 16, v6
    v_and_b32 v37, 0xffff0000, v6
    v_mul_f32 v7, 0xbfb8aa3b, v36
    v_mul_f32 v8, 0xbfb8aa3b, v37
    v_exp_f32 v7, v7
    v_exp_f32 v8, v8
    v_add_f32 v7, 1.0, v7
    v_add_f32 v8, 1.0, v8
    v_rcp_f32 v7, v7
    v_rcp_f32 v8, v8
    v_mul_f32 v36, v36, v7
    v_mul_f32 v37, v37, v8
    v_cvt_pk_bf16_f32 v62, v36, v37
    v_cvt_pk_bf16_f32 v6, v38, v39
    v_lshlrev_b32 v38, 16, v6
    v_and_b32 v39, 0xffff0000, v6
    v_mul_f32 v9, 0xbfb8aa3b, v38
    v_mul_f32 v10, 0xbfb8aa3b, v39
    v_exp_f32 v9, v9
    v_exp_f32 v10, v10
    v_add_f32 v9, 1.0, v9
    v_add_f32 v10, 1.0, v10
    v_rcp_f32 v9, v9
    v_rcp_f32 v10, v10
    v_mul_f32 v38, v38, v9
    v_mul_f32 v39, v39, v10
    v_cvt_pk_bf16_f32 v63, v38, v39
    ds_write_b128 v4, v[56:59]
    ds_write_b128 v4, v[60:63] offset:1024
    s_waitcnt lgkmcnt(0)
    s_barrier
    ds_read_b128 v[72:75], v5 offset:0
    ds_read_b128 v[76:79], v5 offset:1024
    ds_read_b128 v[80:83], v5 offset:2048
    ds_read_b128 v[84:87], v5 offset:3072
    ds_read_b128 v[88:91], v5 offset:4096
    ds_read_b128 v[92:95], v5 offset:5120
    ds_read_b128 v[96:99], v5 offset:6144
    ds_read_b128 v[100:103], v5 offset:7168
    ds_read_b128 v[104:107], v5 offset:8192
    ds_read_b128 v[108:111], v5 offset:9216
    ds_read_b128 v[112:115], v5 offset:10240
    ds_read_b128 v[116:119], v5 offset:11264
    ds_read_b128 v[120:123], v5 offset:12288
    ds_read_b128 v[124:127], v5 offset:13312
    ds_read_b128 v[128:131], v5 offset:14336
    ds_read_b128 v[132:135], v5 offset:15360
    s_waitcnt lgkmcnt(0)
    s_waitcnt vmcnt(20)
    v_mfma_f32_32x32x16_bf16 v[136:151], v[192:195], v[72:75], 0
    buffer_load_dwordx4 v[192:195], v1, s[12:15], s17 offen offset:1024
    s_waitcnt vmcnt(20)
    v_mfma_f32_32x32x16_bf16 v[136:151], v[196:199], v[76:79], v[136:151]
    buffer_load_dwordx4 v[196:199], v1, s[12:15], s17 offen offset:2048
    s_waitcnt vmcnt(20)
    v_mfma_f32_32x32x16_bf16 v[136:151], v[200:203], v[80:83], v[136:151]
    buffer_load_dwordx4 v[200:203], v1, s[12:15], s17 offen offset:3072
    s_add_u32 s17, s17, 4096
    s_waitcnt vmcnt(20)
    v_mfma_f32_32x32x16_bf16 v[136:151], v[204:207], v[84:87], v[136:151]
    buffer_load_dwordx4 v[204:207], v1, s[12:15], s17 offen offset:0
    s_waitcnt vmcnt(20)
    v_mfma_f32_32x32x16_bf16 v[136:151], v[208:211], v[88:91], v[136:151]
    buffer_load_dwordx4 v[208:211], v1, s[12:15], s17 offen offset:1024
    s_waitcnt vmcnt(20)
    v_mfma_f32_32x32x16_bf16 v[136:151], v[212:215], v[92:95], v[136:151]
    buffer_load_dwordx4 v[212:215], v1, s[12:15], s17 offen offset:2048
    s_waitcnt vmcnt(20)
    v_mfma_f32_32x32x16_bf16 v[136:151], v[216:219], v[96:99], v[136:151]
    buffer_load_dwordx4 v[216:219], v1, s[12:15], s17 offen offset:3072
    s_add_u32 s17, s17, 4096
    s_waitcnt vmcnt(20)
    v_mfma_f32_32x32x16_bf16 v[136:151], v[220:223], v[100:103], v[136:151]
    buffer_load_dwordx4 v[220:223], v1, s[12:15], s17 offen offset:0
    s_waitcnt vmcnt(20)
    v_mfma_f32_32x32x16_bf16 v[136:151], v[224:227], v[104:107], v[136:151]
    buffer_load_dwordx4 v[224:227], v1, s[12:15], s17 offen offset:1024
    s_waitcnt vmcnt(20)
    v_mfma_f32_32x32x16_bf16 v[136:151], v[228:231], v[108:111], v[136:151]
    buffer_load_dwordx4 v[228:231], v1, s[12:15], s17 offen offset:2048
    s_waitcnt vmcnt(20)
    v_mfma_f32_32x32x16_bf16 v[136:151], v[232:235], v[112:115], v[136:151]
    buffer_load_dwordx4 v[232:235], v1, s[12:15], s17 offen offset:3072
    s_add_u32 s17, s17, 4096
    s_waitcnt vmcnt(20)
    v_mfma_f32_32x32x16_bf16 v[136:151], v[236:239], v[116:119], v[136:151]
    buffer_load_dwordx4 v[236:239], v1, s[12:15], s17 offen offset:0
    s_waitcnt vmcnt(20)
    v_mfma_f32_32x32x16_bf16 v[136:151], v[240:243], v[120:123], v[136:151]
    buffer_load_dwordx4 v[240:243], v1, s[12:15], s17 offen offset:1024
    s_waitcnt vmcnt(20)
    v_mfma_f32_32x32x16_bf16 v[136:151], v[244:247], v[124:127], v[136:151]
    buffer_load_dwordx4 v[244:247], v1, s[12:15], s17 offen offset:2048
    s_waitcnt vmcnt(20)
    v_mfma_f32_32x32x16_bf16 v[136:151], v[248:251], v[128:131], v[136:151]
    buffer_load_dwordx4 v[248:251], v1, s[12:15], s17 offen offset:3072
    s_add_u32 s17, s17, 4096
    s_waitcnt vmcnt(20)
    v_mfma_f32_32x32x16_bf16 v[136:151], v[168:171], v[132:135], v[136:151]
    buffer_load_dwordx4 v[168:171], v1, s[12:15], s17 offen offset:0
    s_nop 10
    v_cvt_pk_bf16_f32 v6, v136, v137
    v_lshlrev_b32 v136, 16, v6
    v_and_b32 v137, 0xffff0000, v6
    v_cvt_pk_bf16_f32 v6, v138, v139
    v_lshlrev_b32 v138, 16, v6
    v_and_b32 v139, 0xffff0000, v6
    v_cvt_pk_bf16_f32 v6, v140, v141
    v_lshlrev_b32 v140, 16, v6
    v_and_b32 v141, 0xffff0000, v6
    v_cvt_pk_bf16_f32 v6, v142, v143
    v_lshlrev_b32 v142, 16, v6
    v_and_b32 v143, 0xffff0000, v6
    v_cvt_pk_bf16_f32 v6, v144, v145
    v_lshlrev_b32 v144, 16, v6
    v_and_b32 v145, 0xffff0000, v6
    v_cvt_pk_bf16_f32 v6, v146, v147
    v_lshlrev_b32 v146, 16, v6
    v_and_b32 v147, 0xffff0000, v6
    v_cvt_pk_bf16_f32 v6, v148, v149
    v_lshlrev_b32 v148, 16, v6
    v_and_b32 v149, 0xffff0000, v6
    v_cvt_pk_bf16_f32 v6, v150, v151
    v_lshlrev_b32 v150, 16, v6
    v_and_b32 v151, 0xffff0000, v6
    v_lshlrev_b32 v24, 16, v16
    v_and_b32 v25, 0xffff0000, v16
    v_lshlrev_b32 v26, 16, v17
    v_and_b32 v27, 0xffff0000, v17
    v_lshlrev_b32 v28, 16, v18
    v_and_b32 v29, 0xffff0000, v18
    v_lshlrev_b32 v30, 16, v19
    v_and_b32 v31, 0xffff0000, v19
    v_lshlrev_b32 v32, 16, v20
    v_and_b32 v33, 0xffff0000, v20
    v_lshlrev_b32 v34, 16, v21
    v_and_b32 v35, 0xffff0000, v21
    v_lshlrev_b32 v36, 16, v22
    v_and_b32 v37, 0xffff0000, v22
    v_lshlrev_b32 v38, 16, v23
    v_and_b32 v39, 0xffff0000, v23
    v_pk_add_f32 v[24:25], v[24:25], v[136:137]
    v_pk_add_f32 v[26:27], v[26:27], v[138:139]
    v_pk_add_f32 v[28:29], v[28:29], v[140:141]
    v_pk_add_f32 v[30:31], v[30:31], v[142:143]
    v_pk_add_f32 v[32:33], v[32:33], v[144:145]
    v_pk_add_f32 v[34:35], v[34:35], v[146:147]
    v_pk_add_f32 v[36:37], v[36:37], v[148:149]
    v_pk_add_f32 v[38:39], v[38:39], v[150:151]
    v_cvt_pk_bf16_f32 v16, v24, v25
    v_cvt_pk_bf16_f32 v17, v26, v27
    v_cvt_pk_bf16_f32 v18, v28, v29
    v_cvt_pk_bf16_f32 v19, v30, v31
    v_cvt_pk_bf16_f32 v20, v32, v33
    v_cvt_pk_bf16_f32 v21, v34, v35
    v_cvt_pk_bf16_f32 v22, v36, v37
    v_cvt_pk_bf16_f32 v23, v38, v39
    v_lshlrev_b32 v24, 16, v16
    v_and_b32 v25, 0xffff0000, v16
    v_lshlrev_b32 v26, 16, v17
    v_and_b32 v27, 0xffff0000, v17
    v_lshlrev_b32 v28, 16, v18
    v_and_b32 v29, 0xffff0000, v18
    v_lshlrev_b32 v30, 16, v19
    v_and_b32 v31, 0xffff0000, v19
    v_lshlrev_b32 v32, 16, v20
    v_and_b32 v33, 0xffff0000, v20
    v_lshlrev_b32 v34, 16, v21
    v_and_b32 v35, 0xffff0000, v21
    v_lshlrev_b32 v36, 16, v22
    v_and_b32 v37, 0xffff0000, v22
    v_lshlrev_b32 v38, 16, v23
    v_and_b32 v39, 0xffff0000, v23
    v_pk_add_f32 v[6:7], v[24:25], v[26:27]
    v_pk_add_f32 v[8:9], v[28:29], v[30:31]
    v_pk_add_f32 v[10:11], v[32:33], v[34:35]
    v_pk_add_f32 v[12:13], v[36:37], v[38:39]
    v_pk_add_f32 v[6:7], v[6:7], v[8:9]
    v_pk_add_f32 v[10:11], v[10:11], v[12:13]
    v_pk_add_f32 v[6:7], v[6:7], v[10:11]
    v_add_f32 v6, v6, v7
    v_mul_f32 v6, 0x3d800000, v6
    v_pk_add_f32 v[10:11], v[24:25], v[6:7] op_sel_hi:[1,0] neg_lo:[0,1] neg_hi:[0,1]
    v_pk_mul_f32 v[8:9], v[10:11], v[10:11]
    v_pk_add_f32 v[12:13], v[26:27], v[6:7] op_sel_hi:[1,0] neg_lo:[0,1] neg_hi:[0,1]
    v_pk_fma_f32 v[8:9], v[12:13], v[12:13], v[8:9]
    v_pk_add_f32 v[10:11], v[28:29], v[6:7] op_sel_hi:[1,0] neg_lo:[0,1] neg_hi:[0,1]
    v_pk_fma_f32 v[8:9], v[10:11], v[10:11], v[8:9]
    v_pk_add_f32 v[12:13], v[30:31], v[6:7] op_sel_hi:[1,0] neg_lo:[0,1] neg_hi:[0,1]
    v_pk_fma_f32 v[8:9], v[12:13], v[12:13], v[8:9]
    v_pk_add_f32 v[10:11], v[32:33], v[6:7] op_sel_hi:[1,0] neg_lo:[0,1] neg_hi:[0,1]
    v_pk_fma_f32 v[8:9], v[10:11], v[10:11], v[8:9]
    v_pk_add_f32 v[12:13], v[34:35], v[6:7] op_sel_hi:[1,0] neg_lo:[0,1] neg_hi:[0,1]
    v_pk_fma_f32 v[8:9], v[12:13], v[12:13], v[8:9]
    v_pk_add_f32 v[10:11], v[36:37], v[6:7] op_sel_hi:[1,0] neg_lo:[0,1] neg_hi:[0,1]
    v_pk_fma_f32 v[8:9], v[10:11], v[10:11], v[8:9]
    v_pk_add_f32 v[12:13], v[38:39], v[6:7] op_sel_hi:[1,0] neg_lo:[0,1] neg_hi:[0,1]
    v_pk_fma_f32 v[8:9], v[12:13], v[12:13], v[8:9]
    v_add_f32 v8, v8, v9
    ds_write_b32 v2, v6 offset:0
    ds_write_b32 v2, v8 offset:2560
    s_waitcnt lgkmcnt(0)
    s_barrier
    ds_read_b128 v[40:43], v3 offset:0
    ds_read_b128 v[44:47], v3 offset:16
    ds_read_b128 v[48:51], v3 offset:32
    ds_read_b128 v[52:55], v3 offset:48
    ds_read_b128 v[56:59], v3 offset:2560
    ds_read_b128 v[60:63], v3 offset:2576
    ds_read_b128 v[64:67], v3 offset:2592
    ds_read_b128 v[68:71], v3 offset:2608
    s_waitcnt lgkmcnt(4)
    v_pk_add_f32 v[6:7], v[40:41], v[42:43]
    v_pk_add_f32 v[8:9], v[44:45], v[46:47]
    v_pk_add_f32 v[10:11], v[48:49], v[50:51]
    v_pk_add_f32 v[12:13], v[52:53], v[54:55]
    v_pk_add_f32 v[6:7], v[6:7], v[8:9]
    v_pk_add_f32 v[10:11], v[10:11], v[12:13]
    v_pk_add_f32 v[6:7], v[6:7], v[10:11]
    v_add_f32 v6, v6, v7
    v_mul_f32 v6, 0x3d800000, v6
    v_pk_add_f32 v[10:11], v[40:41], v[6:7] op_sel_hi:[1,0] neg_lo:[0,1] neg_hi:[0,1]
    v_pk_mul_f32 v[8:9], v[10:11], v[10:11]
    v_pk_add_f32 v[12:13], v[42:43], v[6:7] op_sel_hi:[1,0] neg_lo:[0,1] neg_hi:[0,1]
    v_pk_fma_f32 v[8:9], v[12:13], v[12:13], v[8:9]
    v_pk_add_f32 v[10:11], v[44:45], v[6:7] op_sel_hi:[1,0] neg_lo:[0,1] neg_hi:[0,1]
    v_pk_fma_f32 v[8:9], v[10:11], v[10:11], v[8:9]
    v_pk_add_f32 v[12:13], v[46:47], v[6:7] op_sel_hi:[1,0] neg_lo:[0,1] neg_hi:[0,1]
    v_pk_fma_f32 v[8:9], v[12:13], v[12:13], v[8:9]
    v_pk_add_f32 v[10:11], v[48:49], v[6:7] op_sel_hi:[1,0] neg_lo:[0,1] neg_hi:[0,1]
    v_pk_fma_f32 v[8:9], v[10:11], v[10:11], v[8:9]
    v_pk_add_f32 v[12:13], v[50:51], v[6:7] op_sel_hi:[1,0] neg_lo:[0,1] neg_hi:[0,1]
    v_pk_fma_f32 v[8:9], v[12:13], v[12:13], v[8:9]
    v_pk_add_f32 v[10:11], v[52:53], v[6:7] op_sel_hi:[1,0] neg_lo:[0,1] neg_hi:[0,1]
    v_pk_fma_f32 v[8:9], v[10:11], v[10:11], v[8:9]
    v_pk_add_f32 v[12:13], v[54:55], v[6:7] op_sel_hi:[1,0] neg_lo:[0,1] neg_hi:[0,1]
    v_pk_fma_f32 v[8:9], v[12:13], v[12:13], v[8:9]
    v_add_f32 v8, v8, v9
    s_waitcnt lgkmcnt(0)
    v_pk_add_f32 v[40:41], v[56:57], v[58:59]
    v_pk_add_f32 v[42:43], v[60:61], v[62:63]
    v_pk_add_f32 v[44:45], v[64:65], v[66:67]
    v_pk_add_f32 v[46:47], v[68:69], v[70:71]
    v_pk_add_f32 v[40:41], v[40:41], v[42:43]
    v_pk_add_f32 v[44:45], v[44:45], v[46:47]
    v_pk_add_f32 v[40:41], v[40:41], v[44:45]
    v_add_f32 v40, v40, v41
    v_fmac_f32 v40, 0x41800000, v8
    v_mul_f32 v8, 0x3b800000, v40
    v_cvt_pk_bf16_f32 v10, v6, v8
    v_lshlrev_b32 v6, 16, v10
    v_and_b32 v8, 0xffff0000, v10
    v_add_f32 v8, 0x3727c5ac, v8
    v_cvt_pk_bf16_f32 v10, v8, v8
    v_lshlrev_b32 v8, 16, v10
    v_sqrt_f32 v8, v8
    v_pk_add_f32 v[40:41], v[24:25], v[6:7] op_sel_hi:[1,0] neg_lo:[0,1] neg_hi:[0,1]
    v_pk_add_f32 v[42:43], v[26:27], v[6:7] op_sel_hi:[1,0] neg_lo:[0,1] neg_hi:[0,1]
    v_pk_add_f32 v[44:45], v[28:29], v[6:7] op_sel_hi:[1,0] neg_lo:[0,1] neg_hi:[0,1]
    v_pk_add_f32 v[46:47], v[30:31], v[6:7] op_sel_hi:[1,0] neg_lo:[0,1] neg_hi:[0,1]
    v_pk_add_f32 v[48:49], v[32:33], v[6:7] op_sel_hi:[1,0] neg_lo:[0,1] neg_hi:[0,1]
    v_pk_add_f32 v[50:51], v[34:35], v[6:7] op_sel_hi:[1,0] neg_lo:[0,1] neg_hi:[0,1]
    v_pk_add_f32 v[52:53], v[36:37], v[6:7] op_sel_hi:[1,0] neg_lo:[0,1] neg_hi:[0,1]
    v_pk_add_f32 v[54:55], v[38:39], v[6:7] op_sel_hi:[1,0] neg_lo:[0,1] neg_hi:[0,1]
    v_cvt_pk_bf16_f32 v10, v8, v8
    v_lshlrev_b32 v8, 16, v10
    v_rcp_f32 v8, v8
    v_cvt_pk_bf16_f32 v10, v40, v41
    v_lshlrev_b32 v40, 16, v10
    v_and_b32 v41, 0xffff0000, v10
    v_cvt_pk_bf16_f32 v10, v42, v43
    v_lshlrev_b32 v42, 16, v10
    v_and_b32 v43, 0xffff0000, v10
    v_cvt_pk_bf16_f32 v10, v44, v45
    v_lshlrev_b32 v44, 16, v10
    v_and_b32 v45, 0xffff0000, v10
    v_cvt_pk_bf16_f32 v10, v46, v47
    v_lshlrev_b32 v46, 16, v10
    v_and_b32 v47, 0xffff0000, v10
    v_cvt_pk_bf16_f32 v10, v48, v49
    v_lshlrev_b32 v48, 16, v10
    v_and_b32 v49, 0xffff0000, v10
    v_cvt_pk_bf16_f32 v10, v50, v51
    v_lshlrev_b32 v50, 16, v10
    v_and_b32 v51, 0xffff0000, v10
    v_cvt_pk_bf16_f32 v10, v52, v53
    v_lshlrev_b32 v52, 16, v10
    v_and_b32 v53, 0xffff0000, v10
    v_cvt_pk_bf16_f32 v10, v54, v55
    v_lshlrev_b32 v54, 16, v10
    v_and_b32 v55, 0xffff0000, v10
    v_pk_mul_f32 v[40:41], v[40:41], v[8:9] op_sel_hi:[1,0]
    v_pk_mul_f32 v[42:43], v[42:43], v[8:9] op_sel_hi:[1,0]
    v_pk_mul_f32 v[44:45], v[44:45], v[8:9] op_sel_hi:[1,0]
    v_pk_mul_f32 v[46:47], v[46:47], v[8:9] op_sel_hi:[1,0]
    v_pk_mul_f32 v[48:49], v[48:49], v[8:9] op_sel_hi:[1,0]
    v_pk_mul_f32 v[50:51], v[50:51], v[8:9] op_sel_hi:[1,0]
    v_pk_mul_f32 v[52:53], v[52:53], v[8:9] op_sel_hi:[1,0]
    v_pk_mul_f32 v[54:55], v[54:55], v[8:9] op_sel_hi:[1,0]
    v_cvt_pk_bf16_f32 v56, v40, v41
    v_cvt_pk_bf16_f32 v57, v42, v43
    v_cvt_pk_bf16_f32 v58, v44, v45
    v_cvt_pk_bf16_f32 v59, v46, v47
    v_cvt_pk_bf16_f32 v60, v48, v49
    v_cvt_pk_bf16_f32 v61, v50, v51
    v_cvt_pk_bf16_f32 v62, v52, v53
    v_cvt_pk_bf16_f32 v63, v54, v55
    ds_write_b128 v4, v[56:59] offset:0
    ds_write_b128 v4, v[60:63] offset:1024
    s_waitcnt lgkmcnt(0)
    s_barrier
    ds_read_b128 v[72:75], v5 offset:0
    ds_read_b128 v[76:79], v5 offset:1024
    ds_read_b128 v[80:83], v5 offset:2048
    ds_read_b128 v[84:87], v5 offset:3072
    ds_read_b128 v[88:91], v5 offset:4096
    ds_read_b128 v[92:95], v5 offset:5120
    ds_read_b128 v[96:99], v5 offset:6144
    ds_read_b128 v[100:103], v5 offset:7168
    ds_read_b128 v[104:107], v5 offset:8192
    ds_read_b128 v[108:111], v5 offset:9216
    ds_read_b128 v[112:115], v5 offset:10240
    ds_read_b128 v[116:119], v5 offset:11264
    ds_read_b128 v[120:123], v5 offset:12288
    ds_read_b128 v[124:127], v5 offset:13312
    ds_read_b128 v[128:131], v5 offset:14336
    ds_read_b128 v[132:135], v5 offset:15360
    s_waitcnt lgkmcnt(0)
    s_waitcnt vmcnt(20)
    v_mfma_f32_32x32x16_bf16 v[136:151], v[172:175], v[72:75], 0
    buffer_load_dwordx4 v[172:175], v1, s[12:15], s17 offen offset:1024
    s_waitcnt vmcnt(20)
    v_mfma_f32_32x32x16_bf16 v[136:151], v[176:179], v[76:79], v[136:151]
    buffer_load_dwordx4 v[176:179], v1, s[12:15], s17 offen offset:2048
    s_waitcnt vmcnt(20)
    v_mfma_f32_32x32x16_bf16 v[136:151], v[180:183], v[80:83], v[136:151]
    buffer_load_dwordx4 v[180:183], v1, s[12:15], s17 offen offset:3072
    s_add_u32 s17, s17, 4096
    s_waitcnt vmcnt(20)
    v_mfma_f32_32x32x16_bf16 v[136:151], v[184:187], v[84:87], v[136:151]
    buffer_load_dwordx4 v[184:187], v1, s[12:15], s17 offen offset:0
    s_waitcnt vmcnt(20)
    v_mfma_f32_32x32x16_bf16 v[136:151], v[188:191], v[88:91], v[136:151]
    buffer_load_dwordx4 v[188:191], v1, s[12:15], s17 offen offset:1024
    s_waitcnt vmcnt(20)
    v_mfma_f32_32x32x16_bf16 v[136:151], v[192:195], v[92:95], v[136:151]
    buffer_load_dwordx4 v[192:195], v1, s[12:15], s17 offen offset:2048
    s_waitcnt vmcnt(20)
    v_mfma_f32_32x32x16_bf16 v[136:151], v[196:199], v[96:99], v[136:151]
    buffer_load_dwordx4 v[196:199], v1, s[12:15], s17 offen offset:3072
    s_add_u32 s17, s17, 4096
    s_waitcnt vmcnt(20)
    v_mfma_f32_32x32x16_bf16 v[136:151], v[200:203], v[100:103], v[136:151]
    buffer_load_dwordx4 v[200:203], v1, s[12:15], s17 offen offset:0
    s_waitcnt vmcnt(20)
    v_mfma_f32_32x32x16_bf16 v[136:151], v[204:207], v[104:107], v[136:151]
    buffer_load_dwordx4 v[204:207], v1, s[12:15], s17 offen offset:1024
    s_waitcnt vmcnt(20)
    v_mfma_f32_32x32x16_bf16 v[136:151], v[208:211], v[108:111], v[136:151]
    buffer_load_dwordx4 v[208:211], v1, s[12:15], s17 offen offset:2048
    s_waitcnt vmcnt(20)
    v_mfma_f32_32x32x16_bf16 v[136:151], v[212:215], v[112:115], v[136:151]
    buffer_load_dwordx4 v[212:215], v1, s[12:15], s17 offen offset:3072
    s_add_u32 s17, s17, 4096
    s_waitcnt vmcnt(20)
    v_mfma_f32_32x32x16_bf16 v[136:151], v[216:219], v[116:119], v[136:151]
    buffer_load_dwordx4 v[216:219], v1, s[12:15], s17 offen offset:0
    s_waitcnt vmcnt(20)
    v_mfma_f32_32x32x16_bf16 v[136:151], v[220:223], v[120:123], v[136:151]
    buffer_load_dwordx4 v[220:223], v1, s[12:15], s17 offen offset:1024
    s_waitcnt vmcnt(20)
    v_mfma_f32_32x32x16_bf16 v[136:151], v[224:227], v[124:127], v[136:151]
    buffer_load_dwordx4 v[224:227], v1, s[12:15], s17 offen offset:2048
    s_waitcnt vmcnt(20)
    v_mfma_f32_32x32x16_bf16 v[136:151], v[228:231], v[128:131], v[136:151]
    buffer_load_dwordx4 v[228:231], v1, s[12:15], s17 offen offset:3072
    s_add_u32 s17, s17, 4096
    s_waitcnt vmcnt(20)
    v_mfma_f32_32x32x16_bf16 v[136:151], v[232:235], v[132:135], v[136:151]
    buffer_load_dwordx4 v[232:235], v1, s[12:15], s17 offen offset:0
    s_waitcnt vmcnt(20)
    v_mfma_f32_32x32x16_bf16 v[152:167], v[236:239], v[72:75], 0
    buffer_load_dwordx4 v[236:239], v1, s[12:15], s17 offen offset:1024
    s_nop 7
    v_cvt_pk_bf16_f32 v6, v136, v137
    v_lshlrev_b32 v136, 16, v6
    v_and_b32 v137, 0xffff0000, v6
    v_mul_f32 v7, 0xbfb8aa3b, v136
    v_mul_f32 v8, 0xbfb8aa3b, v137
    v_exp_f32 v7, v7
    v_exp_f32 v8, v8
    v_add_f32 v7, 1.0, v7
    s_waitcnt vmcnt(20)
    v_mfma_f32_32x32x16_bf16 v[152:167], v[240:243], v[76:79], v[152:167]
    buffer_load_dwordx4 v[240:243], v1, s[12:15], s17 offen offset:2048
    v_add_f32 v8, 1.0, v8
    v_rcp_f32 v7, v7
    v_rcp_f32 v8, v8
    v_mul_f32 v136, v136, v7
    v_mul_f32 v137, v137, v8
    v_cvt_pk_bf16_f32 v40, v136, v137
    v_cvt_pk_bf16_f32 v6, v138, v139
    v_lshlrev_b32 v138, 16, v6
    s_waitcnt vmcnt(20)
    v_mfma_f32_32x32x16_bf16 v[152:167], v[244:247], v[80:83], v[152:167]
    buffer_load_dwordx4 v[244:247], v1, s[12:15], s17 offen offset:3072
    s_add_u32 s17, s17, 4096
    v_and_b32 v139, 0xffff0000, v6
    v_mul_f32 v9, 0xbfb8aa3b, v138
    v_mul_f32 v10, 0xbfb8aa3b, v139
    v_exp_f32 v9, v9
    v_exp_f32 v10, v10
    v_add_f32 v9, 1.0, v9
    v_add_f32 v10, 1.0, v10
    v_rcp_f32 v9, v9
    s_waitcnt vmcnt(20)
    v_mfma_f32_32x32x16_bf16 v[152:167], v[248:251], v[84:87], v[152:167]
    buffer_load_dwordx4 v[248:251], v1, s[12:15], s17 offen offset:0
    v_rcp_f32 v10, v10
    v_mul_f32 v138, v138, v9
    v_mul_f32 v139, v139, v10
    v_cvt_pk_bf16_f32 v41, v138, v139
    v_cvt_pk_bf16_f32 v6, v140, v141
    v_lshlrev_b32 v140, 16, v6
    v_and_b32 v141, 0xffff0000, v6
    v_mul_f32 v7, 0xbfb8aa3b, v140
    s_waitcnt vmcnt(20)
    v_mfma_f32_32x32x16_bf16 v[152:167], v[168:171], v[88:91], v[152:167]
    buffer_load_dwordx4 v[168:171], v1, s[12:15], s17 offen offset:1024
    v_mul_f32 v8, 0xbfb8aa3b, v141
    v_exp_f32 v7, v7
    v_exp_f32 v8, v8
    v_add_f32 v7, 1.0, v7
    v_add_f32 v8, 1.0, v8
    v_rcp_f32 v7, v7
    v_rcp_f32 v8, v8
    v_mul_f32 v140, v140, v7
    s_waitcnt vmcnt(20)
    v_mfma_f32_32x32x16_bf16 v[152:167], v[172:175], v[92:95], v[152:167]
    buffer_load_dwordx4 v[172:175], v1, s[12:15], s17 offen offset:2048
    v_mul_f32 v141, v141, v8
    v_cvt_pk_bf16_f32 v42, v140, v141
    v_cvt_pk_bf16_f32 v6, v142, v143
    v_lshlrev_b32 v142, 16, v6
    v_and_b32 v143, 0xffff0000, v6
    v_mul_f32 v9, 0xbfb8aa3b, v142
    v_mul_f32 v10, 0xbfb8aa3b, v143
    v_exp_f32 v9, v9
    s_waitcnt vmcnt(20)
    v_mfma_f32_32x32x16_bf16 v[152:167], v[176:179], v[96:99], v[152:167]
    buffer_load_dwordx4 v[176:179], v1, s[12:15], s17 offen offset:3072
    s_add_u32 s17, s17, 4096
    v_exp_f32 v10, v10
    v_add_f32 v9, 1.0, v9
    v_add_f32 v10, 1.0, v10
    v_rcp_f32 v9, v9
    v_rcp_f32 v10, v10
    v_mul_f32 v142, v142, v9
    v_mul_f32 v143, v143, v10
    v_cvt_pk_bf16_f32 v43, v142, v143
    s_waitcnt vmcnt(20)
    v_mfma_f32_32x32x16_bf16 v[152:167], v[180:183], v[100:103], v[152:167]
    buffer_load_dwordx4 v[180:183], v1, s[12:15], s17 offen offset:0
    v_cvt_pk_bf16_f32 v6, v144, v145
    v_lshlrev_b32 v144, 16, v6
    v_and_b32 v145, 0xffff0000, v6
    v_mul_f32 v7, 0xbfb8aa3b, v144
    v_mul_f32 v8, 0xbfb8aa3b, v145
    v_exp_f32 v7, v7
    v_exp_f32 v8, v8
    v_add_f32 v7, 1.0, v7
    s_waitcnt vmcnt(20)
    v_mfma_f32_32x32x16_bf16 v[152:167], v[184:187], v[104:107], v[152:167]
    buffer_load_dwordx4 v[184:187], v1, s[12:15], s17 offen offset:1024
    v_add_f32 v8, 1.0, v8
    v_rcp_f32 v7, v7
    v_rcp_f32 v8, v8
    v_mul_f32 v144, v144, v7
    v_mul_f32 v145, v145, v8
    v_cvt_pk_bf16_f32 v44, v144, v145
    v_cvt_pk_bf16_f32 v6, v146, v147
    v_lshlrev_b32 v146, 16, v6
    s_waitcnt vmcnt(20)
    v_mfma_f32_32x32x16_bf16 v[152:167], v[188:191], v[108:111], v[152:167]
    buffer_load_dwordx4 v[188:191], v1, s[12:15], s17 offen offset:2048
    v_and_b32 v147, 0xffff0000, v6
    v_mul_f32 v9, 0xbfb8aa3b, v146
    v_mul_f32 v10, 0xbfb8aa3b, v147
    v_exp_f32 v9, v9
    v_exp_f32 v10, v10
    v_add_f32 v9, 1.0, v9
    v_add_f32 v10, 1.0, v10
    v_rcp_f32 v9, v9
    s_waitcnt vmcnt(20)
    v_mfma_f32_32x32x16_bf16 v[152:167], v[192:195], v[112:115], v[152:167]
    buffer_load_dwordx4 v[192:195], v1, s[12:15], s17 offen offset:3072
    s_add_u32 s17, s17, 4096
    v_rcp_f32 v10, v10
    v_mul_f32 v146, v146, v9
    v_mul_f32 v147, v147, v10
    v_cvt_pk_bf16_f32 v45, v146, v147
    v_cvt_pk_bf16_f32 v6, v148, v149
    v_lshlrev_b32 v148, 16, v6
    v_and_b32 v149, 0xffff0000, v6
    v_mul_f32 v7, 0xbfb8aa3b, v148
    s_waitcnt vmcnt(20)
    v_mfma_f32_32x32x16_bf16 v[152:167], v[196:199], v[116:119], v[152:167]
    buffer_load_dwordx4 v[196:199], v1, s[12:15], s17 offen offset:0
    v_mul_f32 v8, 0xbfb8aa3b, v149
    v_exp_f32 v7, v7
    v_exp_f32 v8, v8
    v_add_f32 v7, 1.0, v7
    v_add_f32 v8, 1.0, v8
    v_rcp_f32 v7, v7
    v_rcp_f32 v8, v8
    v_mul_f32 v148, v148, v7
    s_waitcnt vmcnt(20)
    v_mfma_f32_32x32x16_bf16 v[152:167], v[200:203], v[120:123], v[152:167]
    buffer_load_dwordx4 v[200:203], v1, s[12:15], s17 offen offset:1024
    v_mul_f32 v149, v149, v8
    v_cvt_pk_bf16_f32 v46, v148, v149
    v_cvt_pk_bf16_f32 v6, v150, v151
    v_lshlrev_b32 v150, 16, v6
    v_and_b32 v151, 0xffff0000, v6
    v_mul_f32 v9, 0xbfb8aa3b, v150
    v_mul_f32 v10, 0xbfb8aa3b, v151
    v_exp_f32 v9, v9
    s_waitcnt vmcnt(20)
    v_mfma_f32_32x32x16_bf16 v[152:167], v[204:207], v[124:127], v[152:167]
    buffer_load_dwordx4 v[204:207], v1, s[12:15], s17 offen offset:2048
    v_exp_f32 v10, v10
    v_add_f32 v9, 1.0, v9
    v_add_f32 v10, 1.0, v10
    v_rcp_f32 v9, v9
    v_rcp_f32 v10, v10
    v_mul_f32 v150, v150, v9
    v_mul_f32 v151, v151, v10
    v_cvt_pk_bf16_f32 v47, v150, v151
    s_waitcnt vmcnt(20)
    v_mfma_f32_32x32x16_bf16 v[152:167], v[208:211], v[128:131], v[152:167]
    buffer_load_dwordx4 v[208:211], v1, s[12:15], s17 offen offset:3072
    s_add_u32 s17, s17, 4096
    ds_write_b128 v0, v[40:43] offset:0
    ds_write_b128 v0, v[44:47] offset:1024
    s_waitcnt vmcnt(20)
    v_mfma_f32_32x32x16_bf16 v[152:167], v[212:215], v[132:135], v[152:167]
    buffer_load_dwordx4 v[212:215], v1, s[12:15], s17 offen offset:0
    s_waitcnt vmcnt(20)
    v_mfma_f32_32x32x16_bf16 v[136:151], v[216:219], v[72:75], 0
    buffer_load_dwordx4 v[216:219], v1, s[12:15], s17 offen offset:1024
    s_nop 7
    v_cvt_pk_bf16_f32 v11, v152, v153
    v_lshlrev_b32 v152, 16, v11
    v_and_b32 v153, 0xffff0000, v11
    v_mul_f32 v12, 0xbfb8aa3b, v152
    v_mul_f32 v13, 0xbfb8aa3b, v153
    v_exp_f32 v12, v12
    v_exp_f32 v13, v13
    v_add_f32 v12, 1.0, v12
    s_waitcnt vmcnt(20)
    v_mfma_f32_32x32x16_bf16 v[136:151], v[220:223], v[76:79], v[136:151]
    buffer_load_dwordx4 v[220:223], v1, s[12:15], s17 offen offset:2048
    v_add_f32 v13, 1.0, v13
    v_rcp_f32 v12, v12
    v_rcp_f32 v13, v13
    v_mul_f32 v152, v152, v12
    v_mul_f32 v153, v153, v13
    v_cvt_pk_bf16_f32 v56, v152, v153
    v_cvt_pk_bf16_f32 v11, v154, v155
    v_lshlrev_b32 v154, 16, v11
    s_waitcnt vmcnt(20)
    v_mfma_f32_32x32x16_bf16 v[136:151], v[224:227], v[80:83], v[136:151]
    buffer_load_dwordx4 v[224:227], v1, s[12:15], s17 offen offset:3072
    s_add_u32 s17, s17, 4096
    v_and_b32 v155, 0xffff0000, v11
    v_mul_f32 v14, 0xbfb8aa3b, v154
    v_mul_f32 v15, 0xbfb8aa3b, v155
    v_exp_f32 v14, v14
    v_exp_f32 v15, v15
    v_add_f32 v14, 1.0, v14
    v_add_f32 v15, 1.0, v15
    v_rcp_f32 v14, v14
    s_waitcnt vmcnt(20)
    v_mfma_f32_32x32x16_bf16 v[136:151], v[228:231], v[84:87], v[136:151]
    buffer_load_dwordx4 v[228:231], v1, s[12:15], s17 offen offset:0
    v_rcp_f32 v15, v15
    v_mul_f32 v154, v154, v14
    v_mul_f32 v155, v155, v15
    v_cvt_pk_bf16_f32 v57, v154, v155
    v_cvt_pk_bf16_f32 v11, v156, v157
    v_lshlrev_b32 v156, 16, v11
    v_and_b32 v157, 0xffff0000, v11
    v_mul_f32 v12, 0xbfb8aa3b, v156
    s_waitcnt vmcnt(20)
    v_mfma_f32_32x32x16_bf16 v[136:151], v[232:235], v[88:91], v[136:151]
    buffer_load_dwordx4 v[232:235], v1, s[12:15], s17 offen offset:1024
    v_mul_f32 v13, 0xbfb8aa3b, v157
    v_exp_f32 v12, v12
    v_exp_f32 v13, v13
    v_add_f32 v12, 1.0, v12
    v_add_f32 v13, 1.0, v13
    v_rcp_f32 v12, v12
    v_rcp_f32 v13, v13
    v_mul_f32 v156, v156, v12
    s_waitcnt vmcnt(20)
    v_mfma_f32_32x32x16_bf16 v[136:151], v[236:239], v[92:95], v[136:151]
    buffer_load_dwordx4 v[236:239], v1, s[12:15], s17 offen offset:2048
    v_mul_f32 v157, v157, v13
    v_cvt_pk_bf16_f32 v58, v156, v157
    v_cvt_pk_bf16_f32 v11, v158, v159
    v_lshlrev_b32 v158, 16, v11
    v_and_b32 v159, 0xffff0000, v11
    v_mul_f32 v14, 0xbfb8aa3b, v158
    v_mul_f32 v15, 0xbfb8aa3b, v159
    v_exp_f32 v14, v14
    s_waitcnt vmcnt(20)
    v_mfma_f32_32x32x16_bf16 v[136:151], v[240:243], v[96:99], v[136:151]
    buffer_load_dwordx4 v[240:243], v1, s[12:15], s17 offen offset:3072
    s_add_u32 s17, s17, 4096
    v_exp_f32 v15, v15
    v_add_f32 v14, 1.0, v14
    v_add_f32 v15, 1.0, v15
    v_rcp_f32 v14, v14
    v_rcp_f32 v15, v15
    v_mul_f32 v158, v158, v14
    v_mul_f32 v159, v159, v15
    v_cvt_pk_bf16_f32 v59, v158, v159
    s_waitcnt vmcnt(20)
    v_mfma_f32_32x32x16_bf16 v[136:151], v[244:247], v[100:103], v[136:151]
    buffer_load_dwordx4 v[244:247], v1, s[12:15], s17 offen offset:0
    v_cvt_pk_bf16_f32 v11, v160, v161
    v_lshlrev_b32 v160, 16, v11
    v_and_b32 v161, 0xffff0000, v11
    v_mul_f32 v12, 0xbfb8aa3b, v160
    v_mul_f32 v13, 0xbfb8aa3b, v161
    v_exp_f32 v12, v12
    v_exp_f32 v13, v13
    v_add_f32 v12, 1.0, v12
    s_waitcnt vmcnt(20)
    v_mfma_f32_32x32x16_bf16 v[136:151], v[248:251], v[104:107], v[136:151]
    buffer_load_dwordx4 v[248:251], v1, s[12:15], s17 offen offset:1024
    v_add_f32 v13, 1.0, v13
    v_rcp_f32 v12, v12
    v_rcp_f32 v13, v13
    v_mul_f32 v160, v160, v12
    v_mul_f32 v161, v161, v13
    v_cvt_pk_bf16_f32 v60, v160, v161
    v_cvt_pk_bf16_f32 v11, v162, v163
    v_lshlrev_b32 v162, 16, v11
    s_waitcnt vmcnt(20)
    v_mfma_f32_32x32x16_bf16 v[136:151], v[168:171], v[108:111], v[136:151]
    buffer_load_dwordx4 v[168:171], v1, s[12:15], s17 offen offset:2048
    v_and_b32 v163, 0xffff0000, v11
    v_mul_f32 v14, 0xbfb8aa3b, v162
    v_mul_f32 v15, 0xbfb8aa3b, v163
    v_exp_f32 v14, v14
    v_exp_f32 v15, v15
    v_add_f32 v14, 1.0, v14
    v_add_f32 v15, 1.0, v15
    v_rcp_f32 v14, v14
    s_waitcnt vmcnt(20)
    v_mfma_f32_32x32x16_bf16 v[136:151], v[172:175], v[112:115], v[136:151]
    buffer_load_dwordx4 v[172:175], v1, s[12:15], s17 offen offset:3072
    s_add_u32 s17, s17, 4096
    v_rcp_f32 v15, v15
    v_mul_f32 v162, v162, v14
    v_mul_f32 v163, v163, v15
    v_cvt_pk_bf16_f32 v61, v162, v163
    v_cvt_pk_bf16_f32 v11, v164, v165
    v_lshlrev_b32 v164, 16, v11
    v_and_b32 v165, 0xffff0000, v11
    v_mul_f32 v12, 0xbfb8aa3b, v164
    s_waitcnt vmcnt(20)
    v_mfma_f32_32x32x16_bf16 v[136:151], v[176:179], v[116:119], v[136:151]
    buffer_load_dwordx4 v[176:179], v1, s[12:15], s17 offen offset:0
    v_mul_f32 v13, 0xbfb8aa3b, v165
    v_exp_f32 v12, v12
    v_exp_f32 v13, v13
    v_add_f32 v12, 1.0, v12
    v_add_f32 v13, 1.0, v13
    v_rcp_f32 v12, v12
    v_rcp_f32 v13, v13
    v_mul_f32 v164, v164, v12
    s_waitcnt vmcnt(20)
    v_mfma_f32_32x32x16_bf16 v[136:151], v[180:183], v[120:123], v[136:151]
    buffer_load_dwordx4 v[180:183], v1, s[12:15], s17 offen offset:1024
    v_mul_f32 v165, v165, v13
    v_cvt_pk_bf16_f32 v62, v164, v165
    v_cvt_pk_bf16_f32 v11, v166, v167
    v_lshlrev_b32 v166, 16, v11
    v_and_b32 v167, 0xffff0000, v11
    v_mul_f32 v14, 0xbfb8aa3b, v166
    v_mul_f32 v15, 0xbfb8aa3b, v167
    v_exp_f32 v14, v14
    s_waitcnt vmcnt(20)
    v_mfma_f32_32x32x16_bf16 v[136:151], v[184:187], v[124:127], v[136:151]
    buffer_load_dwordx4 v[184:187], v1, s[12:15], s17 offen offset:2048
    v_exp_f32 v15, v15
    v_add_f32 v14, 1.0, v14
    v_add_f32 v15, 1.0, v15
    v_rcp_f32 v14, v14
    v_rcp_f32 v15, v15
    v_mul_f32 v166, v166, v14
    v_mul_f32 v167, v167, v15
    v_cvt_pk_bf16_f32 v63, v166, v167
    s_waitcnt vmcnt(20)
    v_mfma_f32_32x32x16_bf16 v[136:151], v[188:191], v[128:131], v[136:151]
    buffer_load_dwordx4 v[188:191], v1, s[12:15], s17 offen offset:3072
    s_add_u32 s17, s17, 4096
    ds_write_b128 v0, v[56:59] offset:2048
    ds_write_b128 v0, v[60:63] offset:3072
    s_waitcnt vmcnt(20)
    v_mfma_f32_32x32x16_bf16 v[136:151], v[192:195], v[132:135], v[136:151]
    buffer_load_dwordx4 v[192:195], v1, s[12:15], s17 offen offset:0
    s_waitcnt vmcnt(20)
    v_mfma_f32_32x32x16_bf16 v[152:167], v[196:199], v[72:75], 0
    buffer_load_dwordx4 v[196:199], v1, s[12:15], s17 offen offset:1024
    s_nop 7
    v_cvt_pk_bf16_f32 v6, v136, v137
    v_lshlrev_b32 v136, 16, v6
    v_and_b32 v137, 0xffff0000, v6
    v_mul_f32 v7, 0xbfb8aa3b, v136
    v_mul_f32 v8, 0xbfb8aa3b, v137
    v_exp_f32 v7, v7
    v_exp_f32 v8, v8
    v_add_f32 v7, 1.0, v7
    s_waitcnt vmcnt(20)
    v_mfma_f32_32x32x16_bf16 v[152:167], v[200:203], v[76:79], v[152:167]
    buffer_load_dwordx4 v[200:203], v1, s[12:15], s17 offen offset:2048
    v_add_f32 v8, 1.0, v8
    v_rcp_f32 v7, v7
    v_rcp_f32 v8, v8
    v_mul_f32 v136, v136, v7
    v_mul_f32 v137, v137, v8
    v_cvt_pk_bf16_f32 v40, v136, v137
    v_cvt_pk_bf16_f32 v6, v138, v139
    v_lshlrev_b32 v138, 16, v6
    s_waitcnt vmcnt(20)
    v_mfma_f32_32x32x16_bf16 v[152:167], v[204:207], v[80:83], v[152:167]
    buffer_load_dwordx4 v[204:207], v1, s[12:15], s17 offen offset:3072
    s_add_u32 s17, s17, 4096
    v_and_b32 v139, 0xffff0000, v6
    v_mul_f32 v9, 0xbfb8aa3b, v138
    v_mul_f32 v10, 0xbfb8aa3b, v139
    v_exp_f32 v9, v9
    v_exp_f32 v10, v10
    v_add_f32 v9, 1.0, v9
    v_add_f32 v10, 1.0, v10
    v_rcp_f32 v9, v9
    s_waitcnt vmcnt(20)
    v_mfma_f32_32x32x16_bf16 v[152:167], v[208:211], v[84:87], v[152:167]
    buffer_load_dwordx4 v[208:211], v1, s[12:15], s17 offen offset:0
    v_rcp_f32 v10, v10
    v_mul_f32 v138, v138, v9
    v_mul_f32 v139, v139, v10
    v_cvt_pk_bf16_f32 v41, v138, v139
    v_cvt_pk_bf16_f32 v6, v140, v141
    v_lshlrev_b32 v140, 16, v6
    v_and_b32 v141, 0xffff0000, v6
    v_mul_f32 v7, 0xbfb8aa3b, v140
    s_waitcnt vmcnt(20)
    v_mfma_f32_32x32x16_bf16 v[152:167], v[212:215], v[88:91], v[152:167]
    buffer_load_dwordx4 v[212:215], v1, s[12:15], s17 offen offset:1024
    v_mul_f32 v8, 0xbfb8aa3b, v141
    v_exp_f32 v7, v7
    v_exp_f32 v8, v8
    v_add_f32 v7, 1.0, v7
    v_add_f32 v8, 1.0, v8
    v_rcp_f32 v7, v7
    v_rcp_f32 v8, v8
    v_mul_f32 v140, v140, v7
    s_waitcnt vmcnt(20)
    v_mfma_f32_32x32x16_bf16 v[152:167], v[216:219], v[92:95], v[152:167]
    buffer_load_dwordx4 v[216:219], v1, s[12:15], s17 offen offset:2048
    v_mul_f32 v141, v141, v8
    v_cvt_pk_bf16_f32 v42, v140, v141
    v_cvt_pk_bf16_f32 v6, v142, v143
    v_lshlrev_b32 v142, 16, v6
    v_and_b32 v143, 0xffff0000, v6
    v_mul_f32 v9, 0xbfb8aa3b, v142
    v_mul_f32 v10, 0xbfb8aa3b, v143
    v_exp_f32 v9, v9
    s_waitcnt vmcnt(20)
    v_mfma_f32_32x32x16_bf16 v[152:167], v[220:223], v[96:99], v[152:167]
    buffer_load_dwordx4 v[220:223], v1, s[12:15], s17 offen offset:3072
    s_add_u32 s17, s17, 4096
    v_exp_f32 v10, v10
    v_add_f32 v9, 1.0, v9
    v_add_f32 v10, 1.0, v10
    v_rcp_f32 v9, v9
    v_rcp_f32 v10, v10
    v_mul_f32 v142, v142, v9
    v_mul_f32 v143, v143, v10
    v_cvt_pk_bf16_f32 v43, v142, v143
    s_waitcnt vmcnt(20)
    v_mfma_f32_32x32x16_bf16 v[152:167], v[224:227], v[100:103], v[152:167]
    buffer_load_dwordx4 v[224:227], v1, s[12:15], s17 offen offset:0
    v_cvt_pk_bf16_f32 v6, v144, v145
    v_lshlrev_b32 v144, 16, v6
    v_and_b32 v145, 0xffff0000, v6
    v_mul_f32 v7, 0xbfb8aa3b, v144
    v_mul_f32 v8, 0xbfb8aa3b, v145
    v_exp_f32 v7, v7
    v_exp_f32 v8, v8
    v_add_f32 v7, 1.0, v7
    s_waitcnt vmcnt(20)
    v_mfma_f32_32x32x16_bf16 v[152:167], v[228:231], v[104:107], v[152:167]
    buffer_load_dwordx4 v[228:231], v1, s[12:15], s17 offen offset:1024
    v_add_f32 v8, 1.0, v8
    v_rcp_f32 v7, v7
    v_rcp_f32 v8, v8
    v_mul_f32 v144, v144, v7
    v_mul_f32 v145, v145, v8
    v_cvt_pk_bf16_f32 v44, v144, v145
    v_cvt_pk_bf16_f32 v6, v146, v147
    v_lshlrev_b32 v146, 16, v6
    s_waitcnt vmcnt(20)
    v_mfma_f32_32x32x16_bf16 v[152:167], v[232:235], v[108:111], v[152:167]
    buffer_load_dwordx4 v[232:235], v1, s[12:15], s17 offen offset:2048
    v_and_b32 v147, 0xffff0000, v6
    v_mul_f32 v9, 0xbfb8aa3b, v146
    v_mul_f32 v10, 0xbfb8aa3b, v147
    v_exp_f32 v9, v9
    v_exp_f32 v10, v10
    v_add_f32 v9, 1.0, v9
    v_add_f32 v10, 1.0, v10
    v_rcp_f32 v9, v9
    s_waitcnt vmcnt(20)
    v_mfma_f32_32x32x16_bf16 v[152:167], v[236:239], v[112:115], v[152:167]
    buffer_load_dwordx4 v[236:239], v1, s[12:15], s17 offen offset:3072
    s_add_u32 s17, s17, 4096
    v_rcp_f32 v10, v10
    v_mul_f32 v146, v146, v9
    v_mul_f32 v147, v147, v10
    v_cvt_pk_bf16_f32 v45, v146, v147
    v_cvt_pk_bf16_f32 v6, v148, v149
    v_lshlrev_b32 v148, 16, v6
    v_and_b32 v149, 0xffff0000, v6
    v_mul_f32 v7, 0xbfb8aa3b, v148
    s_waitcnt vmcnt(20)
    v_mfma_f32_32x32x16_bf16 v[152:167], v[240:243], v[116:119], v[152:167]
    buffer_load_dwordx4 v[240:243], v1, s[12:15], s17 offen offset:0
    v_mul_f32 v8, 0xbfb8aa3b, v149
    v_exp_f32 v7, v7
    v_exp_f32 v8, v8
    v_add_f32 v7, 1.0, v7
    v_add_f32 v8, 1.0, v8
    v_rcp_f32 v7, v7
    v_rcp_f32 v8, v8
    v_mul_f32 v148, v148, v7
    s_waitcnt vmcnt(20)
    v_mfma_f32_32x32x16_bf16 v[152:167], v[244:247], v[120:123], v[152:167]
    buffer_load_dwordx4 v[244:247], v1, s[12:15], s17 offen offset:1024
    v_mul_f32 v149, v149, v8
    v_cvt_pk_bf16_f32 v46, v148, v149
    v_cvt_pk_bf16_f32 v6, v150, v151
    v_lshlrev_b32 v150, 16, v6
    v_and_b32 v151, 0xffff0000, v6
    v_mul_f32 v9, 0xbfb8aa3b, v150
    v_mul_f32 v10, 0xbfb8aa3b, v151
    v_exp_f32 v9, v9
    s_waitcnt vmcnt(20)
    v_mfma_f32_32x32x16_bf16 v[152:167], v[248:251], v[124:127], v[152:167]
    buffer_load_dwordx4 v[248:251], v1, s[12:15], s17 offen offset:2048
    v_exp_f32 v10, v10
    v_add_f32 v9, 1.0, v9
    v_add_f32 v10, 1.0, v10
    v_rcp_f32 v9, v9
    v_rcp_f32 v10, v10
    v_mul_f32 v150, v150, v9
    v_mul_f32 v151, v151, v10
    v_cvt_pk_bf16_f32 v47, v150, v151
    s_waitcnt vmcnt(20)
    v_mfma_f32_32x32x16_bf16 v[152:167], v[168:171], v[128:131], v[152:167]
    buffer_load_dwordx4 v[168:171], v1, s[12:15], s17 offen offset:3072
    s_add_u32 s17, s17, 4096
    ds_write_b128 v0, v[40:43] offset:4096
    ds_write_b128 v0, v[44:47] offset:5120
    s_waitcnt vmcnt(20)
    v_mfma_f32_32x32x16_bf16 v[152:167], v[172:175], v[132:135], v[152:167]
    buffer_load_dwordx4 v[172:175], v1, s[12:15], s17 offen offset:0
    s_nop 10
    v_cvt_pk_bf16_f32 v11, v152, v153
    v_lshlrev_b32 v152, 16, v11
    v_and_b32 v153, 0xffff0000, v11
    v_mul_f32 v12, 0xbfb8aa3b, v152
    v_mul_f32 v13, 0xbfb8aa3b, v153
    v_exp_f32 v12, v12
    v_exp_f32 v13, v13
    v_add_f32 v12, 1.0, v12
    v_add_f32 v13, 1.0, v13
    v_rcp_f32 v12, v12
    v_rcp_f32 v13, v13
    v_mul_f32 v152, v152, v12
    v_mul_f32 v153, v153, v13
    v_cvt_pk_bf16_f32 v56, v152, v153
    v_cvt_pk_bf16_f32 v11, v154, v155
    v_lshlrev_b32 v154, 16, v11
    v_and_b32 v155, 0xffff0000, v11
    v_mul_f32 v14, 0xbfb8aa3b, v154
    v_mul_f32 v15, 0xbfb8aa3b, v155
    v_exp_f32 v14, v14
    v_exp_f32 v15, v15
    v_add_f32 v14, 1.0, v14
    v_add_f32 v15, 1.0, v15
    v_rcp_f32 v14, v14
    v_rcp_f32 v15, v15
    v_mul_f32 v154, v154, v14
    v_mul_f32 v155, v155, v15
    v_cvt_pk_bf16_f32 v57, v154, v155
    v_cvt_pk_bf16_f32 v11, v156, v157
    v_lshlrev_b32 v156, 16, v11
    v_and_b32 v157, 0xffff0000, v11
    v_mul_f32 v12, 0xbfb8aa3b, v156
    v_mul_f32 v13, 0xbfb8aa3b, v157
    v_exp_f32 v12, v12
    v_exp_f32 v13, v13
    v_add_f32 v12, 1.0, v12
    v_add_f32 v13, 1.0, v13
    v_rcp_f32 v12, v12
    v_rcp_f32 v13, v13
    v_mul_f32 v156, v156, v12
    v_mul_f32 v157, v157, v13
    v_cvt_pk_bf16_f32 v58, v156, v157
    v_cvt_pk_bf16_f32 v11, v158, v159
    v_lshlrev_b32 v158, 16, v11
    v_and_b32 v159, 0xffff0000, v11
    v_mul_f32 v14, 0xbfb8aa3b, v158
    v_mul_f32 v15, 0xbfb8aa3b, v159
    v_exp_f32 v14, v14
    v_exp_f32 v15, v15
    v_add_f32 v14, 1.0, v14
    v_add_f32 v15, 1.0, v15
    v_rcp_f32 v14, v14
    v_rcp_f32 v15, v15
    v_mul_f32 v158, v158, v14
    v_mul_f32 v159, v159, v15
    v_cvt_pk_bf16_f32 v59, v158, v159
    v_cvt_pk_bf16_f32 v11, v160, v161
    v_lshlrev_b32 v160, 16, v11
    v_and_b32 v161, 0xffff0000, v11
    v_mul_f32 v12, 0xbfb8aa3b, v160
    v_mul_f32 v13, 0xbfb8aa3b, v161
    v_exp_f32 v12, v12
    v_exp_f32 v13, v13
    v_add_f32 v12, 1.0, v12
    v_add_f32 v13, 1.0, v13
    v_rcp_f32 v12, v12
    v_rcp_f32 v13, v13
    v_mul_f32 v160, v160, v12
    v_mul_f32 v161, v161, v13
    v_cvt_pk_bf16_f32 v60, v160, v161
    v_cvt_pk_bf16_f32 v11, v162, v163
    v_lshlrev_b32 v162, 16, v11
    v_and_b32 v163, 0xffff0000, v11
    v_mul_f32 v14, 0xbfb8aa3b, v162
    v_mul_f32 v15, 0xbfb8aa3b, v163
    v_exp_f32 v14, v14
    v_exp_f32 v15, v15
    v_add_f32 v14, 1.0, v14
    v_add_f32 v15, 1.0, v15
    v_rcp_f32 v14, v14
    v_rcp_f32 v15, v15
    v_mul_f32 v162, v162, v14
    v_mul_f32 v163, v163, v15
    v_cvt_pk_bf16_f32 v61, v162, v163
    v_cvt_pk_bf16_f32 v11, v164, v165
    v_lshlrev_b32 v164, 16, v11
    v_and_b32 v165, 0xffff0000, v11
    v_mul_f32 v12, 0xbfb8aa3b, v164
    v_mul_f32 v13, 0xbfb8aa3b, v165
    v_exp_f32 v12, v12
    v_exp_f32 v13, v13
    v_add_f32 v12, 1.0, v12
    v_add_f32 v13, 1.0, v13
    v_rcp_f32 v12, v12
    v_rcp_f32 v13, v13
    v_mul_f32 v164, v164, v12
    v_mul_f32 v165, v165, v13
    v_cvt_pk_bf16_f32 v62, v164, v165
    v_cvt_pk_bf16_f32 v11, v166, v167
    v_lshlrev_b32 v166, 16, v11
    v_and_b32 v167, 0xffff0000, v11
    v_mul_f32 v14, 0xbfb8aa3b, v166
    v_mul_f32 v15, 0xbfb8aa3b, v167
    v_exp_f32 v14, v14
    v_exp_f32 v15, v15
    v_add_f32 v14, 1.0, v14
    v_add_f32 v15, 1.0, v15
    v_rcp_f32 v14, v14
    v_rcp_f32 v15, v15
    v_mul_f32 v166, v166, v14
    v_mul_f32 v167, v167, v15
    v_cvt_pk_bf16_f32 v63, v166, v167
    ds_write_b128 v0, v[56:59] offset:6144
    ds_write_b128 v0, v[60:63] offset:7168
    s_waitcnt lgkmcnt(0)
    s_barrier
    ds_read_b128 v[72:75], v1 offset:0
    ds_read_b128 v[76:79], v1 offset:1024
    ds_read_b128 v[80:83], v1 offset:2048
    ds_read_b128 v[84:87], v1 offset:3072
    ds_read_b128 v[88:91], v1 offset:4096
    ds_read_b128 v[92:95], v1 offset:5120
    ds_read_b128 v[96:99], v1 offset:6144
    ds_read_b128 v[100:103], v1 offset:7168
    s_waitcnt vmcnt(20)
    s_waitcnt lgkmcnt(7)
    v_mfma_f32_32x32x16_bf16 v[136:151], v[176:179], v[72:75], 0
    buffer_load_dwordx4 v[176:179], v1, s[12:15], s17 offen offset:1024
    ds_read_b128 v[72:75], v1 offset:8192
    s_waitcnt vmcnt(20)
    s_waitcnt lgkmcnt(7)
    v_mfma_f32_32x32x16_bf16 v[136:151], v[180:183], v[76:79], v[136:151]
    buffer_load_dwordx4 v[180:183], v1, s[12:15], s17 offen offset:2048
    ds_read_b128 v[76:79], v1 offset:9216
    s_waitcnt vmcnt(20)
    s_waitcnt lgkmcnt(7)
    v_mfma_f32_32x32x16_bf16 v[136:151], v[184:187], v[80:83], v[136:151]
    buffer_load_dwordx4 v[184:187], v1, s[12:15], s17 offen offset:3072
    s_add_u32 s17, s17, 4096
    ds_read_b128 v[80:83], v1 offset:10240
    s_waitcnt vmcnt(20)
    s_waitcnt lgkmcnt(7)
    v_mfma_f32_32x32x16_bf16 v[136:151], v[188:191], v[84:87], v[136:151]
    buffer_load_dwordx4 v[188:191], v1, s[12:15], s17 offen offset:0
    ds_read_b128 v[84:87], v1 offset:11264
    s_waitcnt vmcnt(20)
    s_waitcnt lgkmcnt(7)
    v_mfma_f32_32x32x16_bf16 v[136:151], v[192:195], v[88:91], v[136:151]
    buffer_load_dwordx4 v[192:195], v1, s[12:15], s17 offen offset:1024
    ds_read_b128 v[88:91], v1 offset:12288
    s_waitcnt vmcnt(20)
    s_waitcnt lgkmcnt(7)
    v_mfma_f32_32x32x16_bf16 v[136:151], v[196:199], v[92:95], v[136:151]
    buffer_load_dwordx4 v[196:199], v1, s[12:15], s17 offen offset:2048
    ds_read_b128 v[92:95], v1 offset:13312
    s_waitcnt vmcnt(20)
    s_waitcnt lgkmcnt(7)
    v_mfma_f32_32x32x16_bf16 v[136:151], v[200:203], v[96:99], v[136:151]
    buffer_load_dwordx4 v[200:203], v1, s[12:15], s17 offen offset:3072
    s_add_u32 s17, s17, 4096
    ds_read_b128 v[96:99], v1 offset:14336
    s_waitcnt vmcnt(20)
    s_waitcnt lgkmcnt(7)
    v_mfma_f32_32x32x16_bf16 v[136:151], v[204:207], v[100:103], v[136:151]
    buffer_load_dwordx4 v[204:207], v1, s[12:15], s17 offen offset:0
    ds_read_b128 v[100:103], v1 offset:15360
    s_waitcnt vmcnt(20)
    s_waitcnt lgkmcnt(7)
    v_mfma_f32_32x32x16_bf16 v[136:151], v[208:211], v[72:75], v[136:151]
    buffer_load_dwordx4 v[208:211], v1, s[12:15], s17 offen offset:1024
    ds_read_b128 v[72:75], v1 offset:16384
    s_waitcnt vmcnt(20)
    s_waitcnt lgkmcnt(7)
    v_mfma_f32_32x32x16_bf16 v[136:151], v[212:215], v[76:79], v[136:151]
    buffer_load_dwordx4 v[212:215], v1, s[12:15], s17 offen offset:2048
    ds_read_b128 v[76:79], v1 offset:17408
    s_waitcnt vmcnt(20)
    s_waitcnt lgkmcnt(7)
    v_mfma_f32_32x32x16_bf16 v[136:151], v[216:219], v[80:83], v[136:151]
    buffer_load_dwordx4 v[216:219], v1, s[12:15], s17 offen offset:3072
    s_add_u32 s17, s17, 4096
    ds_read_b128 v[80:83], v1 offset:18432
    s_waitcnt vmcnt(20)
    s_waitcnt lgkmcnt(7)
    v_mfma_f32_32x32x16_bf16 v[136:151], v[220:223], v[84:87], v[136:151]
    buffer_load_dwordx4 v[220:223], v1, s[12:15], s17 offen offset:0
    ds_read_b128 v[84:87], v1 offset:19456
    s_waitcnt vmcnt(20)
    s_waitcnt lgkmcnt(7)
    v_mfma_f32_32x32x16_bf16 v[136:151], v[224:227], v[88:91], v[136:151]
    buffer_load_dwordx4 v[224:227], v1, s[12:15], s17 offen offset:1024
    ds_read_b128 v[88:91], v1 offset:20480
    s_waitcnt vmcnt(20)
    s_waitcnt lgkmcnt(7)
    v_mfma_f32_32x32x16_bf16 v[136:151], v[228:231], v[92:95], v[136:151]
    buffer_load_dwordx4 v[228:231], v1, s[12:15], s17 offen offset:2048
    ds_read_b128 v[92:95], v1 offset:21504
    s_waitcnt vmcnt(20)
    s_waitcnt lgkmcnt(7)
    v_mfma_f32_32x32x16_bf16 v[136:151], v[232:235], v[96:99], v[136:151]
    buffer_load_dwordx4 v[232:235], v1, s[12:15], s17 offen offset:3072
    s_add_u32 s17, s17, 4096
    ds_read_b128 v[96:99], v1 offset:22528
    s_waitcnt vmcnt(20)
    s_waitcnt lgkmcnt(7)
    v_mfma_f32_32x32x16_bf16 v[136:151], v[236:239], v[100:103], v[136:151]
    buffer_load_dwordx4 v[236:239], v1, s[12:15], s17 offen offset:0
    ds_read_b128 v[100:103], v1 offset:23552
    s_waitcnt vmcnt(20)
    s_waitcnt lgkmcnt(7)
    v_mfma_f32_32x32x16_bf16 v[136:151], v[240:243], v[72:75], v[136:151]
    buffer_load_dwordx4 v[240:243], v1, s[12:15], s17 offen offset:1024
    ds_read_b128 v[72:75], v1 offset:24576
    s_waitcnt vmcnt(20)
    s_waitcnt lgkmcnt(7)
    v_mfma_f32_32x32x16_bf16 v[136:151], v[244:247], v[76:79], v[136:151]
    buffer_load_dwordx4 v[244:247], v1, s[12:15], s17 offen offset:2048
    ds_read_b128 v[76:79], v1 offset:25600
    s_waitcnt vmcnt(20)
    s_waitcnt lgkmcnt(7)
    v_mfma_f32_32x32x16_bf16 v[136:151], v[248:251], v[80:83], v[136:151]
    buffer_load_dwordx4 v[248:251], v1, s[12:15], s17 offen offset:3072
    s_add_u32 s17, s17, 4096
    ds_read_b128 v[80:83], v1 offset:26624
    s_waitcnt vmcnt(20)
    s_waitcnt lgkmcnt(7)
    v_mfma_f32_32x32x16_bf16 v[136:151], v[168:171], v[84:87], v[136:151]
    buffer_load_dwordx4 v[168:171], v1, s[12:15], s17 offen offset:0
    ds_read_b128 v[84:87], v1 offset:27648
    s_waitcnt vmcnt(20)
    s_waitcnt lgkmcnt(7)
    v_mfma_f32_32x32x16_bf16 v[136:151], v[172:175], v[88:91], v[136:151]
    buffer_load_dwordx4 v[172:175], v1, s[12:15], s17 offen offset:1024
    ds_read_b128 v[88:91], v1 offset:28672
    s_waitcnt vmcnt(20)
    s_waitcnt lgkmcnt(7)
    v_mfma_f32_32x32x16_bf16 v[136:151], v[176:179], v[92:95], v[136:151]
    buffer_load_dwordx4 v[176:179], v1, s[12:15], s17 offen offset:2048
    ds_read_b128 v[92:95], v1 offset:29696
    s_waitcnt vmcnt(20)
    s_waitcnt lgkmcnt(7)
    v_mfma_f32_32x32x16_bf16 v[136:151], v[180:183], v[96:99], v[136:151]
    buffer_load_dwordx4 v[180:183], v1, s[12:15], s17 offen offset:3072
    s_add_u32 s17, s17, 4096
    ds_read_b128 v[96:99], v1 offset:30720
    s_waitcnt vmcnt(20)
    s_waitcnt lgkmcnt(7)
    v_mfma_f32_32x32x16_bf16 v[136:151], v[184:187], v[100:103], v[136:151]
    buffer_load_dwordx4 v[184:187], v1, s[12:15], s17 offen offset:0
    ds_read_b128 v[100:103], v1 offset:31744
    s_waitcnt vmcnt(20)
    s_waitcnt lgkmcnt(7)
    v_mfma_f32_32x32x16_bf16 v[136:151], v[188:191], v[72:75], v[136:151]
    buffer_load_dwordx4 v[188:191], v1, s[12:15], s17 offen offset:1024
    ds_read_b128 v[72:75], v1 offset:32768
    s_waitcnt vmcnt(20)
    s_waitcnt lgkmcnt(7)
    v_mfma_f32_32x32x16_bf16 v[136:151], v[192:195], v[76:79], v[136:151]
    buffer_load_dwordx4 v[192:195], v1, s[12:15], s17 offen offset:2048
    ds_read_b128 v[76:79], v1 offset:33792
    s_waitcnt vmcnt(20)
    s_waitcnt lgkmcnt(7)
    v_mfma_f32_32x32x16_bf16 v[136:151], v[196:199], v[80:83], v[136:151]
    buffer_load_dwordx4 v[196:199], v1, s[12:15], s17 offen offset:3072
    s_add_u32 s17, s17, 4096
    ds_read_b128 v[80:83], v1 offset:34816
    s_waitcnt vmcnt(20)
    s_waitcnt lgkmcnt(7)
    v_mfma_f32_32x32x16_bf16 v[136:151], v[200:203], v[84:87], v[136:151]
    buffer_load_dwordx4 v[200:203], v1, s[12:15], s17 offen offset:0
    ds_read_b128 v[84:87], v1 offset:35840
    s_waitcnt vmcnt(20)
    s_waitcnt lgkmcnt(7)
    v_mfma_f32_32x32x16_bf16 v[136:151], v[204:207], v[88:91], v[136:151]
    buffer_load_dwordx4 v[204:207], v1, s[12:15], s17 offen offset:1024
    ds_read_b128 v[88:91], v1 offset:36864
    s_waitcnt vmcnt(20)
    s_waitcnt lgkmcnt(7)
    v_mfma_f32_32x32x16_bf16 v[136:151], v[208:211], v[92:95], v[136:151]
    buffer_load_dwordx4 v[208:211], v1, s[12:15], s17 offen offset:2048
    ds_read_b128 v[92:95], v1 offset:37888
    s_waitcnt vmcnt(20)
    s_waitcnt lgkmcnt(7)
    v_mfma_f32_32x32x16_bf16 v[136:151], v[212:215], v[96:99], v[136:151]
    buffer_load_dwordx4 v[212:215], v1, s[12:15], s17 offen offset:3072
    s_add_u32 s17, s17, 4096
    ds_read_b128 v[96:99], v1 offset:38912
    s_waitcnt vmcnt(20)
    s_waitcnt lgkmcnt(7)
    v_mfma_f32_32x32x16_bf16 v[136:151], v[216:219], v[100:103], v[136:151]
    buffer_load_dwordx4 v[216:219], v1, s[12:15], s17 offen offset:0
    ds_read_b128 v[100:103], v1 offset:39936
    s_waitcnt vmcnt(20)
    s_waitcnt lgkmcnt(7)
    v_mfma_f32_32x32x16_bf16 v[136:151], v[220:223], v[72:75], v[136:151]
    buffer_load_dwordx4 v[220:223], v1, s[12:15], s17 offen offset:1024
    ds_read_b128 v[72:75], v1 offset:40960
    s_waitcnt vmcnt(20)
    s_waitcnt lgkmcnt(7)
    v_mfma_f32_32x32x16_bf16 v[136:151], v[224:227], v[76:79], v[136:151]
    buffer_load_dwordx4 v[224:227], v1, s[12:15], s17 offen offset:2048
    ds_read_b128 v[76:79], v1 offset:41984
    s_waitcnt vmcnt(20)
    s_waitcnt lgkmcnt(7)
    v_mfma_f32_32x32x16_bf16 v[136:151], v[228:231], v[80:83], v[136:151]
    buffer_load_dwordx4 v[228:231], v1, s[12:15], s17 offen offset:3072
    s_add_u32 s17, s17, 4096
    ds_read_b128 v[80:83], v1 offset:43008
    s_waitcnt vmcnt(20)
    s_waitcnt lgkmcnt(7)
    v_mfma_f32_32x32x16_bf16 v[136:151], v[232:235], v[84:87], v[136:151]
    buffer_load_dwordx4 v[232:235], v1, s[12:15], s17 offen offset:0
    ds_read_b128 v[84:87], v1 offset:44032
    s_waitcnt vmcnt(20)
    s_waitcnt lgkmcnt(7)
    v_mfma_f32_32x32x16_bf16 v[136:151], v[236:239], v[88:91], v[136:151]
    buffer_load_dwordx4 v[236:239], v1, s[12:15], s17 offen offset:1024
    ds_read_b128 v[88:91], v1 offset:45056
    s_waitcnt vmcnt(20)
    s_waitcnt lgkmcnt(7)
    v_mfma_f32_32x32x16_bf16 v[136:151], v[240:243], v[92:95], v[136:151]
    buffer_load_dwordx4 v[240:243], v1, s[12:15], s17 offen offset:2048
    ds_read_b128 v[92:95], v1 offset:46080
    s_waitcnt vmcnt(20)
    s_waitcnt lgkmcnt(7)
    v_mfma_f32_32x32x16_bf16 v[136:151], v[244:247], v[96:99], v[136:151]
    buffer_load_dwordx4 v[244:247], v1, s[12:15], s17 offen offset:3072
    s_add_u32 s17, s17, 4096
    ds_read_b128 v[96:99], v1 offset:47104
    s_waitcnt vmcnt(20)
    s_waitcnt lgkmcnt(7)
    v_mfma_f32_32x32x16_bf16 v[136:151], v[248:251], v[100:103], v[136:151]
    buffer_load_dwordx4 v[248:251], v1, s[12:15], s17 offen offset:0
    ds_read_b128 v[100:103], v1 offset:48128
    s_waitcnt vmcnt(20)
    s_waitcnt lgkmcnt(7)
    v_mfma_f32_32x32x16_bf16 v[136:151], v[168:171], v[72:75], v[136:151]
    buffer_load_dwordx4 v[168:171], v1, s[12:15], s17 offen offset:1024
    ds_read_b128 v[72:75], v1 offset:49152
    s_waitcnt vmcnt(20)
    s_waitcnt lgkmcnt(7)
    v_mfma_f32_32x32x16_bf16 v[136:151], v[172:175], v[76:79], v[136:151]
    buffer_load_dwordx4 v[172:175], v1, s[12:15], s17 offen offset:2048
    ds_read_b128 v[76:79], v1 offset:50176
    s_waitcnt vmcnt(20)
    s_waitcnt lgkmcnt(7)
    v_mfma_f32_32x32x16_bf16 v[136:151], v[176:179], v[80:83], v[136:151]
    buffer_load_dwordx4 v[176:179], v1, s[12:15], s17 offen offset:3072
    s_add_u32 s17, s17, 4096
    ds_read_b128 v[80:83], v1 offset:51200
    s_waitcnt vmcnt(20)
    s_waitcnt lgkmcnt(7)
    v_mfma_f32_32x32x16_bf16 v[136:151], v[180:183], v[84:87], v[136:151]
    ds_read_b128 v[84:87], v1 offset:52224
    s_waitcnt vmcnt(19)
    s_waitcnt lgkmcnt(7)
    v_mfma_f32_32x32x16_bf16 v[136:151], v[184:187], v[88:91], v[136:151]
    ds_read_b128 v[88:91], v1 offset:53248
    s_waitcnt vmcnt(18)
    s_waitcnt lgkmcnt(7)
    v_mfma_f32_32x32x16_bf16 v[136:151], v[188:191], v[92:95], v[136:151]
    ds_read_b128 v[92:95], v1 offset:54272
    s_waitcnt vmcnt(17)
    s_waitcnt lgkmcnt(7)
    v_mfma_f32_32x32x16_bf16 v[136:151], v[192:195], v[96:99], v[136:151]
    ds_read_b128 v[96:99], v1 offset:55296
    s_waitcnt vmcnt(16)
    s_waitcnt lgkmcnt(7)
    v_mfma_f32_32x32x16_bf16 v[136:151], v[196:199], v[100:103], v[136:151]
    ds_read_b128 v[100:103], v1 offset:56320
    s_waitcnt vmcnt(15)
    s_waitcnt lgkmcnt(7)
    v_mfma_f32_32x32x16_bf16 v[136:151], v[200:203], v[72:75], v[136:151]
    ds_read_b128 v[72:75], v1 offset:57344
    s_waitcnt vmcnt(14)
    s_waitcnt lgkmcnt(7)
    v_mfma_f32_32x32x16_bf16 v[136:151], v[204:207], v[76:79], v[136:151]
    ds_read_b128 v[76:79], v1 offset:58368
    s_waitcnt vmcnt(13)
    s_waitcnt lgkmcnt(7)
    v_mfma_f32_32x32x16_bf16 v[136:151], v[208:211], v[80:83], v[136:151]
    ds_read_b128 v[80:83], v1 offset:59392
    s_waitcnt vmcnt(12)
    s_waitcnt lgkmcnt(7)
    v_mfma_f32_32x32x16_bf16 v[136:151], v[212:215], v[84:87], v[136:151]
    ds_read_b128 v[84:87], v1 offset:60416
    s_waitcnt vmcnt(11)
    s_waitcnt lgkmcnt(7)
    v_mfma_f32_32x32x16_bf16 v[136:151], v[216:219], v[88:91], v[136:151]
    ds_read_b128 v[88:91], v1 offset:61440
    s_waitcnt vmcnt(10)
    s_waitcnt lgkmcnt(7)
    v_mfma_f32_32x32x16_bf16 v[136:151], v[220:223], v[92:95], v[136:151]
    ds_read_b128 v[92:95], v1 offset:62464
    s_waitcnt vmcnt(9)
    s_waitcnt lgkmcnt(7)
    v_mfma_f32_32x32x16_bf16 v[136:151], v[224:227], v[96:99], v[136:151]
    ds_read_b128 v[96:99], v1 offset:63488
    s_waitcnt vmcnt(8)
    s_waitcnt lgkmcnt(7)
    v_mfma_f32_32x32x16_bf16 v[136:151], v[228:231], v[100:103], v[136:151]
    ds_read_b128 v[100:103], v1 offset:64512
    s_waitcnt vmcnt(7)
    s_waitcnt lgkmcnt(7)
    v_mfma_f32_32x32x16_bf16 v[136:151], v[232:235], v[72:75], v[136:151]
    s_waitcnt vmcnt(6)
    s_waitcnt lgkmcnt(6)
    v_mfma_f32_32x32x16_bf16 v[136:151], v[236:239], v[76:79], v[136:151]
    s_waitcnt vmcnt(5)
    s_waitcnt lgkmcnt(5)
    v_mfma_f32_32x32x16_bf16 v[136:151], v[240:243], v[80:83], v[136:151]
    s_waitcnt vmcnt(4)
    s_waitcnt lgkmcnt(4)
    v_mfma_f32_32x32x16_bf16 v[136:151], v[244:247], v[84:87], v[136:151]
    s_waitcnt vmcnt(3)
    s_waitcnt lgkmcnt(3)
    v_mfma_f32_32x32x16_bf16 v[136:151], v[248:251], v[88:91], v[136:151]
    s_waitcnt vmcnt(2)
    s_waitcnt lgkmcnt(2)
    v_mfma_f32_32x32x16_bf16 v[136:151], v[168:171], v[92:95], v[136:151]
    s_waitcnt vmcnt(1)
    s_waitcnt lgkmcnt(1)
    v_mfma_f32_32x32x16_bf16 v[136:151], v[172:175], v[96:99], v[136:151]
    s_waitcnt vmcnt(0)
    s_waitcnt lgkmcnt(0)
    v_mfma_f32_32x32x16_bf16 v[136:151], v[176:179], v[100:103], v[136:151]
    s_nop 11
    v_cvt_pk_bf16_f32 v6, v136, v137
    v_lshlrev_b32 v136, 16, v6
    v_and_b32 v137, 0xffff0000, v6
    v_cvt_pk_bf16_f32 v6, v138, v139
    v_lshlrev_b32 v138, 16, v6
    v_and_b32 v139, 0xffff0000, v6
    v_cvt_pk_bf16_f32 v6, v140, v141
    v_lshlrev_b32 v140, 16, v6
    v_and_b32 v141, 0xffff0000, v6
    v_cvt_pk_bf16_f32 v6, v142, v143
    v_lshlrev_b32 v142, 16, v6
    v_and_b32 v143, 0xffff0000, v6
    v_cvt_pk_bf16_f32 v6, v144, v145
    v_lshlrev_b32 v144, 16, v6
    v_and_b32 v145, 0xffff0000, v6
    v_cvt_pk_bf16_f32 v6, v146, v147
    v_lshlrev_b32 v146, 16, v6
    v_and_b32 v147, 0xffff0000, v6
    v_cvt_pk_bf16_f32 v6, v148, v149
    v_lshlrev_b32 v148, 16, v6
    v_and_b32 v149, 0xffff0000, v6
    v_cvt_pk_bf16_f32 v6, v150, v151
    v_lshlrev_b32 v150, 16, v6
    v_and_b32 v151, 0xffff0000, v6
    v_lshlrev_b32 v24, 16, v16
    v_and_b32 v25, 0xffff0000, v16
    v_lshlrev_b32 v26, 16, v17
    v_and_b32 v27, 0xffff0000, v17
    v_lshlrev_b32 v28, 16, v18
    v_and_b32 v29, 0xffff0000, v18
    v_lshlrev_b32 v30, 16, v19
    v_and_b32 v31, 0xffff0000, v19
    v_lshlrev_b32 v32, 16, v20
    v_and_b32 v33, 0xffff0000, v20
    v_lshlrev_b32 v34, 16, v21
    v_and_b32 v35, 0xffff0000, v21
    v_lshlrev_b32 v36, 16, v22
    v_and_b32 v37, 0xffff0000, v22
    v_lshlrev_b32 v38, 16, v23
    v_and_b32 v39, 0xffff0000, v23
    v_mov_b32 v8, 0.5
    v_pk_fma_f32 v[24:25], v[136:137], v[8:9], v[24:25] op_sel_hi:[1,0,1]
    v_pk_fma_f32 v[26:27], v[138:139], v[8:9], v[26:27] op_sel_hi:[1,0,1]
    v_pk_fma_f32 v[28:29], v[140:141], v[8:9], v[28:29] op_sel_hi:[1,0,1]
    v_pk_fma_f32 v[30:31], v[142:143], v[8:9], v[30:31] op_sel_hi:[1,0,1]
    v_pk_fma_f32 v[32:33], v[144:145], v[8:9], v[32:33] op_sel_hi:[1,0,1]
    v_pk_fma_f32 v[34:35], v[146:147], v[8:9], v[34:35] op_sel_hi:[1,0,1]
    v_pk_fma_f32 v[36:37], v[148:149], v[8:9], v[36:37] op_sel_hi:[1,0,1]
    v_pk_fma_f32 v[38:39], v[150:151], v[8:9], v[38:39] op_sel_hi:[1,0,1]
    v_cvt_pk_bf16_f32 v16, v24, v25
    v_cvt_pk_bf16_f32 v17, v26, v27
    v_cvt_pk_bf16_f32 v18, v28, v29
    v_cvt_pk_bf16_f32 v19, v30, v31
    v_cvt_pk_bf16_f32 v20, v32, v33
    v_cvt_pk_bf16_f32 v21, v34, v35
    v_cvt_pk_bf16_f32 v22, v36, v37
    v_cvt_pk_bf16_f32 v23, v38, v39
    v_lshlrev_b32 v24, 16, v16
    v_and_b32 v25, 0xffff0000, v16
    v_lshlrev_b32 v26, 16, v17
    v_and_b32 v27, 0xffff0000, v17
    v_lshlrev_b32 v28, 16, v18
    v_and_b32 v29, 0xffff0000, v18
    v_lshlrev_b32 v30, 16, v19
    v_and_b32 v31, 0xffff0000, v19
    v_lshlrev_b32 v32, 16, v20
    v_and_b32 v33, 0xffff0000, v20
    v_lshlrev_b32 v34, 16, v21
    v_and_b32 v35, 0xffff0000, v21
    v_lshlrev_b32 v36, 16, v22
    v_and_b32 v37, 0xffff0000, v22
    v_lshlrev_b32 v38, 16, v23
    v_and_b32 v39, 0xffff0000, v23
    v_pk_add_f32 v[6:7], v[24:25], v[26:27]
    v_pk_add_f32 v[8:9], v[28:29], v[30:31]
    v_pk_add_f32 v[10:11], v[32:33], v[34:35]
    v_pk_add_f32 v[12:13], v[36:37], v[38:39]
    v_pk_add_f32 v[6:7], v[6:7], v[8:9]
    v_pk_add_f32 v[10:11], v[10:11], v[12:13]
    v_pk_add_f32 v[6:7], v[6:7], v[10:11]
    v_add_f32 v6, v6, v7
    v_mul_f32 v6, 0x3d800000, v6
    v_pk_add_f32 v[10:11], v[24:25], v[6:7] op_sel_hi:[1,0] neg_lo:[0,1] neg_hi:[0,1]
    v_pk_mul_f32 v[8:9], v[10:11], v[10:11]
    v_pk_add_f32 v[12:13], v[26:27], v[6:7] op_sel_hi:[1,0] neg_lo:[0,1] neg_hi:[0,1]
    v_pk_fma_f32 v[8:9], v[12:13], v[12:13], v[8:9]
    v_pk_add_f32 v[10:11], v[28:29], v[6:7] op_sel_hi:[1,0] neg_lo:[0,1] neg_hi:[0,1]
    v_pk_fma_f32 v[8:9], v[10:11], v[10:11], v[8:9]
    v_pk_add_f32 v[12:13], v[30:31], v[6:7] op_sel_hi:[1,0] neg_lo:[0,1] neg_hi:[0,1]
    v_pk_fma_f32 v[8:9], v[12:13], v[12:13], v[8:9]
    v_pk_add_f32 v[10:11], v[32:33], v[6:7] op_sel_hi:[1,0] neg_lo:[0,1] neg_hi:[0,1]
    v_pk_fma_f32 v[8:9], v[10:11], v[10:11], v[8:9]
    v_pk_add_f32 v[12:13], v[34:35], v[6:7] op_sel_hi:[1,0] neg_lo:[0,1] neg_hi:[0,1]
    v_pk_fma_f32 v[8:9], v[12:13], v[12:13], v[8:9]
    v_pk_add_f32 v[10:11], v[36:37], v[6:7] op_sel_hi:[1,0] neg_lo:[0,1] neg_hi:[0,1]
    v_pk_fma_f32 v[8:9], v[10:11], v[10:11], v[8:9]
    v_pk_add_f32 v[12:13], v[38:39], v[6:7] op_sel_hi:[1,0] neg_lo:[0,1] neg_hi:[0,1]
    v_pk_fma_f32 v[8:9], v[12:13], v[12:13], v[8:9]
    v_add_f32 v8, v8, v9
    ds_write_b32 v2, v6 offset:0
    ds_write_b32 v2, v8 offset:2560
    s_waitcnt lgkmcnt(0)
    s_barrier
    ds_read_b128 v[40:43], v3 offset:0
    ds_read_b128 v[44:47], v3 offset:16
    ds_read_b128 v[48:51], v3 offset:32
    ds_read_b128 v[52:55], v3 offset:48
    ds_read_b128 v[56:59], v3 offset:2560
    ds_read_b128 v[60:63], v3 offset:2576
    ds_read_b128 v[64:67], v3 offset:2592
    ds_read_b128 v[68:71], v3 offset:2608
    s_waitcnt lgkmcnt(4)
    v_pk_add_f32 v[6:7], v[40:41], v[42:43]
    v_pk_add_f32 v[8:9], v[44:45], v[46:47]
    v_pk_add_f32 v[10:11], v[48:49], v[50:51]
    v_pk_add_f32 v[12:13], v[52:53], v[54:55]
    v_pk_add_f32 v[6:7], v[6:7], v[8:9]
    v_pk_add_f32 v[10:11], v[10:11], v[12:13]
    v_pk_add_f32 v[6:7], v[6:7], v[10:11]
    v_add_f32 v6, v6, v7
    v_mul_f32 v6, 0x3d800000, v6
    v_pk_add_f32 v[10:11], v[40:41], v[6:7] op_sel_hi:[1,0] neg_lo:[0,1] neg_hi:[0,1]
    v_pk_mul_f32 v[8:9], v[10:11], v[10:11]
    v_pk_add_f32 v[12:13], v[42:43], v[6:7] op_sel_hi:[1,0] neg_lo:[0,1] neg_hi:[0,1]
    v_pk_fma_f32 v[8:9], v[12:13], v[12:13], v[8:9]
    v_pk_add_f32 v[10:11], v[44:45], v[6:7] op_sel_hi:[1,0] neg_lo:[0,1] neg_hi:[0,1]
    v_pk_fma_f32 v[8:9], v[10:11], v[10:11], v[8:9]
    v_pk_add_f32 v[12:13], v[46:47], v[6:7] op_sel_hi:[1,0] neg_lo:[0,1] neg_hi:[0,1]
    v_pk_fma_f32 v[8:9], v[12:13], v[12:13], v[8:9]
    v_pk_add_f32 v[10:11], v[48:49], v[6:7] op_sel_hi:[1,0] neg_lo:[0,1] neg_hi:[0,1]
    v_pk_fma_f32 v[8:9], v[10:11], v[10:11], v[8:9]
    v_pk_add_f32 v[12:13], v[50:51], v[6:7] op_sel_hi:[1,0] neg_lo:[0,1] neg_hi:[0,1]
    v_pk_fma_f32 v[8:9], v[12:13], v[12:13], v[8:9]
    v_pk_add_f32 v[10:11], v[52:53], v[6:7] op_sel_hi:[1,0] neg_lo:[0,1] neg_hi:[0,1]
    v_pk_fma_f32 v[8:9], v[10:11], v[10:11], v[8:9]
    v_pk_add_f32 v[12:13], v[54:55], v[6:7] op_sel_hi:[1,0] neg_lo:[0,1] neg_hi:[0,1]
    v_pk_fma_f32 v[8:9], v[12:13], v[12:13], v[8:9]
    v_add_f32 v8, v8, v9
    s_waitcnt lgkmcnt(0)
    v_pk_add_f32 v[40:41], v[56:57], v[58:59]
    v_pk_add_f32 v[42:43], v[60:61], v[62:63]
    v_pk_add_f32 v[44:45], v[64:65], v[66:67]
    v_pk_add_f32 v[46:47], v[68:69], v[70:71]
    v_pk_add_f32 v[40:41], v[40:41], v[42:43]
    v_pk_add_f32 v[44:45], v[44:45], v[46:47]
    v_pk_add_f32 v[40:41], v[40:41], v[44:45]
    v_add_f32 v40, v40, v41
    v_fmac_f32 v40, 0x41800000, v8
    v_mul_f32 v8, 0x3b800000, v40
    v_cvt_pk_bf16_f32 v10, v6, v8
    v_lshlrev_b32 v6, 16, v10
    v_and_b32 v8, 0xffff0000, v10
    v_add_f32 v8, 0x3727c5ac, v8
    v_cvt_pk_bf16_f32 v10, v8, v8
    v_lshlrev_b32 v8, 16, v10
    v_sqrt_f32 v8, v8
    v_pk_add_f32 v[40:41], v[24:25], v[6:7] op_sel_hi:[1,0] neg_lo:[0,1] neg_hi:[0,1]
    v_pk_add_f32 v[42:43], v[26:27], v[6:7] op_sel_hi:[1,0] neg_lo:[0,1] neg_hi:[0,1]
    v_pk_add_f32 v[44:45], v[28:29], v[6:7] op_sel_hi:[1,0] neg_lo:[0,1] neg_hi:[0,1]
    v_pk_add_f32 v[46:47], v[30:31], v[6:7] op_sel_hi:[1,0] neg_lo:[0,1] neg_hi:[0,1]
    v_pk_add_f32 v[48:49], v[32:33], v[6:7] op_sel_hi:[1,0] neg_lo:[0,1] neg_hi:[0,1]
    v_pk_add_f32 v[50:51], v[34:35], v[6:7] op_sel_hi:[1,0] neg_lo:[0,1] neg_hi:[0,1]
    v_pk_add_f32 v[52:53], v[36:37], v[6:7] op_sel_hi:[1,0] neg_lo:[0,1] neg_hi:[0,1]
    v_pk_add_f32 v[54:55], v[38:39], v[6:7] op_sel_hi:[1,0] neg_lo:[0,1] neg_hi:[0,1]
    v_cvt_pk_bf16_f32 v10, v8, v8
    v_lshlrev_b32 v8, 16, v10
    v_rcp_f32 v8, v8
    v_cvt_pk_bf16_f32 v10, v40, v41
    v_lshlrev_b32 v40, 16, v10
    v_and_b32 v41, 0xffff0000, v10
    v_cvt_pk_bf16_f32 v10, v42, v43
    v_lshlrev_b32 v42, 16, v10
    v_and_b32 v43, 0xffff0000, v10
    v_cvt_pk_bf16_f32 v10, v44, v45
    v_lshlrev_b32 v44, 16, v10
    v_and_b32 v45, 0xffff0000, v10
    v_cvt_pk_bf16_f32 v10, v46, v47
    v_lshlrev_b32 v46, 16, v10
    v_and_b32 v47, 0xffff0000, v10
    v_cvt_pk_bf16_f32 v10, v48, v49
    v_lshlrev_b32 v48, 16, v10
    v_and_b32 v49, 0xffff0000, v10
    v_cvt_pk_bf16_f32 v10, v50, v51
    v_lshlrev_b32 v50, 16, v10
    v_and_b32 v51, 0xffff0000, v10
    v_cvt_pk_bf16_f32 v10, v52, v53
    v_lshlrev_b32 v52, 16, v10
    v_and_b32 v53, 0xffff0000, v10
    v_cvt_pk_bf16_f32 v10, v54, v55
    v_lshlrev_b32 v54, 16, v10
    v_and_b32 v55, 0xffff0000, v10
    v_pk_mul_f32 v[40:41], v[40:41], v[8:9] op_sel_hi:[1,0]
    v_pk_mul_f32 v[42:43], v[42:43], v[8:9] op_sel_hi:[1,0]
    v_pk_mul_f32 v[44:45], v[44:45], v[8:9] op_sel_hi:[1,0]
    v_pk_mul_f32 v[46:47], v[46:47], v[8:9] op_sel_hi:[1,0]
    v_pk_mul_f32 v[48:49], v[48:49], v[8:9] op_sel_hi:[1,0]
    v_pk_mul_f32 v[50:51], v[50:51], v[8:9] op_sel_hi:[1,0]
    v_pk_mul_f32 v[52:53], v[52:53], v[8:9] op_sel_hi:[1,0]
    v_pk_mul_f32 v[54:55], v[54:55], v[8:9] op_sel_hi:[1,0]
    v_cvt_pk_bf16_f32 v56, v40, v41
    v_cvt_pk_bf16_f32 v57, v42, v43
    v_cvt_pk_bf16_f32 v58, v44, v45
    v_cvt_pk_bf16_f32 v59, v46, v47
    v_cvt_pk_bf16_f32 v60, v48, v49
    v_cvt_pk_bf16_f32 v61, v50, v51
    v_cvt_pk_bf16_f32 v62, v52, v53
    v_cvt_pk_bf16_f32 v63, v54, v55
    v_lshrrev_b32 v8, 4, v1
    v_and_b32 v9, 31, v8
    v_lshrrev_b32 v8, 5, v8
    v_lshlrev_b32 v9, 9, v9
    v_lshl_add_u32 v11, v8, 3, v9
    s_lshl_b32 s18, s2, 14
    s_add_u32 s18, s18, s29
    s_mov_b32 s8, s24
    s_and_b32 s9, s25, 0xffff
    s_mov_b32 s10, 4096000
    s_mov_b32 s11, 0x20000
    buffer_store_dwordx2 v[56:57], v11, s[8:11], s18 offen offset:0
    buffer_store_dwordx2 v[58:59], v11, s[8:11], s18 offen offset:16
    buffer_store_dwordx2 v[60:61], v11, s[8:11], s18 offen offset:32
    buffer_store_dwordx2 v[62:63], v11, s[8:11], s18 offen offset:48
L_k34_end_post_kernel:
    s_endpgm
.section .rodata,"a"
.p2align 6
.amdhsa_kernel pack_kernel
  .amdhsa_next_free_vgpr 72
  .amdhsa_next_free_sgpr 102
  .amdhsa_accum_offset 72
  .amdhsa_group_segment_fixed_size 0
  .amdhsa_kernarg_size 104
  .amdhsa_user_sgpr_count 2
  .amdhsa_user_sgpr_kernarg_segment_ptr 1
  .amdhsa_system_sgpr_workgroup_id_x 1
.end_amdhsa_kernel
.p2align 6
.amdhsa_kernel ff1qkv_kernel
  .amdhsa_next_free_vgpr 256
  .amdhsa_next_free_sgpr 102
  .amdhsa_accum_offset 256
  .amdhsa_group_segment_fixed_size 0
  .amdhsa_kernarg_size 104
  .amdhsa_user_sgpr_count 2
  .amdhsa_user_sgpr_kernarg_segment_ptr 1
  .amdhsa_system_sgpr_workgroup_id_x 1
.end_amdhsa_kernel
.p2align 6
.amdhsa_kernel attn_kernel
  .amdhsa_next_free_vgpr 256
  .amdhsa_next_free_sgpr 102
  .amdhsa_accum_offset 256
  .amdhsa_group_segment_fixed_size 0
  .amdhsa_kernarg_size 104
  .amdhsa_user_sgpr_count 2
  .amdhsa_user_sgpr_kernarg_segment_ptr 1
  .amdhsa_system_sgpr_workgroup_id_x 1
.end_amdhsa_kernel
.p2align 6
.amdhsa_kernel post_kernel
  .amdhsa_next_free_vgpr 256
  .amdhsa_next_free_sgpr 102
  .amdhsa_accum_offset 256
  .amdhsa_group_segment_fixed_size 0
  .amdhsa_kernarg_size 104
  .amdhsa_user_sgpr_count 2
  .amdhsa_user_sgpr_kernarg_segment_ptr 1
  .amdhsa_system_sgpr_workgroup_id_x 1
.end_amdhsa_kernel
```
